```python
import torch

def _softmax(x, axis=-1):
    return torch.softmax(x, dim=axis)

def _gelu(x):
    return torch.nn.functional.gelu(x, approximate='tanh')

def _silu(x):
    return torch.nn.functional.silu(x)

def _sigmoid(x):
    return torch.sigmoid(x)

def _layernorm(x, axis=-1, eps=1e-05):
    m = x.mean(dim=axis, keepdim=True)
    v = x.var(dim=axis, keepdim=True, unbiased=False)
    return (x - m) / torch.sqrt(v + eps)

def _scatter_add(tgt, idx, src, axis=0):
    return tgt.clone().index_add_(axis, idx, src)

def _segment_sum(src, seg, n):
    out = torch.zeros((n,) + src.shape[1:], dtype=src.dtype)
    return out.index_add_(0, seg, src)

def _pad(x, pw):
    flat = tuple((v for pair in reversed(pw) for v in pair))
    return torch.nn.functional.pad(x, flat)
kernel_name = 'gated_mix__memory_aug_recurrent_mem_tr__dense_activation_silu__prompt'

def setup_inputs():

    _w = lambda a: (lambda t: t.to(torch.bfloat16) if t.is_floating_point() else t)(torch.as_tensor(a))

    def _A_setup():
        B, S, Dm = (1, 2048, 512)
        H, Dh = (32, 128)
        M, seg = (8, 32)
        seg = min(seg, S)
        S = S // seg * seg
        return {'x': _w((lambda *s: torch.randn(*s, dtype=torch.bfloat16) * 0.05)(B, S, Dm)), 'mem0': _w((lambda *s: torch.randn(*s, dtype=torch.bfloat16) * 0.4)(B, M, Dm)), 'Wq': _w((lambda *s: torch.randn(*s, dtype=torch.bfloat16) * 6.4)(Dm, H, Dh) * Dm ** (-0.5)), 'Wk': _w((lambda *s: torch.randn(*s, dtype=torch.bfloat16) * 6.4)(Dm, H, Dh) * Dm ** (-0.5)), 'Wv': _w((lambda *s: torch.randn(*s, dtype=torch.bfloat16) * 0.4)(Dm, H, Dh) * Dm ** (-0.5)), 'Wo': _w((lambda *s: torch.randn(*s, dtype=torch.bfloat16) * 0.4)(H, Dh, Dm) * (H * Dh) ** (-0.5)), 'seg_len': seg}
    _A_in = _A_setup()

    def _B_setup():
        B, S, D, F = (1, 2048, 512, 1376)
        return {'x': _w((lambda *s: torch.randn(*s, dtype=torch.bfloat16) * 0.05)(B, S, D)), 'w1': _w((lambda *s: torch.randn(*s, dtype=torch.bfloat16) * 3.2)(D, F) * D ** (-0.5)), 'w2': _w((lambda *s: torch.randn(*s, dtype=torch.bfloat16) * 0.2)(F, D) * F ** (-0.5))}
    _B_in = _B_setup()
    return {'A_x': _A_in['x'], 'A_mem0': _A_in['mem0'], 'A_Wq': _A_in['Wq'], 'A_Wk': _A_in['Wk'], 'A_Wv': _A_in['Wv'], 'A_Wo': _A_in['Wo'], 'A_seg_len': _A_in['seg_len'], 'B_x': _B_in['x'], 'B_w1': _B_in['w1'], 'B_w2': _B_in['w2'], 'gate_w': _w((lambda *s: torch.randn(*s, dtype=torch.bfloat16) * 0.05)(512) * 16.0)}

def reference(A_x, A_mem0, A_Wq, A_Wk, A_Wv, A_Wo, A_seg_len, B_x, B_w1, B_w2, gate_w):

    def _A_ref(x, mem0, Wq, Wk, Wv, Wo, seg_len):
        B, S, Dm = x.shape
        H, Dh = (Wq.shape[1], Wq.shape[2])
        M = mem0.shape[1]
        scale = Dh ** (-0.5)
        n_seg = S // seg_len
        L = M + seg_len
        idx = torch.arange(L)
        mask = (idx[:, None] < M) | (idx[:, None] >= idx[None, :])
        mem = mem0
        outs = []
        for s in range(n_seg):
            xs = x[:, s * seg_len:(s + 1) * seg_len, :].clone()
            h = torch.concatenate([mem, xs], axis=1)
            q = torch.einsum('btd,dhe->bhte', h, Wq)
            k = torch.einsum('btd,dhe->bhte', h, Wk)
            v = torch.einsum('btd,dhe->bhte', h, Wv)
            scores = torch.einsum('bhqe,bhke->bhqk', q, k) * scale
            scores = torch.where(mask[None, None], scores, -1000000000.0)
            p = _softmax(scores, axis=-1)
            o = torch.einsum('bhqk,bhke->bhqe', p, v)
            o = torch.einsum('bhte,hed->btd', o, Wo)
            mem = o[:, :M, :].clone()
            outs.append(o[:, M:, :])
        return torch.concatenate(outs, axis=1)

    def _B_ref(x, w1, w2):
        h = torch.einsum('bsd,df->bsf', x, w1)
        h = _silu(h)
        out = torch.einsum('bsf,fd->bsd', h, w2)
        return out
    x = A_x
    g = _sigmoid((x * gate_w).sum(-1, keepdims=True))
    a = _A_ref(x, A_mem0, A_Wq, A_Wk, A_Wv, A_Wo, A_seg_len)
    b = _B_ref(x, B_w1, B_w2)
    return g * a + (1 - g) * b
```

```asm
; @launch grid=(256,1,1) block=(256,1,1) lds=163840
.amdgcn_target "amdgcn-amd-amdhsa--gfx950"
.text
.globl gated_mix__memory_aug_recurrent_mem_tr__dense_activation_silu__prompt_kernel
.p2align 8
.type gated_mix__memory_aug_recurrent_mem_tr__dense_activation_silu__prompt_kernel,@function
gated_mix__memory_aug_recurrent_mem_tr__dense_activation_silu__prompt_kernel:
    s_cmp_ge_u32 s2, 256
    s_cbranch_scc1 L_exit
    s_load_dwordx16 s[64:79], s[0:1], 0
    s_load_dwordx8 s[80:87], s[0:1], 64
    s_load_dwordx4 s[88:91], s[0:1], 96
    s_and_b32 s34, s2, 7
    s_lshr_b32 s33, s2, 3
    s_getpc_b64 s[44:45]
L_pc:
    s_mov_b32 s46, 0
    s_mov_b32 s47, L_chain-L_pc
    s_cmp_lt_u32 s34, 3
    s_cselect_b32 s46, L_out-L_pc, s46
    s_cselect_b32 s47, L_exit-L_out, s47
    s_cmp_eq_u32 s34, 0
    s_cselect_b32 s46, L_chain-L_pc, s46
    s_cselect_b32 s47, L_top_s-L_chain, s47
    v_lshlrev_b32 v2, 7, v0
    s_add_u32 s44, s44, s46
    s_addc_u32 s45, s45, 0
    v_min_u32 v2, s47, v2
    v_mov_b32 v5, s45
    v_add_co_u32 v4, vcc, s44, v2
    v_addc_co_u32 v5, vcc, 0, v5, vcc
    global_load_dword v255, v[4:5], off
    v_lshrrev_b32 v1, 6, v0
    s_mov_b32 s41, 0
    v_readfirstlane_b32 s32, v1
    s_cmp_eq_u32 s34, 0
    s_cbranch_scc1 L_chain
    s_waitcnt lgkmcnt(0)
    s_mov_b32 s4, s90
    s_mov_b32 s5, s91
    s_mov_b32 s6, 0x5860000
    s_mov_b32 s7, 0x00020000
    s_mov_b32 s8, s88
    s_mov_b32 s9, s89
    s_mov_b32 s10, 0x100
    s_mov_b32 s11, 0x00020000
    s_mov_b32 s12, s64
    s_mov_b32 s13, s65
    s_mov_b32 s14, 0x200000
    s_mov_b32 s15, 0x00020000
    s_cmp_lt_u32 s34, 3
    s_cbranch_scc1 L_out
    s_sub_u32 s35, s34, 3
    s_lshl_b32 s35, s35, 5
    s_add_u32 s35, s35, s33
    s_mul_i32 s44, s35, 205
    s_lshr_b32 s44, s44, 10
    s_mul_i32 s36, s44, 5
    s_sub_u32 s45, s35, s36
    s_mov_b32 s16, s68
    s_mov_b32 s17, s69
    s_mov_b32 s18, 0x400000
    s_mov_b32 s19, 0x00020000
    s_mov_b32 s20, s70
    s_mov_b32 s21, s71
    s_mov_b32 s22, 0x400000
    s_mov_b32 s23, 0x00020000
    s_mov_b32 s24, s72
    s_mov_b32 s25, s73
    s_mov_b32 s26, 0x400000
    s_mov_b32 s27, 0x00020000
    v_and_b32 v1, 63, v0
    v_lshlrev_b32 v2, 4, v1
    v_mov_b32 v10, 0
    v_mul_u32_u24 v3, 528, v1
    s_lshl_b32 s35, s32, 7
    v_add_u32 v3, s35, v3
    v_lshrrev_b32 v4, 5, v1
    v_mul_u32_u24 v4, 528, v4
    v_and_b32 v12, 31, v1
    v_lshlrev_b32 v12, 4, v12
    v_add_u32 v4, v4, v12
    s_mov_b32 s46, s45
    v_lshrrev_b32 v5, 2, v1
    v_mul_u32_u24 v5, 8192, v5
    v_and_b32 v12, 3, v1
    v_lshlrev_b32 v12, 4, v12
    v_add_u32 v5, v5, v12
    s_lshl_b32 s35, s44, 8
    s_lshl_b32 s36, s32, 6
    s_add_u32 s35, s35, s36
    v_add_u32 v5, s35, v5
    s_mul_i32 s37, s32, 6144
    s_add_u32 s37, s37, 81920
    v_lshrrev_b32 v6, 2, v1
    v_lshlrev_b32 v6, 6, v6
    v_lshrrev_b32 v12, 4, v1
    v_lshlrev_b32 v12, 7, v12
    v_add_u32 v6, v6, v12
    v_and_b32 v12, 3, v1
    v_lshlrev_b32 v12, 4, v12
    v_add_u32 v6, v6, v12
    v_add_u32 v6, s37, v6
    v_lshrrev_b32 v12, 4, v1
    v_bfe_u32 v13, v1, 2, 2
    v_and_b32 v7, 3, v1
    v_lshlrev_b32 v7, 3, v7
    v_bfe_u32 v15, v12, 1, 1
    v_mul_u32_u24 v15, 768, v15
    v_add_u32 v7, v7, v15
    v_bfe_u32 v15, v13, 0, 2
    v_mul_u32_u24 v15, 64, v15
    v_add_u32 v7, v7, v15
    v_bfe_u32 v15, v12, 0, 1
    v_mul_u32_u24 v15, 32, v15
    v_add_u32 v7, v7, v15
    v_add_u32 v7, s37, v7
    s_lshl_b32 s35, s32, 10
    v_bfe_u32 v8, v1, 4, 1
    v_mul_u32_u24 v8, 4096, v8
    v_bfe_u32 v15, v1, 5, 1
    v_mul_u32_u24 v15, 256, v15
    v_add_u32 v8, v8, v15
    v_bfe_u32 v15, v1, 0, 4
    v_mul_u32_u24 v15, 16, v15
    v_add_u32 v8, v8, v15
    v_add_u32 v8, s35, v8
    s_lshl_b32 s35, s32, 11
    v_bfe_u32 v9, v1, 4, 1
    v_mul_u32_u24 v9, 1024, v9
    v_bfe_u32 v15, v1, 5, 1
    v_mul_u32_u24 v15, 256, v15
    v_add_u32 v9, v9, v15
    v_bfe_u32 v15, v1, 0, 4
    v_mul_u32_u24 v15, 16, v15
    v_add_u32 v9, v9, v15
    v_add_u32 v9, s35, v9
    s_mov_b32 s35, 0x0
    buffer_load_dwordx4 a[128:131], v5, s[20:23], s35 offen
    s_mov_b32 s35, 0x20000
    buffer_load_dwordx4 a[132:135], v5, s[20:23], s35 offen
    s_mov_b32 s35, 0x40000
    buffer_load_dwordx4 a[136:139], v5, s[20:23], s35 offen
    s_mov_b32 s35, 0x60000
    buffer_load_dwordx4 a[140:143], v5, s[20:23], s35 offen
    s_mov_b32 s35, 0x80000
    buffer_load_dwordx4 a[144:147], v5, s[20:23], s35 offen
    s_mov_b32 s35, 0xa0000
    buffer_load_dwordx4 a[148:151], v5, s[20:23], s35 offen
    s_mov_b32 s35, 0xc0000
    buffer_load_dwordx4 a[152:155], v5, s[20:23], s35 offen
    s_mov_b32 s35, 0xe0000
    buffer_load_dwordx4 a[156:159], v5, s[20:23], s35 offen
    s_mov_b32 s35, 0x100000
    buffer_load_dwordx4 a[160:163], v5, s[20:23], s35 offen
    s_mov_b32 s35, 0x120000
    buffer_load_dwordx4 a[164:167], v5, s[20:23], s35 offen
    s_mov_b32 s35, 0x140000
    buffer_load_dwordx4 a[168:171], v5, s[20:23], s35 offen
    s_mov_b32 s35, 0x160000
    buffer_load_dwordx4 a[172:175], v5, s[20:23], s35 offen
    s_mov_b32 s35, 0x180000
    buffer_load_dwordx4 a[176:179], v5, s[20:23], s35 offen
    s_mov_b32 s35, 0x1a0000
    buffer_load_dwordx4 a[180:183], v5, s[20:23], s35 offen
    s_mov_b32 s35, 0x1c0000
    buffer_load_dwordx4 a[184:187], v5, s[20:23], s35 offen
    s_mov_b32 s35, 0x1e0000
    buffer_load_dwordx4 a[188:191], v5, s[20:23], s35 offen
    s_mov_b32 s35, 0x200000
    buffer_load_dwordx4 a[192:195], v5, s[20:23], s35 offen
    s_mov_b32 s35, 0x220000
    buffer_load_dwordx4 a[196:199], v5, s[20:23], s35 offen
    s_mov_b32 s35, 0x240000
    buffer_load_dwordx4 a[200:203], v5, s[20:23], s35 offen
    s_mov_b32 s35, 0x260000
    buffer_load_dwordx4 a[204:207], v5, s[20:23], s35 offen
    s_waitcnt vmcnt(18)
    ds_write_b128 v6, a[128:131] offset:0
    ds_write_b128 v6, a[132:135] offset:1536
    ds_read_b64_tr_b16 a[128:129], v7 offset:0
    ds_read_b64_tr_b16 a[130:131], v7 offset:384
    ds_read_b64_tr_b16 a[132:133], v7 offset:1536
    ds_read_b64_tr_b16 a[134:135], v7 offset:1920
    s_mov_b32 s35, 0x280000
    buffer_load_dwordx4 a[208:211], v5, s[20:23], s35 offen
    s_mov_b32 s35, 0x2a0000
    buffer_load_dwordx4 a[212:215], v5, s[20:23], s35 offen
    s_waitcnt vmcnt(18)
    ds_write_b128 v6, a[136:139] offset:3072
    ds_write_b128 v6, a[140:143] offset:4608
    ds_read_b64_tr_b16 a[136:137], v7 offset:3072
    ds_read_b64_tr_b16 a[138:139], v7 offset:3456
    ds_read_b64_tr_b16 a[140:141], v7 offset:4608
    ds_read_b64_tr_b16 a[142:143], v7 offset:4992
    s_mov_b32 s35, 0x2c0000
    buffer_load_dwordx4 a[216:219], v5, s[20:23], s35 offen
    s_mov_b32 s35, 0x2e0000
    buffer_load_dwordx4 a[220:223], v5, s[20:23], s35 offen
    s_waitcnt vmcnt(18)
    ds_write_b128 v6, a[144:147] offset:0
    ds_write_b128 v6, a[148:151] offset:1536
    ds_read_b64_tr_b16 a[144:145], v7 offset:0
    ds_read_b64_tr_b16 a[146:147], v7 offset:384
    ds_read_b64_tr_b16 a[148:149], v7 offset:1536
    ds_read_b64_tr_b16 a[150:151], v7 offset:1920
    s_mov_b32 s35, 0x300000
    buffer_load_dwordx4 a[224:227], v5, s[20:23], s35 offen
    s_mov_b32 s35, 0x320000
    buffer_load_dwordx4 a[228:231], v5, s[20:23], s35 offen
    s_waitcnt vmcnt(18)
    ds_write_b128 v6, a[152:155] offset:3072
    ds_write_b128 v6, a[156:159] offset:4608
    ds_read_b64_tr_b16 a[152:153], v7 offset:3072
    ds_read_b64_tr_b16 a[154:155], v7 offset:3456
    ds_read_b64_tr_b16 a[156:157], v7 offset:4608
    ds_read_b64_tr_b16 a[158:159], v7 offset:4992
    s_mov_b32 s35, 0x340000
    buffer_load_dwordx4 a[232:235], v5, s[20:23], s35 offen
    s_mov_b32 s35, 0x360000
    buffer_load_dwordx4 a[236:239], v5, s[20:23], s35 offen
    s_waitcnt vmcnt(18)
    ds_write_b128 v6, a[160:163] offset:0
    ds_write_b128 v6, a[164:167] offset:1536
    ds_read_b64_tr_b16 a[160:161], v7 offset:0
    ds_read_b64_tr_b16 a[162:163], v7 offset:384
    ds_read_b64_tr_b16 a[164:165], v7 offset:1536
    ds_read_b64_tr_b16 a[166:167], v7 offset:1920
    s_mov_b32 s35, 0x380000
    buffer_load_dwordx4 a[240:243], v5, s[20:23], s35 offen
    s_mov_b32 s35, 0x3a0000
    buffer_load_dwordx4 a[244:247], v5, s[20:23], s35 offen
    s_waitcnt vmcnt(18)
    ds_write_b128 v6, a[168:171] offset:3072
    ds_write_b128 v6, a[172:175] offset:4608
    ds_read_b64_tr_b16 a[168:169], v7 offset:3072
    ds_read_b64_tr_b16 a[170:171], v7 offset:3456
    ds_read_b64_tr_b16 a[172:173], v7 offset:4608
    ds_read_b64_tr_b16 a[174:175], v7 offset:4992
    s_mov_b32 s35, 0x3c0000
    buffer_load_dwordx4 a[248:251], v5, s[20:23], s35 offen
    s_mov_b32 s35, 0x3e0000
    buffer_load_dwordx4 a[252:255], v5, s[20:23], s35 offen
    s_waitcnt vmcnt(18)
    ds_write_b128 v6, a[176:179] offset:0
    ds_write_b128 v6, a[180:183] offset:1536
    ds_read_b64_tr_b16 a[176:177], v7 offset:0
    ds_read_b64_tr_b16 a[178:179], v7 offset:384
    ds_read_b64_tr_b16 a[180:181], v7 offset:1536
    ds_read_b64_tr_b16 a[182:183], v7 offset:1920
    s_mov_b32 s35, 0x0
    buffer_load_dwordx4 v[128:131], v5, s[24:27], s35 offen
    s_mov_b32 s35, 0x20000
    buffer_load_dwordx4 v[132:135], v5, s[24:27], s35 offen
    s_lshl_b32 s35, s46, 15
    s_lshl_b32 s36, s32, 13
    s_add_u32 s35, s35, s36
    buffer_load_dwordx4 v[16:19], v2, s[12:15], s35 offen offset:0
    buffer_load_dwordx4 v[20:23], v2, s[12:15], s35 offen offset:1024
    buffer_load_dwordx4 v[24:27], v2, s[12:15], s35 offen offset:2048
    buffer_load_dwordx4 v[28:31], v2, s[12:15], s35 offen offset:3072
    s_add_u32 s35, s35, 4096
    buffer_load_dwordx4 v[32:35], v2, s[12:15], s35 offen offset:0
    buffer_load_dwordx4 v[36:39], v2, s[12:15], s35 offen offset:1024
    buffer_load_dwordx4 v[40:43], v2, s[12:15], s35 offen offset:2048
    buffer_load_dwordx4 v[44:47], v2, s[12:15], s35 offen offset:3072
    s_waitcnt vmcnt(26)
    ds_write_b128 v6, a[184:187] offset:3072
    ds_write_b128 v6, a[188:191] offset:4608
    ds_read_b64_tr_b16 a[184:185], v7 offset:3072
    ds_read_b64_tr_b16 a[186:187], v7 offset:3456
    ds_read_b64_tr_b16 a[188:189], v7 offset:4608
    ds_read_b64_tr_b16 a[190:191], v7 offset:4992
    s_mov_b32 s35, 0x40000
    buffer_load_dwordx4 v[136:139], v5, s[24:27], s35 offen
    s_mov_b32 s35, 0x60000
    buffer_load_dwordx4 v[140:143], v5, s[24:27], s35 offen
    s_waitcnt vmcnt(26)
    ds_write_b128 v6, a[192:195] offset:0
    ds_write_b128 v6, a[196:199] offset:1536
    ds_read_b64_tr_b16 a[192:193], v7 offset:0
    ds_read_b64_tr_b16 a[194:195], v7 offset:384
    ds_read_b64_tr_b16 a[196:197], v7 offset:1536
    ds_read_b64_tr_b16 a[198:199], v7 offset:1920
    s_mov_b32 s35, 0x80000
    buffer_load_dwordx4 v[144:147], v5, s[24:27], s35 offen
    s_mov_b32 s35, 0xa0000
    buffer_load_dwordx4 v[148:151], v5, s[24:27], s35 offen
    s_waitcnt vmcnt(26)
    ds_write_b128 v6, a[200:203] offset:3072
    ds_write_b128 v6, a[204:207] offset:4608
    ds_read_b64_tr_b16 a[200:201], v7 offset:3072
    ds_read_b64_tr_b16 a[202:203], v7 offset:3456
    ds_read_b64_tr_b16 a[204:205], v7 offset:4608
    ds_read_b64_tr_b16 a[206:207], v7 offset:4992
    s_mov_b32 s35, 0xc0000
    buffer_load_dwordx4 v[152:155], v5, s[24:27], s35 offen
    s_mov_b32 s35, 0xe0000
    buffer_load_dwordx4 v[156:159], v5, s[24:27], s35 offen
    s_waitcnt vmcnt(26)
    ds_write_b128 v6, a[208:211] offset:0
    ds_write_b128 v6, a[212:215] offset:1536
    ds_read_b64_tr_b16 a[208:209], v7 offset:0
    ds_read_b64_tr_b16 a[210:211], v7 offset:384
    ds_read_b64_tr_b16 a[212:213], v7 offset:1536
    ds_read_b64_tr_b16 a[214:215], v7 offset:1920
    s_mov_b32 s35, 0x100000
    buffer_load_dwordx4 v[160:163], v5, s[24:27], s35 offen
    s_mov_b32 s35, 0x120000
    buffer_load_dwordx4 v[164:167], v5, s[24:27], s35 offen
    s_waitcnt vmcnt(26)
    ds_write_b128 v6, a[216:219] offset:3072
    ds_write_b128 v6, a[220:223] offset:4608
    ds_read_b64_tr_b16 a[216:217], v7 offset:3072
    ds_read_b64_tr_b16 a[218:219], v7 offset:3456
    ds_read_b64_tr_b16 a[220:221], v7 offset:4608
    ds_read_b64_tr_b16 a[222:223], v7 offset:4992
    s_mov_b32 s35, 0x140000
    buffer_load_dwordx4 v[168:171], v5, s[24:27], s35 offen
    s_mov_b32 s35, 0x160000
    buffer_load_dwordx4 v[172:175], v5, s[24:27], s35 offen
    s_waitcnt vmcnt(26)
    ds_write_b128 v6, a[224:227] offset:0
    ds_write_b128 v6, a[228:231] offset:1536
    ds_read_b64_tr_b16 a[224:225], v7 offset:0
    ds_read_b64_tr_b16 a[226:227], v7 offset:384
    ds_read_b64_tr_b16 a[228:229], v7 offset:1536
    ds_read_b64_tr_b16 a[230:231], v7 offset:1920
    s_mov_b32 s35, 0x180000
    buffer_load_dwordx4 v[176:179], v5, s[24:27], s35 offen
    s_mov_b32 s35, 0x1a0000
    buffer_load_dwordx4 v[180:183], v5, s[24:27], s35 offen
    s_waitcnt vmcnt(26)
    ds_write_b128 v6, a[232:235] offset:3072
    ds_write_b128 v6, a[236:239] offset:4608
    ds_read_b64_tr_b16 a[232:233], v7 offset:3072
    ds_read_b64_tr_b16 a[234:235], v7 offset:3456
    ds_read_b64_tr_b16 a[236:237], v7 offset:4608
    ds_read_b64_tr_b16 a[238:239], v7 offset:4992
    s_mov_b32 s35, 0x1c0000
    buffer_load_dwordx4 v[184:187], v5, s[24:27], s35 offen
    s_mov_b32 s35, 0x1e0000
    buffer_load_dwordx4 v[188:191], v5, s[24:27], s35 offen
    s_waitcnt vmcnt(26)
    ds_write_b128 v6, a[240:243] offset:0
    ds_write_b128 v6, a[244:247] offset:1536
    ds_read_b64_tr_b16 a[240:241], v7 offset:0
    ds_read_b64_tr_b16 a[242:243], v7 offset:384
    ds_read_b64_tr_b16 a[244:245], v7 offset:1536
    ds_read_b64_tr_b16 a[246:247], v7 offset:1920
    s_mov_b32 s35, 0x200000
    buffer_load_dwordx4 v[192:195], v5, s[24:27], s35 offen
    s_mov_b32 s35, 0x220000
    buffer_load_dwordx4 v[196:199], v5, s[24:27], s35 offen
    s_waitcnt vmcnt(26)
    ds_write_b128 v6, a[248:251] offset:3072
    ds_write_b128 v6, a[252:255] offset:4608
    ds_read_b64_tr_b16 a[248:249], v7 offset:3072
    ds_read_b64_tr_b16 a[250:251], v7 offset:3456
    ds_read_b64_tr_b16 a[252:253], v7 offset:4608
    ds_read_b64_tr_b16 a[254:255], v7 offset:4992
    s_mov_b32 s35, 0x240000
    buffer_load_dwordx4 v[200:203], v5, s[24:27], s35 offen
    s_mov_b32 s35, 0x260000
    buffer_load_dwordx4 v[204:207], v5, s[24:27], s35 offen
    s_waitcnt vmcnt(26)
    ds_write_b128 v6, v[128:131] offset:0
    ds_write_b128 v6, v[132:135] offset:1536
    ds_read_b64_tr_b16 v[128:129], v7 offset:0
    ds_read_b64_tr_b16 v[130:131], v7 offset:384
    ds_read_b64_tr_b16 v[132:133], v7 offset:1536
    ds_read_b64_tr_b16 v[134:135], v7 offset:1920
    s_mov_b32 s35, 0x280000
    buffer_load_dwordx4 v[208:211], v5, s[24:27], s35 offen
    s_mov_b32 s35, 0x2a0000
    buffer_load_dwordx4 v[212:215], v5, s[24:27], s35 offen
    s_waitcnt vmcnt(18)
    ds_write_b128 v3, v[16:19] offset:0
    ds_write_b128 v3, v[20:23] offset:16
    ds_write_b128 v3, v[24:27] offset:32
    ds_write_b128 v3, v[28:31] offset:48
    ds_write_b128 v3, v[32:35] offset:64
    ds_write_b128 v3, v[36:39] offset:80
    ds_write_b128 v3, v[40:43] offset:96
    ds_write_b128 v3, v[44:47] offset:112
    ds_write_b128 v6, v[136:139] offset:3072
    ds_write_b128 v6, v[140:143] offset:4608
    ds_read_b64_tr_b16 v[136:137], v7 offset:3072
    ds_read_b64_tr_b16 v[138:139], v7 offset:3456
    ds_read_b64_tr_b16 v[140:141], v7 offset:4608
    ds_read_b64_tr_b16 v[142:143], v7 offset:4992
    s_mov_b32 s35, 0x2c0000
    buffer_load_dwordx4 v[216:219], v5, s[24:27], s35 offen
    s_mov_b32 s35, 0x2e0000
    buffer_load_dwordx4 v[220:223], v5, s[24:27], s35 offen
    s_waitcnt vmcnt(18)
    ds_write_b128 v6, v[144:147] offset:0
    ds_write_b128 v6, v[148:151] offset:1536
    ds_read_b64_tr_b16 v[144:145], v7 offset:0
    ds_read_b64_tr_b16 v[146:147], v7 offset:384
    ds_read_b64_tr_b16 v[148:149], v7 offset:1536
    ds_read_b64_tr_b16 v[150:151], v7 offset:1920
    s_mov_b32 s35, 0x300000
    buffer_load_dwordx4 v[224:227], v5, s[24:27], s35 offen
    s_mov_b32 s35, 0x320000
    buffer_load_dwordx4 v[228:231], v5, s[24:27], s35 offen
    s_waitcnt vmcnt(18)
    ds_write_b128 v6, v[152:155] offset:3072
    ds_write_b128 v6, v[156:159] offset:4608
    ds_read_b64_tr_b16 v[152:153], v7 offset:3072
    ds_read_b64_tr_b16 v[154:155], v7 offset:3456
    ds_read_b64_tr_b16 v[156:157], v7 offset:4608
    ds_read_b64_tr_b16 v[158:159], v7 offset:4992
    s_mov_b32 s35, 0x340000
    buffer_load_dwordx4 v[232:235], v5, s[24:27], s35 offen
    s_mov_b32 s35, 0x360000
    buffer_load_dwordx4 v[236:239], v5, s[24:27], s35 offen
    s_waitcnt vmcnt(18)
    ds_write_b128 v6, v[160:163] offset:0
    ds_write_b128 v6, v[164:167] offset:1536
    ds_read_b64_tr_b16 v[160:161], v7 offset:0
    ds_read_b64_tr_b16 v[162:163], v7 offset:384
    ds_read_b64_tr_b16 v[164:165], v7 offset:1536
    ds_read_b64_tr_b16 v[166:167], v7 offset:1920
    s_mov_b32 s35, 0x380000
    buffer_load_dwordx4 v[240:243], v5, s[24:27], s35 offen
    s_mov_b32 s35, 0x3a0000
    buffer_load_dwordx4 v[244:247], v5, s[24:27], s35 offen
    s_waitcnt vmcnt(18)
    ds_write_b128 v6, v[168:171] offset:3072
    ds_write_b128 v6, v[172:175] offset:4608
    ds_read_b64_tr_b16 v[168:169], v7 offset:3072
    ds_read_b64_tr_b16 v[170:171], v7 offset:3456
    ds_read_b64_tr_b16 v[172:173], v7 offset:4608
    ds_read_b64_tr_b16 v[174:175], v7 offset:4992
    s_mov_b32 s35, 0x3c0000
    buffer_load_dwordx4 v[248:251], v5, s[24:27], s35 offen
    s_mov_b32 s35, 0x3e0000
    buffer_load_dwordx4 v[252:255], v5, s[24:27], s35 offen
    s_waitcnt vmcnt(18)
    ds_write_b128 v6, v[176:179] offset:0
    ds_write_b128 v6, v[180:183] offset:1536
    ds_read_b64_tr_b16 v[176:177], v7 offset:0
    ds_read_b64_tr_b16 v[178:179], v7 offset:384
    ds_read_b64_tr_b16 v[180:181], v7 offset:1536
    ds_read_b64_tr_b16 v[182:183], v7 offset:1920
    s_waitcnt vmcnt(16)
    ds_write_b128 v6, v[184:187] offset:3072
    ds_write_b128 v6, v[188:191] offset:4608
    ds_read_b64_tr_b16 v[184:185], v7 offset:3072
    ds_read_b64_tr_b16 v[186:187], v7 offset:3456
    ds_read_b64_tr_b16 v[188:189], v7 offset:4608
    ds_read_b64_tr_b16 v[190:191], v7 offset:4992
    s_waitcnt vmcnt(14)
    ds_write_b128 v6, v[192:195] offset:0
    ds_write_b128 v6, v[196:199] offset:1536
    ds_read_b64_tr_b16 v[192:193], v7 offset:0
    ds_read_b64_tr_b16 v[194:195], v7 offset:384
    ds_read_b64_tr_b16 v[196:197], v7 offset:1536
    ds_read_b64_tr_b16 v[198:199], v7 offset:1920
    s_waitcnt vmcnt(12)
    ds_write_b128 v6, v[200:203] offset:3072
    ds_write_b128 v6, v[204:207] offset:4608
    ds_read_b64_tr_b16 v[200:201], v7 offset:3072
    ds_read_b64_tr_b16 v[202:203], v7 offset:3456
    ds_read_b64_tr_b16 v[204:205], v7 offset:4608
    ds_read_b64_tr_b16 v[206:207], v7 offset:4992
    s_waitcnt vmcnt(10)
    ds_write_b128 v6, v[208:211] offset:0
    ds_write_b128 v6, v[212:215] offset:1536
    ds_read_b64_tr_b16 v[208:209], v7 offset:0
    ds_read_b64_tr_b16 v[210:211], v7 offset:384
    ds_read_b64_tr_b16 v[212:213], v7 offset:1536
    ds_read_b64_tr_b16 v[214:215], v7 offset:1920
    s_waitcnt vmcnt(8)
    ds_write_b128 v6, v[216:219] offset:3072
    ds_write_b128 v6, v[220:223] offset:4608
    ds_read_b64_tr_b16 v[216:217], v7 offset:3072
    ds_read_b64_tr_b16 v[218:219], v7 offset:3456
    ds_read_b64_tr_b16 v[220:221], v7 offset:4608
    ds_read_b64_tr_b16 v[222:223], v7 offset:4992
    s_waitcnt vmcnt(6)
    ds_write_b128 v6, v[224:227] offset:0
    ds_write_b128 v6, v[228:231] offset:1536
    ds_read_b64_tr_b16 v[224:225], v7 offset:0
    ds_read_b64_tr_b16 v[226:227], v7 offset:384
    ds_read_b64_tr_b16 v[228:229], v7 offset:1536
    ds_read_b64_tr_b16 v[230:231], v7 offset:1920
    s_waitcnt vmcnt(4)
    ds_write_b128 v6, v[232:235] offset:3072
    ds_write_b128 v6, v[236:239] offset:4608
    ds_read_b64_tr_b16 v[232:233], v7 offset:3072
    ds_read_b64_tr_b16 v[234:235], v7 offset:3456
    ds_read_b64_tr_b16 v[236:237], v7 offset:4608
    ds_read_b64_tr_b16 v[238:239], v7 offset:4992
    s_waitcnt vmcnt(2)
    ds_write_b128 v6, v[240:243] offset:0
    ds_write_b128 v6, v[244:247] offset:1536
    ds_read_b64_tr_b16 v[240:241], v7 offset:0
    ds_read_b64_tr_b16 v[242:243], v7 offset:384
    ds_read_b64_tr_b16 v[244:245], v7 offset:1536
    ds_read_b64_tr_b16 v[246:247], v7 offset:1920
    s_waitcnt vmcnt(0)
    ds_write_b128 v6, v[248:251] offset:3072
    ds_write_b128 v6, v[252:255] offset:4608
    ds_read_b64_tr_b16 v[248:249], v7 offset:3072
    ds_read_b64_tr_b16 v[250:251], v7 offset:3456
    ds_read_b64_tr_b16 v[252:253], v7 offset:4608
    ds_read_b64_tr_b16 v[254:255], v7 offset:4992
    s_waitcnt lgkmcnt(0)
    s_waitcnt lgkmcnt(0)
    s_barrier
    s_mov_b32 s48, 36864
    v_add_u32 v3, s48, v3
    s_mov_b32 s52, -1
    s_mov_b32 s53, 1
    s_lshl_b32 s60, s44, 7
    s_lshl_b32 s35, s45, 2
    s_add_u32 s60, s60, s35
    s_add_u32 s60, s60, 0x110000
    buffer_load_dword v15, v10, s[8:11], 0 offen offset:0 sc1
    ds_read_b128 v[48:51], v4 offset:0
    ds_read_b128 v[52:55], v4 offset:1056
    ds_read_b128 v[56:59], v4 offset:2112
    ds_read_b128 v[60:63], v4 offset:3168
    s_waitcnt lgkmcnt(3)
    v_mfma_f32_32x32x16_bf16 v[80:95], a[128:131], v[48:51], 0
    v_mfma_f32_32x32x16_bf16 v[96:111], v[48:51], v[128:131], 0
    ds_read_b128 v[48:51], v4 offset:4224
    s_waitcnt lgkmcnt(3)
    v_mfma_f32_32x32x16_bf16 v[80:95], a[132:135], v[52:55], v[80:95]
    v_mfma_f32_32x32x16_bf16 v[96:111], v[52:55], v[132:135], v[96:111]
    ds_read_b128 v[52:55], v4 offset:5280
    s_waitcnt lgkmcnt(3)
    v_mfma_f32_32x32x16_bf16 v[80:95], a[136:139], v[56:59], v[80:95]
    v_mfma_f32_32x32x16_bf16 v[96:111], v[56:59], v[136:139], v[96:111]
    ds_read_b128 v[56:59], v4 offset:6336
    s_waitcnt lgkmcnt(3)
    v_mfma_f32_32x32x16_bf16 v[80:95], a[140:143], v[60:63], v[80:95]
    v_mfma_f32_32x32x16_bf16 v[96:111], v[60:63], v[140:143], v[96:111]
    ds_read_b128 v[60:63], v4 offset:7392
    s_waitcnt lgkmcnt(3)
    v_mfma_f32_32x32x16_bf16 v[80:95], a[144:147], v[48:51], v[80:95]
    v_mfma_f32_32x32x16_bf16 v[96:111], v[48:51], v[144:147], v[96:111]
    ds_read_b128 v[48:51], v4 offset:8448
    s_waitcnt lgkmcnt(3)
    v_mfma_f32_32x32x16_bf16 v[80:95], a[148:151], v[52:55], v[80:95]
    v_mfma_f32_32x32x16_bf16 v[96:111], v[52:55], v[148:151], v[96:111]
    ds_read_b128 v[52:55], v4 offset:9504
    s_waitcnt lgkmcnt(3)
    v_mfma_f32_32x32x16_bf16 v[80:95], a[152:155], v[56:59], v[80:95]
    v_mfma_f32_32x32x16_bf16 v[96:111], v[56:59], v[152:155], v[96:111]
    ds_read_b128 v[56:59], v4 offset:10560
    s_waitcnt lgkmcnt(3)
    v_mfma_f32_32x32x16_bf16 v[80:95], a[156:159], v[60:63], v[80:95]
    v_mfma_f32_32x32x16_bf16 v[96:111], v[60:63], v[156:159], v[96:111]
    ds_read_b128 v[60:63], v4 offset:11616
    s_waitcnt lgkmcnt(3)
    v_mfma_f32_32x32x16_bf16 v[80:95], a[160:163], v[48:51], v[80:95]
    v_mfma_f32_32x32x16_bf16 v[96:111], v[48:51], v[160:163], v[96:111]
    ds_read_b128 v[48:51], v4 offset:12672
    s_waitcnt lgkmcnt(3)
    v_mfma_f32_32x32x16_bf16 v[80:95], a[164:167], v[52:55], v[80:95]
    v_mfma_f32_32x32x16_bf16 v[96:111], v[52:55], v[164:167], v[96:111]
    ds_read_b128 v[52:55], v4 offset:13728
    s_waitcnt lgkmcnt(3)
    v_mfma_f32_32x32x16_bf16 v[80:95], a[168:171], v[56:59], v[80:95]
    v_mfma_f32_32x32x16_bf16 v[96:111], v[56:59], v[168:171], v[96:111]
    ds_read_b128 v[56:59], v4 offset:14784
    s_waitcnt lgkmcnt(3)
    v_mfma_f32_32x32x16_bf16 v[80:95], a[172:175], v[60:63], v[80:95]
    v_mfma_f32_32x32x16_bf16 v[96:111], v[60:63], v[172:175], v[96:111]
    ds_read_b128 v[60:63], v4 offset:15840
    s_waitcnt lgkmcnt(3)
    v_mfma_f32_32x32x16_bf16 v[80:95], a[176:179], v[48:51], v[80:95]
    v_mfma_f32_32x32x16_bf16 v[96:111], v[48:51], v[176:179], v[96:111]
    ds_read_b128 v[48:51], v4 offset:16896
    s_waitcnt lgkmcnt(3)
    v_mfma_f32_32x32x16_bf16 v[80:95], a[180:183], v[52:55], v[80:95]
    v_mfma_f32_32x32x16_bf16 v[96:111], v[52:55], v[180:183], v[96:111]
    ds_read_b128 v[52:55], v4 offset:17952
    s_waitcnt lgkmcnt(3)
    v_mfma_f32_32x32x16_bf16 v[80:95], a[184:187], v[56:59], v[80:95]
    v_mfma_f32_32x32x16_bf16 v[96:111], v[56:59], v[184:187], v[96:111]
    ds_read_b128 v[56:59], v4 offset:19008
    s_waitcnt lgkmcnt(3)
    v_mfma_f32_32x32x16_bf16 v[80:95], a[188:191], v[60:63], v[80:95]
    v_mfma_f32_32x32x16_bf16 v[96:111], v[60:63], v[188:191], v[96:111]
    ds_read_b128 v[60:63], v4 offset:20064
    s_waitcnt lgkmcnt(3)
    v_mfma_f32_32x32x16_bf16 v[80:95], a[192:195], v[48:51], v[80:95]
    v_mfma_f32_32x32x16_bf16 v[96:111], v[48:51], v[192:195], v[96:111]
    ds_read_b128 v[48:51], v4 offset:21120
    s_waitcnt lgkmcnt(3)
    v_mfma_f32_32x32x16_bf16 v[80:95], a[196:199], v[52:55], v[80:95]
    v_mfma_f32_32x32x16_bf16 v[96:111], v[52:55], v[196:199], v[96:111]
    ds_read_b128 v[52:55], v4 offset:22176
    s_waitcnt lgkmcnt(3)
    v_mfma_f32_32x32x16_bf16 v[80:95], a[200:203], v[56:59], v[80:95]
    v_mfma_f32_32x32x16_bf16 v[96:111], v[56:59], v[200:203], v[96:111]
    ds_read_b128 v[56:59], v4 offset:23232
    s_waitcnt lgkmcnt(3)
    v_mfma_f32_32x32x16_bf16 v[80:95], a[204:207], v[60:63], v[80:95]
    v_mfma_f32_32x32x16_bf16 v[96:111], v[60:63], v[204:207], v[96:111]
    ds_read_b128 v[60:63], v4 offset:24288
    s_waitcnt lgkmcnt(3)
    v_mfma_f32_32x32x16_bf16 v[80:95], a[208:211], v[48:51], v[80:95]
    v_mfma_f32_32x32x16_bf16 v[96:111], v[48:51], v[208:211], v[96:111]
    ds_read_b128 v[48:51], v4 offset:25344
    s_waitcnt lgkmcnt(3)
    v_mfma_f32_32x32x16_bf16 v[80:95], a[212:215], v[52:55], v[80:95]
    v_mfma_f32_32x32x16_bf16 v[96:111], v[52:55], v[212:215], v[96:111]
    ds_read_b128 v[52:55], v4 offset:26400
    s_waitcnt lgkmcnt(3)
    v_mfma_f32_32x32x16_bf16 v[80:95], a[216:219], v[56:59], v[80:95]
    v_mfma_f32_32x32x16_bf16 v[96:111], v[56:59], v[216:219], v[96:111]
    ds_read_b128 v[56:59], v4 offset:27456
    s_waitcnt lgkmcnt(3)
    v_mfma_f32_32x32x16_bf16 v[80:95], a[220:223], v[60:63], v[80:95]
    v_mfma_f32_32x32x16_bf16 v[96:111], v[60:63], v[220:223], v[96:111]
    ds_read_b128 v[60:63], v4 offset:28512
    s_waitcnt lgkmcnt(3)
    v_mfma_f32_32x32x16_bf16 v[80:95], a[224:227], v[48:51], v[80:95]
    v_mfma_f32_32x32x16_bf16 v[96:111], v[48:51], v[224:227], v[96:111]
    ds_read_b128 v[48:51], v4 offset:29568
    s_waitcnt lgkmcnt(3)
    v_mfma_f32_32x32x16_bf16 v[80:95], a[228:231], v[52:55], v[80:95]
    v_mfma_f32_32x32x16_bf16 v[96:111], v[52:55], v[228:231], v[96:111]
    ds_read_b128 v[52:55], v4 offset:30624
    s_waitcnt lgkmcnt(3)
    v_mfma_f32_32x32x16_bf16 v[80:95], a[232:235], v[56:59], v[80:95]
    v_mfma_f32_32x32x16_bf16 v[96:111], v[56:59], v[232:235], v[96:111]
    ds_read_b128 v[56:59], v4 offset:31680
    s_waitcnt lgkmcnt(3)
    v_mfma_f32_32x32x16_bf16 v[80:95], a[236:239], v[60:63], v[80:95]
    v_mfma_f32_32x32x16_bf16 v[96:111], v[60:63], v[236:239], v[96:111]
    ds_read_b128 v[60:63], v4 offset:32736
    s_waitcnt lgkmcnt(3)
    v_mfma_f32_32x32x16_bf16 v[80:95], a[240:243], v[48:51], v[80:95]
    v_mfma_f32_32x32x16_bf16 v[96:111], v[48:51], v[240:243], v[96:111]
    s_waitcnt lgkmcnt(2)
    v_mfma_f32_32x32x16_bf16 v[80:95], a[244:247], v[52:55], v[80:95]
    v_mfma_f32_32x32x16_bf16 v[96:111], v[52:55], v[244:247], v[96:111]
    s_waitcnt lgkmcnt(1)
    v_mfma_f32_32x32x16_bf16 v[80:95], a[248:251], v[56:59], v[80:95]
    v_mfma_f32_32x32x16_bf16 v[96:111], v[56:59], v[248:251], v[96:111]
    s_waitcnt lgkmcnt(0)
    v_mfma_f32_32x32x16_bf16 v[80:95], a[252:255], v[60:63], v[80:95]
    v_mfma_f32_32x32x16_bf16 v[96:111], v[60:63], v[252:255], v[96:111]
    s_nop 11
    s_lshl_b32 s49, s46, 5
    s_add_u32 s49, s49, s44
    s_lshl_b32 s50, s49, 14
    s_lshl_b32 s51, s49, 12
    s_lshl_b32 s49, s49, 13
    v_cvt_pk_bf16_f32 v112, v80, v81
    v_cvt_pk_bf16_f32 v113, v82, v83
    v_cvt_pk_bf16_f32 v114, v84, v85
    v_cvt_pk_bf16_f32 v115, v86, v87
    v_cvt_pk_bf16_f32 v116, v88, v89
    v_cvt_pk_bf16_f32 v117, v90, v91
    v_cvt_pk_bf16_f32 v118, v92, v93
    v_cvt_pk_bf16_f32 v119, v94, v95
    s_add_u32 s35, s50, 0x1000000
    buffer_store_dwordx4 v[112:115], v8, s[4:7], s35 offen offset:0 sc1
    buffer_store_dwordx4 v[116:119], v8, s[4:7], s35 offen offset:512 sc1
    v_cvt_pk_bf16_f32 v120, v96, v97
    v_cvt_pk_bf16_f32 v121, v98, v99
    v_cvt_pk_bf16_f32 v122, v104, v105
    v_cvt_pk_bf16_f32 v123, v106, v107
    v_cvt_pk_bf16_f32 v124, v100, v101
    v_cvt_pk_bf16_f32 v125, v102, v103
    v_cvt_pk_bf16_f32 v126, v108, v109
    v_cvt_pk_bf16_f32 v127, v110, v111
    s_add_u32 s35, s50, 0x1002000
    buffer_store_dwordx4 v[120:123], v9, s[4:7], s35 offen offset:0 sc1
    buffer_store_dwordx4 v[124:127], v9, s[4:7], s35 offen offset:512 sc1
    v_mov_b32 v56, -1
    v_mov_b32 v57, -1
    v_mov_b32 v58, -1
    v_mov_b32 v59, -1
    s_lshl_b32 s36, s32, 10
    s_add_u32 s35, s51, s36
    s_add_u32 s35, s35, 0x200000
    buffer_store_dwordx4 v[56:59], v2, s[4:7], s35 offen sc1
    s_mov_b32 s35, 0x0
    buffer_load_dwordx4 a[0:3], v5, s[16:19], s35 offen
    s_mov_b32 s35, 0x20000
    buffer_load_dwordx4 a[4:7], v5, s[16:19], s35 offen
    s_mov_b32 s35, 0x40000
    buffer_load_dwordx4 a[8:11], v5, s[16:19], s35 offen
    s_mov_b32 s35, 0x60000
    buffer_load_dwordx4 a[12:15], v5, s[16:19], s35 offen
    s_mov_b32 s35, 0x80000
    buffer_load_dwordx4 a[16:19], v5, s[16:19], s35 offen
    s_mov_b32 s35, 0xa0000
    buffer_load_dwordx4 a[20:23], v5, s[16:19], s35 offen
    s_mov_b32 s35, 0xc0000
    buffer_load_dwordx4 a[24:27], v5, s[16:19], s35 offen
    s_mov_b32 s35, 0xe0000
    buffer_load_dwordx4 a[28:31], v5, s[16:19], s35 offen
    s_mov_b32 s35, 0x100000
    buffer_load_dwordx4 a[32:35], v5, s[16:19], s35 offen
    s_mov_b32 s35, 0x120000
    buffer_load_dwordx4 a[36:39], v5, s[16:19], s35 offen
    s_mov_b32 s35, 0x140000
    buffer_load_dwordx4 a[40:43], v5, s[16:19], s35 offen
    s_mov_b32 s35, 0x160000
    buffer_load_dwordx4 a[44:47], v5, s[16:19], s35 offen
    s_mov_b32 s35, 0x180000
    buffer_load_dwordx4 a[48:51], v5, s[16:19], s35 offen
    s_mov_b32 s35, 0x1a0000
    buffer_load_dwordx4 a[52:55], v5, s[16:19], s35 offen
    s_mov_b32 s35, 0x1c0000
    buffer_load_dwordx4 a[56:59], v5, s[16:19], s35 offen
    s_mov_b32 s35, 0x1e0000
    buffer_load_dwordx4 a[60:63], v5, s[16:19], s35 offen
    s_waitcnt vmcnt(16)
    s_barrier
    s_cmp_lg_u32 s32, 0
    s_cbranch_scc1 L_hq_nf1_1
    v_readfirstlane_b32 s35, v15
    s_and_b32 s35, s35, 0xff
    s_cmp_ge_u32 s35, 32
    s_cbranch_scc1 L_hq_ci_2
    s_mov_b32 s37, 0
    s_mov_b32 s38, 0
    s_mov_b32 s36, 0
    s_cmp_lg_u32 s41, 0
    s_cbranch_scc1 L_wdhqci_4
L_whqci_3:
    buffer_load_dword v11, v10, s[8:11], s37 offen sc1
    s_waitcnt vmcnt(0)
    v_readfirstlane_b32 s35, v11
    s_lshr_b32 s35, s35, s38
    s_and_b32 s35, s35, 0xff
    s_cmp_ge_u32 s35, 32
    s_cbranch_scc1 L_wdhqci_4
    s_sleep 4
    s_add_u32 s36, s36, 1
    s_cmp_lt_u32 s36, 131072
    s_cbranch_scc1 L_whqci_3
    s_mov_b32 s41, 1
L_wdhqci_4:
L_hq_ci_2:
    v_mov_b32 v11, s53
    s_mov_b64 exec, 1
    buffer_store_dword v11, off, s[4:7], s60 sc1
    s_mov_b64 exec, -1
L_hq_nf1_1:
    s_waitcnt vmcnt(14)
    ds_write_b128 v6, a[0:3] offset:0
    ds_write_b128 v6, a[4:7] offset:1536
    ds_read_b64_tr_b16 a[0:1], v7 offset:0
    ds_read_b64_tr_b16 a[2:3], v7 offset:384
    ds_read_b64_tr_b16 a[4:5], v7 offset:1536
    ds_read_b64_tr_b16 a[6:7], v7 offset:1920
    s_mov_b32 s35, 0x200000
    buffer_load_dwordx4 a[64:67], v5, s[16:19], s35 offen
    s_mov_b32 s35, 0x220000
    buffer_load_dwordx4 a[68:71], v5, s[16:19], s35 offen
    s_waitcnt vmcnt(14)
    ds_write_b128 v6, a[8:11] offset:3072
    ds_write_b128 v6, a[12:15] offset:4608
    ds_read_b64_tr_b16 a[8:9], v7 offset:3072
    ds_read_b64_tr_b16 a[10:11], v7 offset:3456
    ds_read_b64_tr_b16 a[12:13], v7 offset:4608
    ds_read_b64_tr_b16 a[14:15], v7 offset:4992
    s_mov_b32 s35, 0x240000
    buffer_load_dwordx4 a[72:75], v5, s[16:19], s35 offen
    s_mov_b32 s35, 0x260000
    buffer_load_dwordx4 a[76:79], v5, s[16:19], s35 offen
    s_waitcnt vmcnt(14)
    ds_write_b128 v6, a[16:19] offset:0
    ds_write_b128 v6, a[20:23] offset:1536
    ds_read_b64_tr_b16 a[16:17], v7 offset:0
    ds_read_b64_tr_b16 a[18:19], v7 offset:384
    ds_read_b64_tr_b16 a[20:21], v7 offset:1536
    ds_read_b64_tr_b16 a[22:23], v7 offset:1920
    s_mov_b32 s35, 0x280000
    buffer_load_dwordx4 a[80:83], v5, s[16:19], s35 offen
    s_mov_b32 s35, 0x2a0000
    buffer_load_dwordx4 a[84:87], v5, s[16:19], s35 offen
    s_waitcnt vmcnt(14)
    ds_write_b128 v6, a[24:27] offset:3072
    ds_write_b128 v6, a[28:31] offset:4608
    ds_read_b64_tr_b16 a[24:25], v7 offset:3072
    ds_read_b64_tr_b16 a[26:27], v7 offset:3456
    ds_read_b64_tr_b16 a[28:29], v7 offset:4608
    ds_read_b64_tr_b16 a[30:31], v7 offset:4992
    s_mov_b32 s35, 0x2c0000
    buffer_load_dwordx4 a[88:91], v5, s[16:19], s35 offen
    s_mov_b32 s35, 0x2e0000
    buffer_load_dwordx4 a[92:95], v5, s[16:19], s35 offen
    s_waitcnt vmcnt(14)
    ds_write_b128 v6, a[32:35] offset:0
    ds_write_b128 v6, a[36:39] offset:1536
    ds_read_b64_tr_b16 a[32:33], v7 offset:0
    ds_read_b64_tr_b16 a[34:35], v7 offset:384
    ds_read_b64_tr_b16 a[36:37], v7 offset:1536
    ds_read_b64_tr_b16 a[38:39], v7 offset:1920
    s_mov_b32 s35, 0x300000
    buffer_load_dwordx4 a[96:99], v5, s[16:19], s35 offen
    s_mov_b32 s35, 0x320000
    buffer_load_dwordx4 a[100:103], v5, s[16:19], s35 offen
    s_waitcnt vmcnt(14)
    ds_write_b128 v6, a[40:43] offset:3072
    ds_write_b128 v6, a[44:47] offset:4608
    ds_read_b64_tr_b16 a[40:41], v7 offset:3072
    ds_read_b64_tr_b16 a[42:43], v7 offset:3456
    ds_read_b64_tr_b16 a[44:45], v7 offset:4608
    ds_read_b64_tr_b16 a[46:47], v7 offset:4992
    s_mov_b32 s35, 0x340000
    buffer_load_dwordx4 a[104:107], v5, s[16:19], s35 offen
    s_mov_b32 s35, 0x360000
    buffer_load_dwordx4 a[108:111], v5, s[16:19], s35 offen
    s_waitcnt vmcnt(14)
    ds_write_b128 v6, a[48:51] offset:0
    ds_write_b128 v6, a[52:55] offset:1536
    ds_read_b64_tr_b16 a[48:49], v7 offset:0
    ds_read_b64_tr_b16 a[50:51], v7 offset:384
    ds_read_b64_tr_b16 a[52:53], v7 offset:1536
    ds_read_b64_tr_b16 a[54:55], v7 offset:1920
    s_mov_b32 s35, 0x380000
    buffer_load_dwordx4 a[112:115], v5, s[16:19], s35 offen
    s_mov_b32 s35, 0x3a0000
    buffer_load_dwordx4 a[116:119], v5, s[16:19], s35 offen
    s_waitcnt vmcnt(14)
    ds_write_b128 v6, a[56:59] offset:3072
    ds_write_b128 v6, a[60:63] offset:4608
    ds_read_b64_tr_b16 a[56:57], v7 offset:3072
    ds_read_b64_tr_b16 a[58:59], v7 offset:3456
    ds_read_b64_tr_b16 a[60:61], v7 offset:4608
    ds_read_b64_tr_b16 a[62:63], v7 offset:4992
    s_mov_b32 s35, 0x3c0000
    buffer_load_dwordx4 a[120:123], v5, s[16:19], s35 offen
    s_mov_b32 s35, 0x3e0000
    buffer_load_dwordx4 a[124:127], v5, s[16:19], s35 offen
    s_waitcnt vmcnt(14)
    ds_write_b128 v6, a[64:67] offset:0
    ds_write_b128 v6, a[68:71] offset:1536
    ds_read_b64_tr_b16 a[64:65], v7 offset:0
    ds_read_b64_tr_b16 a[66:67], v7 offset:384
    ds_read_b64_tr_b16 a[68:69], v7 offset:1536
    ds_read_b64_tr_b16 a[70:71], v7 offset:1920
    s_waitcnt vmcnt(12)
    ds_write_b128 v6, a[72:75] offset:3072
    ds_write_b128 v6, a[76:79] offset:4608
    ds_read_b64_tr_b16 a[72:73], v7 offset:3072
    ds_read_b64_tr_b16 a[74:75], v7 offset:3456
    ds_read_b64_tr_b16 a[76:77], v7 offset:4608
    ds_read_b64_tr_b16 a[78:79], v7 offset:4992
    s_waitcnt vmcnt(10)
    ds_write_b128 v6, a[80:83] offset:0
    ds_write_b128 v6, a[84:87] offset:1536
    ds_read_b64_tr_b16 a[80:81], v7 offset:0
    ds_read_b64_tr_b16 a[82:83], v7 offset:384
    ds_read_b64_tr_b16 a[84:85], v7 offset:1536
    ds_read_b64_tr_b16 a[86:87], v7 offset:1920
    s_waitcnt vmcnt(8)
    ds_write_b128 v6, a[88:91] offset:3072
    ds_write_b128 v6, a[92:95] offset:4608
    ds_read_b64_tr_b16 a[88:89], v7 offset:3072
    ds_read_b64_tr_b16 a[90:91], v7 offset:3456
    ds_read_b64_tr_b16 a[92:93], v7 offset:4608
    ds_read_b64_tr_b16 a[94:95], v7 offset:4992
    s_waitcnt vmcnt(6)
    ds_write_b128 v6, a[96:99] offset:0
    ds_write_b128 v6, a[100:103] offset:1536
    ds_read_b64_tr_b16 a[96:97], v7 offset:0
    ds_read_b64_tr_b16 a[98:99], v7 offset:384
    ds_read_b64_tr_b16 a[100:101], v7 offset:1536
    ds_read_b64_tr_b16 a[102:103], v7 offset:1920
    s_waitcnt vmcnt(4)
    ds_write_b128 v6, a[104:107] offset:3072
    ds_write_b128 v6, a[108:111] offset:4608
    ds_read_b64_tr_b16 a[104:105], v7 offset:3072
    ds_read_b64_tr_b16 a[106:107], v7 offset:3456
    ds_read_b64_tr_b16 a[108:109], v7 offset:4608
    ds_read_b64_tr_b16 a[110:111], v7 offset:4992
    s_waitcnt vmcnt(2)
    ds_write_b128 v6, a[112:115] offset:0
    ds_write_b128 v6, a[116:119] offset:1536
    ds_read_b64_tr_b16 a[112:113], v7 offset:0
    ds_read_b64_tr_b16 a[114:115], v7 offset:384
    ds_read_b64_tr_b16 a[116:117], v7 offset:1536
    ds_read_b64_tr_b16 a[118:119], v7 offset:1920
    s_waitcnt vmcnt(0)
    ds_write_b128 v6, a[120:123] offset:3072
    ds_write_b128 v6, a[124:127] offset:4608
    ds_read_b64_tr_b16 a[120:121], v7 offset:3072
    ds_read_b64_tr_b16 a[122:123], v7 offset:3456
    ds_read_b64_tr_b16 a[124:125], v7 offset:4608
    ds_read_b64_tr_b16 a[126:127], v7 offset:4992
    s_waitcnt lgkmcnt(0)
    s_lshl_b32 s35, s32, 11
    s_add_u32 s35, s35, 73728
    v_bfe_u32 v14, v1, 5, 1
    v_mul_u32_u24 v14, 256, v14
    v_bfe_u32 v15, v1, 4, 1
    v_mul_u32_u24 v15, 64, v15
    v_add_u32 v14, v14, v15
    v_bfe_u32 v15, v1, 2, 2
    v_mul_u32_u24 v15, 16, v15
    v_add_u32 v14, v14, v15
    v_bfe_u32 v15, v1, 0, 1
    v_mul_u32_u24 v15, 8, v15
    v_add_u32 v14, v14, v15
    v_add_u32 v14, s35, v14
    v_add_u32 v5, s35, v2
    s_lshr_b32 s35, s32, 1
    s_lshl_b32 s35, s35, 10
    v_bfe_u32 v6, v1, 0, 4
    v_mul_u32_u24 v6, 16, v6
    v_bfe_u32 v15, v1, 4, 1
    v_mul_u32_u24 v15, 8, v15
    v_add_u32 v6, v6, v15
    v_add_u32 v6, 0x800, v6
    v_add_u32 v6, s35, v6
    s_and_b32 s36, s32, 1
    s_lshl_b32 s36, s36, 12
    s_lshl_b32 s35, s35, 1
    s_add_u32 s35, s35, s36
    v_add_u32 v7, s35, v2
    s_and_b32 s36, s32, 1
    s_lshl_b32 s36, s36, 4
    v_and_b32 v12, 15, v1
    v_lshrrev_b32 v13, 4, v1
    v_lshlrev_b32 v13, 2, v13
    v_sub_u32 v12, v12, v13
    v_add_u32 v12, s36, v12
    v_cmp_le_i32 s[16:17], 0, v12
    v_cmp_le_i32 s[18:19], 1, v12
    v_cmp_le_i32 s[20:21], 2, v12
    v_cmp_le_i32 s[22:23], 3, v12
    v_cmp_le_i32 s[24:25], 16, v12
    v_cmp_le_i32 s[26:27], 17, v12
    v_cmp_le_i32 s[28:29], 18, v12
    v_cmp_le_i32 s[30:31], 19, v12
    s_mov_b32 s54, -1
    s_mov_b32 s55, 0
    s_mov_b32 s56, 0x3e0293ee
    s_mov_b32 s57, 0xbe0293ee
    s_add_u32 s47, s46, 5
    s_lshl_b32 s35, s47, 15
    s_lshl_b32 s36, s32, 13
    s_add_u32 s35, s35, s36
    buffer_load_dwordx4 v[16:19], v2, s[12:15], s35 offen offset:0
    buffer_load_dwordx4 v[20:23], v2, s[12:15], s35 offen offset:1024
    buffer_load_dwordx4 v[24:27], v2, s[12:15], s35 offen offset:2048
    buffer_load_dwordx4 v[28:31], v2, s[12:15], s35 offen offset:3072
    s_add_u32 s35, s35, 4096
    buffer_load_dwordx4 v[32:35], v2, s[12:15], s35 offen offset:0
    buffer_load_dwordx4 v[36:39], v2, s[12:15], s35 offen offset:1024
    buffer_load_dwordx4 v[40:43], v2, s[12:15], s35 offen offset:2048
    buffer_load_dwordx4 v[44:47], v2, s[12:15], s35 offen offset:3072
    ds_read_b128 v[48:51], v4 offset:0
    ds_read_b128 v[52:55], v4 offset:1056
    ds_read_b128 v[56:59], v4 offset:2112
    ds_read_b128 v[60:63], v4 offset:3168
    s_waitcnt lgkmcnt(3)
    v_mfma_f32_32x32x16_bf16 v[64:79], a[0:3], v[48:51], 0
    ds_read_b128 v[48:51], v4 offset:4224
    s_waitcnt lgkmcnt(3)
    v_mfma_f32_32x32x16_bf16 v[64:79], a[4:7], v[52:55], v[64:79]
    ds_read_b128 v[52:55], v4 offset:5280
    s_waitcnt lgkmcnt(3)
    v_mfma_f32_32x32x16_bf16 v[64:79], a[8:11], v[56:59], v[64:79]
    ds_read_b128 v[56:59], v4 offset:6336
    s_waitcnt lgkmcnt(3)
    v_mfma_f32_32x32x16_bf16 v[64:79], a[12:15], v[60:63], v[64:79]
    ds_read_b128 v[60:63], v4 offset:7392
    s_waitcnt lgkmcnt(3)
    v_mfma_f32_32x32x16_bf16 v[64:79], a[16:19], v[48:51], v[64:79]
    ds_read_b128 v[48:51], v4 offset:8448
    s_waitcnt lgkmcnt(3)
    v_mfma_f32_32x32x16_bf16 v[64:79], a[20:23], v[52:55], v[64:79]
    ds_read_b128 v[52:55], v4 offset:9504
    s_waitcnt lgkmcnt(3)
    v_mfma_f32_32x32x16_bf16 v[64:79], a[24:27], v[56:59], v[64:79]
    ds_read_b128 v[56:59], v4 offset:10560
    s_waitcnt lgkmcnt(3)
    v_mfma_f32_32x32x16_bf16 v[64:79], a[28:31], v[60:63], v[64:79]
    ds_read_b128 v[60:63], v4 offset:11616
    s_waitcnt lgkmcnt(3)
    v_mfma_f32_32x32x16_bf16 v[64:79], a[32:35], v[48:51], v[64:79]
    ds_read_b128 v[48:51], v4 offset:12672
    s_waitcnt lgkmcnt(3)
    v_mfma_f32_32x32x16_bf16 v[64:79], a[36:39], v[52:55], v[64:79]
    s_waitcnt vmcnt(0)
    ds_write_b128 v3, v[16:19] offset:0
    ds_write_b128 v3, v[20:23] offset:16
    ds_write_b128 v3, v[24:27] offset:32
    ds_write_b128 v3, v[28:31] offset:48
    ds_write_b128 v3, v[32:35] offset:64
    ds_write_b128 v3, v[36:39] offset:80
    ds_write_b128 v3, v[40:43] offset:96
    ds_write_b128 v3, v[44:47] offset:112
    s_waitcnt lgkmcnt(0)
    ds_read_b128 v[52:55], v4 offset:13728
    s_waitcnt lgkmcnt(3)
    v_mfma_f32_32x32x16_bf16 v[64:79], a[40:43], v[56:59], v[64:79]
    ds_read_b128 v[56:59], v4 offset:14784
    s_waitcnt lgkmcnt(3)
    v_mfma_f32_32x32x16_bf16 v[64:79], a[44:47], v[60:63], v[64:79]
    ds_read_b128 v[60:63], v4 offset:15840
    s_waitcnt lgkmcnt(3)
    v_mfma_f32_32x32x16_bf16 v[64:79], a[48:51], v[48:51], v[64:79]
    ds_read_b128 v[48:51], v4 offset:16896
    s_waitcnt lgkmcnt(3)
    v_mfma_f32_32x32x16_bf16 v[64:79], a[52:55], v[52:55], v[64:79]
    ds_read_b128 v[52:55], v4 offset:17952
    s_waitcnt lgkmcnt(3)
    v_mfma_f32_32x32x16_bf16 v[64:79], a[56:59], v[56:59], v[64:79]
    ds_read_b128 v[56:59], v4 offset:19008
    s_waitcnt lgkmcnt(3)
    v_mfma_f32_32x32x16_bf16 v[64:79], a[60:63], v[60:63], v[64:79]
    ds_read_b128 v[60:63], v4 offset:20064
    s_waitcnt lgkmcnt(3)
    v_mfma_f32_32x32x16_bf16 v[64:79], a[64:67], v[48:51], v[64:79]
    ds_read_b128 v[48:51], v4 offset:21120
    s_waitcnt lgkmcnt(3)
    v_mfma_f32_32x32x16_bf16 v[64:79], a[68:71], v[52:55], v[64:79]
    ds_read_b128 v[52:55], v4 offset:22176
    s_waitcnt lgkmcnt(3)
    v_mfma_f32_32x32x16_bf16 v[64:79], a[72:75], v[56:59], v[64:79]
    ds_read_b128 v[56:59], v4 offset:23232
    s_waitcnt lgkmcnt(3)
    v_mfma_f32_32x32x16_bf16 v[64:79], a[76:79], v[60:63], v[64:79]
    ds_read_b128 v[60:63], v4 offset:24288
    s_waitcnt lgkmcnt(3)
    v_mfma_f32_32x32x16_bf16 v[64:79], a[80:83], v[48:51], v[64:79]
    ds_read_b128 v[48:51], v4 offset:25344
    s_waitcnt lgkmcnt(3)
    v_mfma_f32_32x32x16_bf16 v[64:79], a[84:87], v[52:55], v[64:79]
    ds_read_b128 v[52:55], v4 offset:26400
    s_waitcnt lgkmcnt(3)
    v_mfma_f32_32x32x16_bf16 v[64:79], a[88:91], v[56:59], v[64:79]
    ds_read_b128 v[56:59], v4 offset:27456
    s_waitcnt lgkmcnt(3)
    v_mfma_f32_32x32x16_bf16 v[64:79], a[92:95], v[60:63], v[64:79]
    ds_read_b128 v[60:63], v4 offset:28512
    s_waitcnt lgkmcnt(3)
    v_mfma_f32_32x32x16_bf16 v[64:79], a[96:99], v[48:51], v[64:79]
    ds_read_b128 v[48:51], v4 offset:29568
    s_waitcnt lgkmcnt(3)
    v_mfma_f32_32x32x16_bf16 v[64:79], a[100:103], v[52:55], v[64:79]
    ds_read_b128 v[52:55], v4 offset:30624
    s_waitcnt lgkmcnt(3)
    v_mfma_f32_32x32x16_bf16 v[64:79], a[104:107], v[56:59], v[64:79]
    ds_read_b128 v[56:59], v4 offset:31680
    s_waitcnt lgkmcnt(3)
    v_mfma_f32_32x32x16_bf16 v[64:79], a[108:111], v[60:63], v[64:79]
    ds_read_b128 v[60:63], v4 offset:32736
    s_waitcnt lgkmcnt(3)
    v_mfma_f32_32x32x16_bf16 v[64:79], a[112:115], v[48:51], v[64:79]
    s_waitcnt lgkmcnt(2)
    v_mfma_f32_32x32x16_bf16 v[64:79], a[116:119], v[52:55], v[64:79]
    s_waitcnt lgkmcnt(1)
    v_mfma_f32_32x32x16_bf16 v[64:79], a[120:123], v[56:59], v[64:79]
    s_waitcnt lgkmcnt(0)
    v_mfma_f32_32x32x16_bf16 v[64:79], a[124:127], v[60:63], v[64:79]
    s_nop 11
    v_cvt_pk_bf16_f32 v48, v64, v65
    v_cvt_pk_bf16_f32 v49, v66, v67
    v_cvt_pk_bf16_f32 v50, v68, v69
    v_cvt_pk_bf16_f32 v51, v70, v71
    v_cvt_pk_bf16_f32 v52, v72, v73
    v_cvt_pk_bf16_f32 v53, v74, v75
    v_cvt_pk_bf16_f32 v54, v76, v77
    v_cvt_pk_bf16_f32 v55, v78, v79
    s_add_u32 s35, s49, 0x3000000
    buffer_store_dwordx4 v[48:51], v8, s[4:7], s35 offen offset:0 sc1
    buffer_store_dwordx4 v[52:55], v8, s[4:7], s35 offen offset:512 sc1
    v_add_u32 v4, s48, v4
    s_sub_u32 s48, 0, s48
    v_add_u32 v3, s48, v3
    s_waitcnt vmcnt(0) lgkmcnt(0)
    s_barrier
    s_mov_b32 s52, s46
    s_mov_b32 s46, s47
L_hq_loop_5:
    s_add_u32 s47, s46, 5
    s_cmp_ge_u32 s46, 64
    s_cbranch_scc1 L_hq_noq_6
    s_lshl_b32 s35, s47, 15
    s_lshl_b32 s36, s32, 13
    s_add_u32 s35, s35, s36
    buffer_load_dwordx4 v[16:19], v2, s[12:15], s35 offen offset:0
    buffer_load_dwordx4 v[20:23], v2, s[12:15], s35 offen offset:1024
    buffer_load_dwordx4 v[24:27], v2, s[12:15], s35 offen offset:2048
    buffer_load_dwordx4 v[28:31], v2, s[12:15], s35 offen offset:3072
    s_add_u32 s35, s35, 4096
    buffer_load_dwordx4 v[32:35], v2, s[12:15], s35 offen offset:0
    buffer_load_dwordx4 v[36:39], v2, s[12:15], s35 offen offset:1024
    buffer_load_dwordx4 v[40:43], v2, s[12:15], s35 offen offset:2048
    buffer_load_dwordx4 v[44:47], v2, s[12:15], s35 offen offset:3072
    ds_read_b128 v[48:51], v4 offset:0
    ds_read_b128 v[52:55], v4 offset:1056
    ds_read_b128 v[56:59], v4 offset:2112
    ds_read_b128 v[60:63], v4 offset:3168
    s_waitcnt lgkmcnt(3)
    v_mfma_f32_32x32x16_bf16 v[80:95], a[128:131], v[48:51], 0
    v_mfma_f32_32x32x16_bf16 v[96:111], v[48:51], v[128:131], 0
    v_mfma_f32_32x32x16_bf16 v[64:79], a[0:3], v[48:51], 0
    ds_read_b128 v[48:51], v4 offset:4224
    s_waitcnt lgkmcnt(3)
    v_mfma_f32_32x32x16_bf16 v[80:95], a[132:135], v[52:55], v[80:95]
    v_mfma_f32_32x32x16_bf16 v[96:111], v[52:55], v[132:135], v[96:111]
    v_mfma_f32_32x32x16_bf16 v[64:79], a[4:7], v[52:55], v[64:79]
    ds_read_b128 v[52:55], v4 offset:5280
    s_waitcnt lgkmcnt(3)
    v_mfma_f32_32x32x16_bf16 v[80:95], a[136:139], v[56:59], v[80:95]
    v_mfma_f32_32x32x16_bf16 v[96:111], v[56:59], v[136:139], v[96:111]
    v_mfma_f32_32x32x16_bf16 v[64:79], a[8:11], v[56:59], v[64:79]
    ds_read_b128 v[56:59], v4 offset:6336
    s_waitcnt lgkmcnt(3)
    v_mfma_f32_32x32x16_bf16 v[80:95], a[140:143], v[60:63], v[80:95]
    v_mfma_f32_32x32x16_bf16 v[96:111], v[60:63], v[140:143], v[96:111]
    v_mfma_f32_32x32x16_bf16 v[64:79], a[12:15], v[60:63], v[64:79]
    ds_read_b128 v[60:63], v4 offset:7392
    s_waitcnt lgkmcnt(3)
    v_mfma_f32_32x32x16_bf16 v[80:95], a[144:147], v[48:51], v[80:95]
    v_mfma_f32_32x32x16_bf16 v[96:111], v[48:51], v[144:147], v[96:111]
    v_mfma_f32_32x32x16_bf16 v[64:79], a[16:19], v[48:51], v[64:79]
    ds_read_b128 v[48:51], v4 offset:8448
    s_waitcnt lgkmcnt(3)
    v_mfma_f32_32x32x16_bf16 v[80:95], a[148:151], v[52:55], v[80:95]
    v_mfma_f32_32x32x16_bf16 v[96:111], v[52:55], v[148:151], v[96:111]
    v_mfma_f32_32x32x16_bf16 v[64:79], a[20:23], v[52:55], v[64:79]
    ds_read_b128 v[52:55], v4 offset:9504
    s_waitcnt lgkmcnt(3)
    v_mfma_f32_32x32x16_bf16 v[80:95], a[152:155], v[56:59], v[80:95]
    v_mfma_f32_32x32x16_bf16 v[96:111], v[56:59], v[152:155], v[96:111]
    v_mfma_f32_32x32x16_bf16 v[64:79], a[24:27], v[56:59], v[64:79]
    ds_read_b128 v[56:59], v4 offset:10560
    s_waitcnt lgkmcnt(3)
    v_mfma_f32_32x32x16_bf16 v[80:95], a[156:159], v[60:63], v[80:95]
    v_mfma_f32_32x32x16_bf16 v[96:111], v[60:63], v[156:159], v[96:111]
    v_mfma_f32_32x32x16_bf16 v[64:79], a[28:31], v[60:63], v[64:79]
    ds_read_b128 v[60:63], v4 offset:11616
    s_waitcnt lgkmcnt(3)
    v_mfma_f32_32x32x16_bf16 v[80:95], a[160:163], v[48:51], v[80:95]
    v_mfma_f32_32x32x16_bf16 v[96:111], v[48:51], v[160:163], v[96:111]
    v_mfma_f32_32x32x16_bf16 v[64:79], a[32:35], v[48:51], v[64:79]
    ds_read_b128 v[48:51], v4 offset:12672
    s_waitcnt lgkmcnt(3)
    v_mfma_f32_32x32x16_bf16 v[80:95], a[164:167], v[52:55], v[80:95]
    v_mfma_f32_32x32x16_bf16 v[96:111], v[52:55], v[164:167], v[96:111]
    v_mfma_f32_32x32x16_bf16 v[64:79], a[36:39], v[52:55], v[64:79]
    s_waitcnt vmcnt(0)
    ds_write_b128 v3, v[16:19] offset:0
    ds_write_b128 v3, v[20:23] offset:16
    ds_write_b128 v3, v[24:27] offset:32
    ds_write_b128 v3, v[28:31] offset:48
    ds_write_b128 v3, v[32:35] offset:64
    ds_write_b128 v3, v[36:39] offset:80
    ds_write_b128 v3, v[40:43] offset:96
    ds_write_b128 v3, v[44:47] offset:112
    s_waitcnt lgkmcnt(0)
    ds_read_b128 v[52:55], v4 offset:13728
    s_waitcnt lgkmcnt(3)
    v_mfma_f32_32x32x16_bf16 v[80:95], a[168:171], v[56:59], v[80:95]
    v_mfma_f32_32x32x16_bf16 v[96:111], v[56:59], v[168:171], v[96:111]
    v_mfma_f32_32x32x16_bf16 v[64:79], a[40:43], v[56:59], v[64:79]
    ds_read_b128 v[56:59], v4 offset:14784
    s_waitcnt lgkmcnt(3)
    v_mfma_f32_32x32x16_bf16 v[80:95], a[172:175], v[60:63], v[80:95]
    v_mfma_f32_32x32x16_bf16 v[96:111], v[60:63], v[172:175], v[96:111]
    v_mfma_f32_32x32x16_bf16 v[64:79], a[44:47], v[60:63], v[64:79]
    ds_read_b128 v[60:63], v4 offset:15840
    s_waitcnt lgkmcnt(3)
    v_mfma_f32_32x32x16_bf16 v[80:95], a[176:179], v[48:51], v[80:95]
    v_mfma_f32_32x32x16_bf16 v[96:111], v[48:51], v[176:179], v[96:111]
    v_mfma_f32_32x32x16_bf16 v[64:79], a[48:51], v[48:51], v[64:79]
    ds_read_b128 v[48:51], v4 offset:16896
    s_waitcnt lgkmcnt(3)
    v_mfma_f32_32x32x16_bf16 v[80:95], a[180:183], v[52:55], v[80:95]
    v_mfma_f32_32x32x16_bf16 v[96:111], v[52:55], v[180:183], v[96:111]
    v_mfma_f32_32x32x16_bf16 v[64:79], a[52:55], v[52:55], v[64:79]
    ds_read_b128 v[52:55], v4 offset:17952
    s_waitcnt lgkmcnt(3)
    v_mfma_f32_32x32x16_bf16 v[80:95], a[184:187], v[56:59], v[80:95]
    v_mfma_f32_32x32x16_bf16 v[96:111], v[56:59], v[184:187], v[96:111]
    v_mfma_f32_32x32x16_bf16 v[64:79], a[56:59], v[56:59], v[64:79]
    ds_read_b128 v[56:59], v4 offset:19008
    s_waitcnt lgkmcnt(3)
    v_mfma_f32_32x32x16_bf16 v[80:95], a[188:191], v[60:63], v[80:95]
    v_mfma_f32_32x32x16_bf16 v[96:111], v[60:63], v[188:191], v[96:111]
    v_mfma_f32_32x32x16_bf16 v[64:79], a[60:63], v[60:63], v[64:79]
    ds_read_b128 v[60:63], v4 offset:20064
    s_waitcnt lgkmcnt(3)
    v_mfma_f32_32x32x16_bf16 v[80:95], a[192:195], v[48:51], v[80:95]
    v_mfma_f32_32x32x16_bf16 v[96:111], v[48:51], v[192:195], v[96:111]
    v_mfma_f32_32x32x16_bf16 v[64:79], a[64:67], v[48:51], v[64:79]
    ds_read_b128 v[48:51], v4 offset:21120
    s_waitcnt lgkmcnt(3)
    v_mfma_f32_32x32x16_bf16 v[80:95], a[196:199], v[52:55], v[80:95]
    v_mfma_f32_32x32x16_bf16 v[96:111], v[52:55], v[196:199], v[96:111]
    v_mfma_f32_32x32x16_bf16 v[64:79], a[68:71], v[52:55], v[64:79]
    ds_read_b128 v[52:55], v4 offset:22176
    s_waitcnt lgkmcnt(3)
    v_mfma_f32_32x32x16_bf16 v[80:95], a[200:203], v[56:59], v[80:95]
    v_mfma_f32_32x32x16_bf16 v[96:111], v[56:59], v[200:203], v[96:111]
    v_mfma_f32_32x32x16_bf16 v[64:79], a[72:75], v[56:59], v[64:79]
    ds_read_b128 v[56:59], v4 offset:23232
    s_waitcnt lgkmcnt(3)
    v_mfma_f32_32x32x16_bf16 v[80:95], a[204:207], v[60:63], v[80:95]
    v_mfma_f32_32x32x16_bf16 v[96:111], v[60:63], v[204:207], v[96:111]
    v_mfma_f32_32x32x16_bf16 v[64:79], a[76:79], v[60:63], v[64:79]
    ds_read_b128 v[60:63], v4 offset:24288
    s_waitcnt lgkmcnt(3)
    v_mfma_f32_32x32x16_bf16 v[80:95], a[208:211], v[48:51], v[80:95]
    v_mfma_f32_32x32x16_bf16 v[96:111], v[48:51], v[208:211], v[96:111]
    v_mfma_f32_32x32x16_bf16 v[64:79], a[80:83], v[48:51], v[64:79]
    ds_read_b128 v[48:51], v4 offset:25344
    s_waitcnt lgkmcnt(3)
    v_mfma_f32_32x32x16_bf16 v[80:95], a[212:215], v[52:55], v[80:95]
    v_mfma_f32_32x32x16_bf16 v[96:111], v[52:55], v[212:215], v[96:111]
    v_mfma_f32_32x32x16_bf16 v[64:79], a[84:87], v[52:55], v[64:79]
    ds_read_b128 v[52:55], v4 offset:26400
    s_waitcnt lgkmcnt(3)
    v_mfma_f32_32x32x16_bf16 v[80:95], a[216:219], v[56:59], v[80:95]
    v_mfma_f32_32x32x16_bf16 v[96:111], v[56:59], v[216:219], v[96:111]
    v_mfma_f32_32x32x16_bf16 v[64:79], a[88:91], v[56:59], v[64:79]
    ds_read_b128 v[56:59], v4 offset:27456
    s_waitcnt lgkmcnt(3)
    v_mfma_f32_32x32x16_bf16 v[80:95], a[220:223], v[60:63], v[80:95]
    v_mfma_f32_32x32x16_bf16 v[96:111], v[60:63], v[220:223], v[96:111]
    v_mfma_f32_32x32x16_bf16 v[64:79], a[92:95], v[60:63], v[64:79]
    ds_read_b128 v[60:63], v4 offset:28512
    s_waitcnt lgkmcnt(3)
    v_mfma_f32_32x32x16_bf16 v[80:95], a[224:227], v[48:51], v[80:95]
    v_mfma_f32_32x32x16_bf16 v[96:111], v[48:51], v[224:227], v[96:111]
    v_mfma_f32_32x32x16_bf16 v[64:79], a[96:99], v[48:51], v[64:79]
    ds_read_b128 v[48:51], v4 offset:29568
    s_waitcnt lgkmcnt(3)
    v_mfma_f32_32x32x16_bf16 v[80:95], a[228:231], v[52:55], v[80:95]
    v_mfma_f32_32x32x16_bf16 v[96:111], v[52:55], v[228:231], v[96:111]
    v_mfma_f32_32x32x16_bf16 v[64:79], a[100:103], v[52:55], v[64:79]
    ds_read_b128 v[52:55], v4 offset:30624
    s_waitcnt lgkmcnt(3)
    v_mfma_f32_32x32x16_bf16 v[80:95], a[232:235], v[56:59], v[80:95]
    v_mfma_f32_32x32x16_bf16 v[96:111], v[56:59], v[232:235], v[96:111]
    v_mfma_f32_32x32x16_bf16 v[64:79], a[104:107], v[56:59], v[64:79]
    ds_read_b128 v[56:59], v4 offset:31680
    s_waitcnt lgkmcnt(3)
    v_mfma_f32_32x32x16_bf16 v[80:95], a[236:239], v[60:63], v[80:95]
    v_mfma_f32_32x32x16_bf16 v[96:111], v[60:63], v[236:239], v[96:111]
    v_mfma_f32_32x32x16_bf16 v[64:79], a[108:111], v[60:63], v[64:79]
    ds_read_b128 v[60:63], v4 offset:32736
    s_waitcnt lgkmcnt(3)
    v_mfma_f32_32x32x16_bf16 v[80:95], a[240:243], v[48:51], v[80:95]
    v_mfma_f32_32x32x16_bf16 v[96:111], v[48:51], v[240:243], v[96:111]
    v_mfma_f32_32x32x16_bf16 v[64:79], a[112:115], v[48:51], v[64:79]
    s_waitcnt lgkmcnt(2)
    v_mfma_f32_32x32x16_bf16 v[80:95], a[244:247], v[52:55], v[80:95]
    v_mfma_f32_32x32x16_bf16 v[96:111], v[52:55], v[244:247], v[96:111]
    v_mfma_f32_32x32x16_bf16 v[64:79], a[116:119], v[52:55], v[64:79]
    s_waitcnt lgkmcnt(1)
    v_mfma_f32_32x32x16_bf16 v[80:95], a[248:251], v[56:59], v[80:95]
    v_mfma_f32_32x32x16_bf16 v[96:111], v[56:59], v[248:251], v[96:111]
    v_mfma_f32_32x32x16_bf16 v[64:79], a[120:123], v[56:59], v[64:79]
    s_waitcnt lgkmcnt(0)
    v_mfma_f32_32x32x16_bf16 v[80:95], a[252:255], v[60:63], v[80:95]
    v_mfma_f32_32x32x16_bf16 v[96:111], v[60:63], v[252:255], v[96:111]
    v_mfma_f32_32x32x16_bf16 v[64:79], a[124:127], v[60:63], v[64:79]
    s_nop 11
    s_lshl_b32 s49, s46, 5
    s_add_u32 s49, s49, s44
    s_lshl_b32 s50, s49, 14
    s_lshl_b32 s51, s49, 12
    s_lshl_b32 s49, s49, 13
    v_cvt_pk_bf16_f32 v112, v80, v81
    v_cvt_pk_bf16_f32 v113, v82, v83
    v_cvt_pk_bf16_f32 v114, v84, v85
    v_cvt_pk_bf16_f32 v115, v86, v87
    v_cvt_pk_bf16_f32 v116, v88, v89
    v_cvt_pk_bf16_f32 v117, v90, v91
    v_cvt_pk_bf16_f32 v118, v92, v93
    v_cvt_pk_bf16_f32 v119, v94, v95
    s_add_u32 s35, s50, 0x1000000
    buffer_store_dwordx4 v[112:115], v8, s[4:7], s35 offen offset:0 sc1
    buffer_store_dwordx4 v[116:119], v8, s[4:7], s35 offen offset:512 sc1
    v_cvt_pk_bf16_f32 v120, v96, v97
    v_cvt_pk_bf16_f32 v121, v98, v99
    v_cvt_pk_bf16_f32 v122, v104, v105
    v_cvt_pk_bf16_f32 v123, v106, v107
    v_cvt_pk_bf16_f32 v124, v100, v101
    v_cvt_pk_bf16_f32 v125, v102, v103
    v_cvt_pk_bf16_f32 v126, v108, v109
    v_cvt_pk_bf16_f32 v127, v110, v111
    s_add_u32 s35, s50, 0x1002000
    buffer_store_dwordx4 v[120:123], v9, s[4:7], s35 offen offset:0 sc1
    buffer_store_dwordx4 v[124:127], v9, s[4:7], s35 offen offset:512 sc1
    v_cvt_pk_bf16_f32 v48, v64, v65
    v_cvt_pk_bf16_f32 v49, v66, v67
    v_cvt_pk_bf16_f32 v50, v68, v69
    v_cvt_pk_bf16_f32 v51, v70, v71
    v_cvt_pk_bf16_f32 v52, v72, v73
    v_cvt_pk_bf16_f32 v53, v74, v75
    v_cvt_pk_bf16_f32 v54, v76, v77
    v_cvt_pk_bf16_f32 v55, v78, v79
    s_add_u32 s35, s49, 0x3000000
    buffer_store_dwordx4 v[48:51], v8, s[4:7], s35 offen offset:0 sc1
    buffer_store_dwordx4 v[52:55], v8, s[4:7], s35 offen offset:512 sc1
    v_mov_b32 v56, -1
    v_mov_b32 v57, -1
    v_mov_b32 v58, -1
    v_mov_b32 v59, -1
    s_lshl_b32 s36, s32, 10
    s_add_u32 s35, s51, s36
    s_add_u32 s35, s35, 0x200000
    buffer_store_dwordx4 v[56:59], v2, s[4:7], s35 offen sc1
    s_cmp_lg_u32 s53, 1
    s_cbranch_scc1 L_hq_pf_8
    s_cmp_gt_u32 s45, 3
    s_cbranch_scc1 L_hq_pf_8
    v_mov_b32 v60, 0
    v_mov_b32 v61, 0
    v_mov_b32 v62, 0
    v_mov_b32 v63, 0
    s_lshl_b32 s35, s45, 18
    s_lshl_b32 s36, s44, 13
    s_add_u32 s35, s35, s36
    s_lshl_b32 s36, s32, 11
    s_add_u32 s35, s35, s36
    s_add_u32 s35, s35, 0xa00000
    buffer_store_dwordx4 v[60:63], v2, s[4:7], s35 offen offset:0 sc1
    buffer_store_dwordx4 v[60:63], v2, s[4:7], s35 offen offset:1024 sc1
L_hq_pf_8:
    v_add_u32 v4, s48, v4
    s_sub_u32 s48, 0, s48
    v_add_u32 v3, s48, v3
    s_waitcnt vmcnt(0) lgkmcnt(0)
    s_barrier
    s_add_u32 s53, s53, 1
    s_cmp_lg_u32 s32, 0
    s_cbranch_scc1 L_hq_noflag_7
    v_mov_b32 v11, s53
    s_mov_b64 exec, 1
    buffer_store_dword v11, off, s[4:7], s60 sc1
    s_mov_b64 exec, -1
L_hq_noflag_7:
L_hq_noq_6:
    s_lshl_b32 s37, s52, 5
    s_add_u32 s37, s37, s44
    s_lshl_b32 s38, s37, 13
    s_lshl_b32 s40, s37, 14
    s_add_u32 s39, s40, 0x1000000
    buffer_load_dwordx4 v[16:19], v2, s[4:7], s39 offen offset:0
    buffer_load_dwordx4 v[20:23], v2, s[4:7], s39 offen offset:1024
    buffer_load_dwordx4 v[24:27], v2, s[4:7], s39 offen offset:2048
    buffer_load_dwordx4 v[28:31], v2, s[4:7], s39 offen offset:3072
    s_add_u32 s39, s39, 4096
    buffer_load_dwordx4 v[32:35], v2, s[4:7], s39 offen offset:0
    buffer_load_dwordx4 v[36:39], v2, s[4:7], s39 offen offset:1024
    buffer_load_dwordx4 v[40:43], v2, s[4:7], s39 offen offset:2048
    buffer_load_dwordx4 v[44:47], v2, s[4:7], s39 offen offset:3072
    s_and_b32 s39, s32, 1
    s_lshl_b32 s39, s39, 12
    s_add_u32 s39, s39, s38
    s_add_u32 s39, s39, 0x3000000
    buffer_load_dwordx4 v[48:51], v2, s[4:7], s39 offen offset:0
    buffer_load_dwordx4 v[52:55], v2, s[4:7], s39 offen offset:1024
    buffer_load_dwordx4 v[56:59], v2, s[4:7], s39 offen offset:2048
    buffer_load_dwordx4 v[60:63], v2, s[4:7], s39 offen offset:3072
    s_lshr_b32 s39, s32, 1
    s_lshl_b32 s39, s39, 12
    s_add_u32 s39, s39, s40
    s_add_u32 s39, s39, 0x1002000
    buffer_load_dwordx4 v[64:67], v2, s[4:7], s39 offen offset:0
    buffer_load_dwordx4 v[68:71], v2, s[4:7], s39 offen offset:1024
    buffer_load_dwordx4 v[72:75], v2, s[4:7], s39 offen offset:2048
    buffer_load_dwordx4 v[76:79], v2, s[4:7], s39 offen offset:3072
    v_mov_b32 v120, 0x3f803f80
    v_mov_b32 v121, 0x3f803f80
    v_mov_b32 v122, 0x3f803f80
    v_mov_b32 v123, 0x3f803f80
    v_mov_b32 v126, 0
    v_mov_b32 v127, 0
    v_mov_b32 v104, 0
    v_mov_b32 v105, 0
    s_lshl_b32 s58, s37, 12
    s_add_u32 s58, s58, 0x200000
    s_cmp_lg_u32 s32, 0
    s_cbranch_scc1 L_xw_9
    s_cmp_lg_u32 s41, 0
    s_cbranch_scc1 L_xw_9
    s_mov_b32 s59, 0
    s_add_u32 s39, s58, 4092
    s_sub_u32 s35, s39, 0x20000
    s_cmp_ge_u32 s52, 62
    s_cselect_b32 s39, s35, s39
L_xp_10:
    buffer_load_dword v11, off, s[4:7], s39 sc1
    s_waitcnt vmcnt(0)
    v_readfirstlane_b32 s35, v11
    s_cmp_lg_u32 s35, -1
    s_cbranch_scc1 L_xw_9
    s_sleep 4
    s_add_u32 s59, s59, 1
    s_cmp_lt_u32 s59, 131072
    s_cbranch_scc1 L_xp_10
    s_mov_b32 s41, 1
L_xw_9:
    s_barrier
    s_mov_b32 s59, 0
L_xr_11:
    buffer_load_dwordx4 v[80:83], v2, s[4:7], s58 offen sc1
    buffer_load_dwordx4 v[84:87], v2, s[4:7], s58 offen offset:1024 sc1
    buffer_load_dwordx2 v[96:97], v6, s[4:7], s58 offen offset:0 sc1
    buffer_load_dwordx2 v[98:99], v6, s[4:7], s58 offen offset:256 sc1
    buffer_load_dwordx2 v[100:101], v6, s[4:7], s58 offen offset:512 sc1
    buffer_load_dwordx2 v[102:103], v6, s[4:7], s58 offen offset:768 sc1
    s_waitcnt vmcnt(4)
    v_max3_u32 v88, v80, v81, v82
    v_max3_u32 v89, v83, v84, v85
    v_max3_u32 v88, v88, v86, v87
    s_waitcnt vmcnt(0)
    v_max3_u32 v90, v96, v97, v98
    v_max3_u32 v91, v99, v100, v101
    v_max3_u32 v90, v90, v102, v103
    v_max3_u32 v88, v88, v89, v90
    v_max_u32 v88, v88, v91
    v_cmp_eq_u32 vcc, -1, v88
    s_add_u32 s59, s59, 1
    s_nop 0
    s_cbranch_vccz L_xk_12
    s_cmp_lg_u32 s41, 0
    s_cbranch_scc1 L_xk_12
    s_sleep 0
    s_cmp_lt_u32 s59, 131072
    s_cbranch_scc1 L_xr_11
    s_mov_b32 s41, 1
L_xk_12:
    ds_write_b128 v5, v[80:83]
    ds_write_b128 v5, v[84:87] offset:1024
    ds_read_b64_tr_b16 v[80:81], v14 offset:0
    ds_read_b64_tr_b16 v[82:83], v14 offset:128
    ds_read_b64_tr_b16 v[84:85], v14 offset:512
    ds_read_b64_tr_b16 v[86:87], v14 offset:640
    ds_read_b64_tr_b16 v[88:89], v14 offset:1024
    ds_read_b64_tr_b16 v[90:91], v14 offset:1152
    ds_read_b64_tr_b16 v[92:93], v14 offset:1536
    ds_read_b64_tr_b16 v[94:95], v14 offset:1664
    v_mfma_f32_16x16x32_bf16 v[108:111], v[16:19], v[48:51], 0
    v_mfma_f32_16x16x32_bf16 v[112:115], v[32:35], v[48:51], 0
    v_mfma_f32_16x16x32_bf16 v[108:111], v[20:23], v[52:55], v[108:111]
    v_mfma_f32_16x16x32_bf16 v[112:115], v[36:39], v[52:55], v[112:115]
    v_mfma_f32_16x16x32_bf16 v[108:111], v[24:27], v[56:59], v[108:111]
    v_mfma_f32_16x16x32_bf16 v[112:115], v[40:43], v[56:59], v[112:115]
    v_mfma_f32_16x16x32_bf16 v[108:111], v[28:31], v[60:63], v[108:111]
    v_mfma_f32_16x16x32_bf16 v[112:115], v[44:47], v[60:63], v[112:115]
    s_waitcnt lgkmcnt(0)
    v_mfma_f32_16x16x32_bf16 v[116:119], v[80:83], v[48:51], 0
    v_mfma_f32_16x16x32_bf16 v[116:119], v[84:87], v[52:55], v[116:119]
    v_mfma_f32_16x16x32_bf16 v[116:119], v[88:91], v[56:59], v[116:119]
    v_mfma_f32_16x16x32_bf16 v[116:119], v[92:95], v[60:63], v[116:119]
    v_mov_b32 v13, 0xff800000
    s_nop 1
    v_cndmask_b32 v108, v13, v108, s[16:17]
    v_cndmask_b32 v109, v13, v109, s[18:19]
    v_cndmask_b32 v110, v13, v110, s[20:21]
    v_cndmask_b32 v111, v13, v111, s[22:23]
    v_cndmask_b32 v112, v13, v112, s[24:25]
    v_cndmask_b32 v113, v13, v113, s[26:27]
    v_cndmask_b32 v114, v13, v114, s[28:29]
    v_cndmask_b32 v115, v13, v115, s[30:31]
    v_max3_f32 v12, v108, v109, v110
    v_max3_f32 v13, v111, v112, v113
    v_max3_f32 v12, v12, v114, v115
    v_max3_f32 v12, v12, v13, v116
    v_max3_f32 v13, v117, v118, v119
    v_max_f32 v16, v12, v13
    v_max_f32 v17, v12, v13
    s_nop 1
    v_permlane16_swap_b32 v16, v17
    v_max_f32 v12, v16, v17
    v_max_f32 v13, v16, v17
    s_nop 1
    v_permlane32_swap_b32 v12, v13
    v_max_f32 v12, v12, v13
    v_mul_f32 v12, s57, v12
    v_fma_f32 v108, v108, s56, v12
    v_fma_f32 v109, v109, s56, v12
    v_fma_f32 v110, v110, s56, v12
    v_fma_f32 v111, v111, s56, v12
    v_fma_f32 v112, v112, s56, v12
    v_fma_f32 v113, v113, s56, v12
    v_fma_f32 v114, v114, s56, v12
    v_fma_f32 v115, v115, s56, v12
    v_fma_f32 v116, v116, s56, v12
    v_fma_f32 v117, v117, s56, v12
    v_fma_f32 v118, v118, s56, v12
    v_fma_f32 v119, v119, s56, v12
    v_exp_f32 v108, v108
    v_exp_f32 v109, v109
    v_exp_f32 v110, v110
    v_exp_f32 v111, v111
    v_exp_f32 v112, v112
    v_exp_f32 v113, v113
    v_exp_f32 v114, v114
    v_exp_f32 v115, v115
    v_exp_f32 v116, v116
    v_exp_f32 v117, v117
    v_exp_f32 v118, v118
    v_exp_f32 v119, v119
    s_nop 0
    v_cvt_pk_bf16_f32 v20, v108, v109
    v_cvt_pk_bf16_f32 v21, v110, v111
    v_cvt_pk_bf16_f32 v22, v112, v113
    v_cvt_pk_bf16_f32 v23, v114, v115
    v_cvt_pk_bf16_f32 v124, v116, v117
    v_cvt_pk_bf16_f32 v125, v118, v119
    v_cndmask_b32 v124, 0, v124, s[54:55]
    v_cndmask_b32 v125, 0, v125, s[54:55]
    s_waitcnt vmcnt(0)
    s_nop 1
    v_mfma_f32_16x16x32_bf16 v[40:43], v[120:123], v[20:23], 0
    v_mfma_f32_16x16x32_bf16 v[24:27], v[64:67], v[20:23], 0
    v_mfma_f32_16x16x32_bf16 v[28:31], v[68:71], v[20:23], 0
    v_mfma_f32_16x16x32_bf16 v[32:35], v[72:75], v[20:23], 0
    v_mfma_f32_16x16x32_bf16 v[36:39], v[76:79], v[20:23], 0
    v_mfma_f32_16x16x32_bf16 v[40:43], v[120:123], v[124:127], v[40:43]
    v_mfma_f32_16x16x32_bf16 v[24:27], v[96:99], v[124:127], v[24:27]
    v_mfma_f32_16x16x32_bf16 v[28:31], v[98:101], v[124:127], v[28:31]
    v_mfma_f32_16x16x32_bf16 v[32:35], v[100:103], v[124:127], v[32:35]
    v_mfma_f32_16x16x32_bf16 v[36:39], v[102:105], v[124:127], v[36:39]
    s_nop 7
    v_rcp_f32 v12, v40
    s_nop 0
    v_mul_f32 v24, v24, v12
    v_mul_f32 v25, v25, v12
    v_mul_f32 v26, v26, v12
    v_mul_f32 v27, v27, v12
    v_mul_f32 v28, v28, v12
    v_mul_f32 v29, v29, v12
    v_mul_f32 v30, v30, v12
    v_mul_f32 v31, v31, v12
    v_mul_f32 v32, v32, v12
    v_mul_f32 v33, v33, v12
    v_mul_f32 v34, v34, v12
    v_mul_f32 v35, v35, v12
    v_mul_f32 v36, v36, v12
    v_mul_f32 v37, v37, v12
    v_mul_f32 v38, v38, v12
    v_mul_f32 v39, v39, v12
    v_cvt_pk_bf16_f32 v48, v24, v25
    v_cvt_pk_bf16_f32 v49, v26, v27
    v_cvt_pk_bf16_f32 v50, v28, v29
    v_cvt_pk_bf16_f32 v51, v30, v31
    v_cvt_pk_bf16_f32 v52, v32, v33
    v_cvt_pk_bf16_f32 v53, v34, v35
    v_cvt_pk_bf16_f32 v54, v36, v37
    v_cvt_pk_bf16_f32 v55, v38, v39
    s_add_u32 s39, s38, 0x4000000
    buffer_store_dwordx4 v[48:51], v7, s[4:7], s39 offen sc1
    buffer_store_dwordx4 v[52:55], v7, s[4:7], s39 offen offset:1024 sc1
    s_waitcnt vmcnt(0)
    s_barrier
    s_cmp_lg_u32 s32, 0
    s_cbranch_scc1 L_xf_13
    s_lshl_b32 s35, s52, 7
    s_lshl_b32 s36, s44, 2
    s_add_u32 s35, s35, s36
    s_add_u32 s35, s35, 0x120000
    v_mov_b32 v11, 1
    s_mov_b64 exec, 1
    buffer_store_dword v11, off, s[4:7], s35 sc1
    s_mov_b64 exec, -1
L_xf_13:
    s_mov_b32 s52, s46
    s_mov_b32 s46, s47
    s_cmp_lt_u32 s52, 63
    s_cbranch_scc1 L_hq_loop_5
    s_branch L_role_end
L_chain:
    s_xor_b32 s44, s33, 0
    v_and_b32 v13, 63, v0
    v_lshlrev_b32 v0, 4, v13
    s_lshl_b32 s35, s44, 8
    s_lshl_b32 s36, s32, 20
    s_add_u32 s35, s35, s36
    v_bfe_u32 v116, v13, 4, 2
    v_mul_u32_u24 v116, 8192, v116
    v_bfe_u32 v15, v13, 0, 4
    v_mul_u32_u24 v15, 16, v15
    v_add_u32 v116, v116, v15
    v_add_u32 v116, s35, v116
    s_lshl_b32 s35, s44, 17
    s_lshl_b32 s36, s32, 8
    s_add_u32 s35, s35, s36
    v_bfe_u32 v117, v13, 4, 2
    v_mul_u32_u24 v117, 1024, v117
    v_bfe_u32 v15, v13, 0, 4
    v_mul_u32_u24 v15, 16, v15
    v_add_u32 v117, v117, v15
    v_add_u32 v117, s35, v117
    v_mov_b32 v16, -1
    v_mov_b32 v17, -1
    v_mov_b32 v18, -1
    v_mov_b32 v19, -1
    v_bfe_u32 v14, v13, 4, 1
    v_xor_b32 v112, -1, v14
    v_xor_b32 v113, -1, v14
    v_xor_b32 v114, -1, v14
    v_xor_b32 v115, -1, v14
    s_lshl_b32 s37, s44, 8
    v_add_u32 v14, s37, v0
    v_cmp_gt_u32 vcc, 16, v13
    v_mov_b32 v15, 0x40000000
    s_nop 0
    v_cndmask_b32 v2, v15, v14, vcc
    v_mov_b32 v20, 0
    v_mov_b32 v21, 0
    v_mov_b32 v22, 0
    v_mov_b32 v23, 0
    v_cndmask_b32 v24, v15, v0, vcc
    v_cmp_gt_u32 vcc, 8, v13
    s_nop 1
    v_cndmask_b32 v25, v15, v0, vcc
    s_mov_b32 s6, 0x5860000
    s_mov_b32 s7, 0x00020000
    s_mov_b32 s30, 0x400000
    s_mov_b32 s31, 0x00020000
    s_mov_b32 s18, 0x400000
    s_mov_b32 s19, 0x00020000
    s_mov_b32 s22, 0x400000
    s_mov_b32 s23, 0x00020000
    s_mov_b32 s26, 0x400000
    s_mov_b32 s27, 0x00020000
    s_mov_b32 s10, 0x100
    s_mov_b32 s11, 0x00020000
    s_mov_b32 s14, 0x200000
    s_mov_b32 s15, 0x00020000
    s_waitcnt lgkmcnt(0)
    s_mov_b64 s[4:5], s[90:91]
    s_mov_b64 s[28:29], s[74:75]
    s_mov_b64 s[16:17], s[68:69]
    s_mov_b64 s[20:21], s[70:71]
    s_mov_b64 s[24:25], s[72:73]
    s_mov_b64 s[8:9], s[88:89]
    s_mov_b64 s[12:13], s[64:65]
    s_lshl_b32 s73, s32, 15
    s_and_b32 s35, s44, 3
    s_cmp_eq_u32 s35, 1
    s_cselect_b32 s77, 1, 0
    s_lshl_b32 s35, s44, 13
    s_lshl_b32 s36, s32, 11
    s_add_u32 s35, s35, s36
    buffer_store_dwordx4 v[112:115], v0, s[4:7], s35 offen sc1
    buffer_store_dwordx4 v[112:115], v0, s[4:7], s35 offen offset:1024 sc1
    s_mov_b32 s36, 0x100000
    buffer_store_dwordx4 v[16:19], v2, s[4:7], s36 offen sc1
    s_mov_b32 s36, 0x102000
    buffer_store_dwordx4 v[16:19], v2, s[4:7], s36 offen sc1
    s_mov_b32 s36, 0x104000
    buffer_store_dwordx4 v[16:19], v2, s[4:7], s36 offen sc1
    s_mov_b32 s36, 0x106000
    buffer_store_dwordx4 v[16:19], v2, s[4:7], s36 offen sc1
    s_lshl_b32 s36, s44, 8
    s_add_u32 s36, s36, 0x120000
    buffer_store_dwordx4 v[20:23], v24, s[4:7], s36 offen sc1
    s_lshl_b32 s36, s44, 7
    s_add_u32 s36, s36, 0x110000
    buffer_store_dwordx4 v[20:23], v25, s[4:7], s36 offen sc1
    s_xor_b32 s35, 0x0, s73
    buffer_load_dwordx4 v[72:75], v117, s[28:31], s35 offen
    s_xor_b32 s35, 0x1000, s73
    buffer_load_dwordx4 v[76:79], v117, s[28:31], s35 offen
    s_xor_b32 s35, 0x2000, s73
    buffer_load_dwordx4 v[80:83], v117, s[28:31], s35 offen
    s_xor_b32 s35, 0x3000, s73
    buffer_load_dwordx4 v[84:87], v117, s[28:31], s35 offen
    s_xor_b32 s35, 0x4000, s73
    buffer_load_dwordx4 v[88:91], v117, s[28:31], s35 offen
    s_xor_b32 s35, 0x5000, s73
    buffer_load_dwordx4 v[92:95], v117, s[28:31], s35 offen
    s_xor_b32 s35, 0x6000, s73
    buffer_load_dwordx4 v[96:99], v117, s[28:31], s35 offen
    s_xor_b32 s35, 0x7000, s73
    buffer_load_dwordx4 v[100:103], v117, s[28:31], s35 offen
    s_cmp_eq_u32 s77, 1
    s_cbranch_scc1 L_sm_14
    s_waitcnt vmcnt(8)
L_sm_14:
    s_xor_b32 s35, 0x8000, s73
    buffer_load_dwordx4 v[40:43], v117, s[28:31], s35 offen
    s_xor_b32 s35, 0x9000, s73
    buffer_load_dwordx4 v[44:47], v117, s[28:31], s35 offen
    s_xor_b32 s35, 0xa000, s73
    buffer_load_dwordx4 v[48:51], v117, s[28:31], s35 offen
    s_xor_b32 s35, 0xb000, s73
    buffer_load_dwordx4 v[52:55], v117, s[28:31], s35 offen
    s_xor_b32 s35, 0xc000, s73
    buffer_load_dwordx4 v[56:59], v117, s[28:31], s35 offen
    s_xor_b32 s35, 0xd000, s73
    buffer_load_dwordx4 v[60:63], v117, s[28:31], s35 offen
    s_xor_b32 s35, 0xe000, s73
    buffer_load_dwordx4 v[64:67], v117, s[28:31], s35 offen
    s_xor_b32 s35, 0xf000, s73
    buffer_load_dwordx4 v[68:71], v117, s[28:31], s35 offen
    s_cmp_eq_u32 s77, 1
    s_cbranch_scc1 L_sm_15
    s_waitcnt vmcnt(8)
L_sm_15:
    s_mov_b32 s35, 0x0
    buffer_load_dwordx4 a[0:3], v116, s[16:19], s35 offen
    s_mov_b32 s35, 0x8000
    buffer_load_dwordx4 a[8:11], v116, s[16:19], s35 offen
    s_mov_b32 s35, 0x10000
    buffer_load_dwordx4 a[32:35], v116, s[16:19], s35 offen
    s_mov_b32 s35, 0x18000
    buffer_load_dwordx4 a[40:43], v116, s[16:19], s35 offen
    s_mov_b32 s35, 0x40000
    buffer_load_dwordx4 a[64:67], v116, s[16:19], s35 offen
    s_mov_b32 s35, 0x48000
    buffer_load_dwordx4 a[72:75], v116, s[16:19], s35 offen
    s_mov_b32 s35, 0x50000
    buffer_load_dwordx4 a[96:99], v116, s[16:19], s35 offen
    s_mov_b32 s35, 0x58000
    buffer_load_dwordx4 a[104:107], v116, s[16:19], s35 offen
    s_lshl_b32 s37, s32, 13
    v_bfe_u32 v118, v13, 4, 2
    v_mul_u32_u24 v118, 256, v118
    v_bfe_u32 v15, v13, 1, 3
    v_mul_u32_u24 v15, 32, v15
    v_add_u32 v118, v118, v15
    v_bfe_u32 v15, v13, 0, 1
    v_mul_u32_u24 v15, 16, v15
    v_add_u32 v118, v118, v15
    v_add_u32 v118, s37, v118
    v_mov_b32 v122, v118
    v_bfe_u32 v126, v13, 4, 1
    v_lshlrev_b32 v14, 5, v126
    v_xor_b32 v118, v118, v14
    v_lshlrev_b32 v14, 6, v126
    v_xor_b32 v122, v122, v14
    v_xor_b32 v119, 64, v118
    v_xor_b32 v120, 0x80, v118
    v_xor_b32 v121, 0xc0, v118
    v_xor_b32 v123, 0x80, v122
    s_lshl_b32 s38, s32, 6
    v_bfe_u32 v124, v13, 2, 1
    v_mul_u32_u24 v124, 288, v124
    v_bfe_u32 v15, v13, 4, 1
    v_mul_u32_u24 v15, 1088, v15
    v_add_u32 v124, v124, v15
    v_bfe_u32 v15, v13, 5, 1
    v_mul_u32_u24 v15, 2048, v15
    v_add_u32 v124, v124, v15
    v_bfe_u32 v15, v13, 3, 1
    v_mul_u32_u24 v15, 4224, v15
    v_add_u32 v124, v124, v15
    v_bfe_u32 v15, v13, 0, 2
    v_mul_u32_u24 v15, 8, v15
    v_add_u32 v124, v124, v15
    v_xor_b32 v124, s38, v124
    v_add_u32 v124, s37, v124
    v_bfe_u32 v125, v13, 2, 1
    v_mul_u32_u24 v125, 320, v125
    v_bfe_u32 v15, v13, 4, 1
    v_mul_u32_u24 v15, 4224, v15
    v_add_u32 v125, v125, v15
    v_bfe_u32 v15, v13, 5, 1
    v_mul_u32_u24 v15, 1024, v15
    v_add_u32 v125, v125, v15
    v_bfe_u32 v15, v13, 3, 1
    v_mul_u32_u24 v15, 32, v15
    v_add_u32 v125, v125, v15
    v_bfe_u32 v15, v13, 0, 2
    v_mul_u32_u24 v15, 8, v15
    v_add_u32 v125, v125, v15
    v_add_u32 v125, s37, v125
    s_lshl_b32 s35, s32, 15
    s_add_u32 s35, s35, 32768
    v_add_u32 v7, s35, v0
    s_waitcnt vmcnt(24)
    s_barrier
    s_cmp_lg_u32 s32, 0
    s_cbranch_scc1 L_ci_16
    s_getreg_b32 s35, hwreg(HW_REG_XCC_ID, 0, 4)
    s_mul_i32 s36, s35, s35
    s_lshl_b32 s36, s36, 17
    s_lshl_b32 s35, s35, 8
    s_add_u32 s35, s35, s36
    s_add_u32 s35, s35, 1
    v_mov_b32 v14, s35
    v_mov_b32 v15, 0
    s_mov_b64 exec, 1
    buffer_atomic_add v14, v15, s[8:11], 0 offen offset:0 sc1
    s_mov_b64 exec, -1
L_ci_16:
    s_lshr_b32 s38, s44, 2
    s_lshl_b32 s38, s38, 10
    s_and_b32 s39, s44, 1
    s_lshl_b32 s39, s39, 9
    s_add_u32 s38, s38, s39
    s_and_b32 s39, s44, 2
    s_lshl_b32 s39, s39, 4
    s_add_u32 s38, s38, s39
    v_bfe_u32 v10, v13, 5, 1
    v_mul_u32_u24 v10, 256, v10
    v_bfe_u32 v15, v13, 1, 2
    v_mul_u32_u24 v15, 64, v15
    v_add_u32 v10, v10, v15
    v_bfe_u32 v15, v13, 0, 1
    v_mul_u32_u24 v15, 16, v15
    v_add_u32 v10, v10, v15
    v_bfe_u32 v15, v13, 4, 1
    v_mul_u32_u24 v15, 8, v15
    v_add_u32 v10, v10, v15
    v_add_u32 v10, s38, v10
    v_and_b32 v15, 8, v13
    v_lshlrev_b32 v15, 27, v15
    v_add_u32 v10, v10, v15
    s_cmp_eq_u32 s32, 0
    s_cbranch_scc1 L_w0_17
    v_mov_b32 v10, v2
    s_cmp_eq_u32 s32, 3
    s_cbranch_scc1 L_w0_17
    v_mov_b32 v10, 0x40000000
L_w0_17:
    v_mov_b32 v2, 0x4444
    v_mov_b32 v14, 0xeeee
    v_and_b32 v15, 2, v13
    v_cmp_ne_u32 vcc, 0, v15
    s_nop 1
    v_cndmask_b32 v2, v2, v14, vcc
    v_mov_b32 v31, 0x4444
    v_mov_b32 v14, 0xeeee
    v_and_b32 v15, 8, v13
    v_cmp_ne_u32 vcc, 0, v15
    s_nop 1
    v_cndmask_b32 v31, v31, v14, vcc
    s_lshl_b32 s35, s32, 9
    v_bfe_u32 v3, v13, 0, 4
    v_mul_u32_u24 v3, 16, v3
    v_bfe_u32 v15, v13, 4, 2
    v_mul_u32_u24 v15, 4, v15
    v_add_u32 v3, v3, v15
    v_add_u32 v3, s35, v3
    s_lshl_b32 s35, s32, 10
    s_lshr_b32 s36, s32, 1
    s_lshl_b32 s36, s36, 11
    s_add_u32 s35, s35, s36
    v_bfe_u32 v1, v13, 0, 4
    v_mul_u32_u24 v1, 32, v1
    v_bfe_u32 v15, v13, 4, 2
    v_mul_u32_u24 v15, 8, v15
    v_add_u32 v1, v1, v15
    v_add_u32 v1, 0x800, v1
    v_add_u32 v1, s35, v1
    v_bfe_u32 v21, v13, 5, 1
    v_mul_u32_u24 v21, 512, v21
    v_bfe_u32 v15, v13, 4, 1
    v_mul_u32_u24 v15, 128, v15
    v_add_u32 v21, v21, v15
    v_bfe_u32 v15, v13, 2, 2
    v_mul_u32_u24 v15, 32, v15
    v_add_u32 v21, v21, v15
    v_bfe_u32 v15, v13, 0, 2
    v_mul_u32_u24 v15, 8, v15
    v_add_u32 v21, v21, v15
    v_bfe_u32 v4, v13, 5, 1
    v_mul_u32_u24 v4, 256, v4
    v_bfe_u32 v15, v13, 4, 1
    v_mul_u32_u24 v15, 64, v15
    v_add_u32 v4, v4, v15
    v_bfe_u32 v15, v13, 2, 2
    v_mul_u32_u24 v15, 16, v15
    v_add_u32 v4, v4, v15
    v_bfe_u32 v15, v13, 0, 1
    v_mul_u32_u24 v15, 8, v15
    v_add_u32 v4, v4, v15
    s_lshl_b32 s35, s32, 9
    v_bfe_u32 v5, v13, 4, 2
    v_mul_u32_u24 v5, 128, v5
    v_bfe_u32 v15, v13, 0, 3
    v_mul_u32_u24 v15, 16, v15
    v_add_u32 v5, v5, v15
    v_add_u32 v5, 0x1000, v5
    v_add_u32 v5, s35, v5
    s_lshl_b32 s35, s32, 11
    s_add_u32 s35, s35, 8192
    v_add_u32 v6, s35, v0
    s_lshl_b32 s35, s32, 16
    s_lshl_b32 s36, s44, 8
    v_bfe_u32 v8, v13, 5, 1
    v_mul_u32_u24 v8, 8192, v8
    v_bfe_u32 v15, v13, 0, 4
    v_mul_u32_u24 v15, 16, v15
    v_add_u32 v8, v8, v15
    v_bfe_u32 v15, v13, 4, 1
    v_mul_u32_u24 v15, 8, v15
    v_add_u32 v8, v8, v15
    v_add_u32 v8, s35, v8
    v_add_u32 v8, s36, v8
    s_lshl_b32 s35, s44, 13
    v_add_u32 v9, s35, v0
    s_and_b32 s36, s32, 1
    s_lshl_b32 s36, s36, 13
    s_lshl_b32 s35, s44, 14
    s_add_u32 s35, s35, s36
    v_lshlrev_b32 v11, 6, v13
    v_add_u32 v11, s35, v11
    s_mov_b32 s58, -1
    s_mov_b32 s59, 0
    s_mov_b32 s60, 0
    s_mov_b32 s61, -1
    s_mov_b32 s52, 0x3e0293ee
    s_mov_b32 s53, 0xbe0293ee
    s_cmp_lg_u32 s32, 0
    s_cbranch_scc1 L_sel_18
    v_and_b32 v14, 15, v13
    v_mov_b32 v30, 0x3f80
    v_mov_b32 v15, 0x3f800000
    v_and_b32 v112, 1, v14
    v_cmp_eq_u32 vcc, 1, v112
    s_nop 1
    v_cndmask_b32 v30, v30, v15, vcc
    v_lshrrev_b32 v14, 1, v14
    v_cmp_eq_u32 vcc, 0, v14
    s_nop 1
    v_cndmask_b32 v16, 0, v30, vcc
    v_cmp_eq_u32 vcc, 1, v14
    s_nop 1
    v_cndmask_b32 v17, 0, v30, vcc
    v_cmp_eq_u32 vcc, 2, v14
    s_nop 1
    v_cndmask_b32 v18, 0, v30, vcc
    v_cmp_eq_u32 vcc, 3, v14
    s_nop 1
    v_cndmask_b32 v19, 0, v30, vcc
    v_bfe_u32 v11, v13, 4, 1
    v_xor_b32 v11, 1, v11
L_sel_18:
    v_mov_b32 v22, 0x3f803f80
    v_mov_b32 v23, 0x3f803f80
    v_mov_b32 v24, 0x3f803f80
    v_mov_b32 v25, 0x3f803f80
    v_mov_b32 v27, 0
    v_mov_b32 v28, 0
    v_mov_b32 v29, 0
    s_lshl_b32 s69, s32, 11
    s_mov_b32 s47, 16384
    s_mov_b32 s70, 32768
    s_mov_b32 s71, 49152
    s_mov_b32 s48, 4096
    s_and_b32 s55, s44, 1
    s_xor_b32 s55, s55, 1
    s_lshl_b32 s40, s44, 7
    s_add_u32 s40, s40, 0x110000
    s_cmp_ge_u32 s32, 2
    s_mov_b32 s35, 0x40000000
    s_mov_b32 s84, 0x1080000
    s_cselect_b32 s84, s84, s35
    s_add_u32 s87, s69, 16384
    s_lshl_b32 s86, s44, 14
    s_add_u32 s86, s86, s69
    s_add_u32 s86, s86, 0x1000000
    s_add_u32 s88, s69, 24576
    s_lshl_b32 s51, s44, 14
    s_add_u32 s51, s51, s69
    s_add_u32 s51, s51, 0x1000000
    s_lshl_b32 s50, s44, 12
    s_add_u32 s50, s50, 0x200000
    s_mov_b32 s80, 8
    s_mov_b32 s81, 1
    s_mov_b32 s79, 1
    s_waitcnt vmcnt(16)
    s_barrier
    ds_write_b128 v122, v[72:75] offset:0
    ds_write_b128 v122, v[76:79] offset:1024
    ds_write_b128 v122, v[80:83] offset:2048
    ds_write_b128 v122, v[84:87] offset:3072
    ds_write_b128 v123, v[88:91] offset:4096
    ds_write_b128 v123, v[92:95] offset:5120
    ds_write_b128 v123, v[96:99] offset:6144
    ds_write_b128 v123, v[100:103] offset:7168
    v_xor_b32 v126, 0x0, v125
    ds_read_b64_tr_b16 a[224:225], v126 offset:0
    ds_read_b64_tr_b16 a[226:227], v126 offset:512
    ds_read_b64_tr_b16 a[228:229], v126 offset:2048
    ds_read_b64_tr_b16 a[230:231], v126 offset:2560
    v_xor_b32 v127, 0x40, v125
    ds_read_b64_tr_b16 a[232:233], v127 offset:0
    ds_read_b64_tr_b16 a[234:235], v127 offset:512
    ds_read_b64_tr_b16 a[236:237], v127 offset:2048
    ds_read_b64_tr_b16 a[238:239], v127 offset:2560
    v_xor_b32 v126, 0x80, v125
    ds_read_b64_tr_b16 a[240:241], v126 offset:0
    ds_read_b64_tr_b16 a[242:243], v126 offset:512
    ds_read_b64_tr_b16 a[244:245], v126 offset:2048
    ds_read_b64_tr_b16 a[246:247], v126 offset:2560
    v_xor_b32 v127, 0xc0, v125
    ds_read_b64_tr_b16 a[248:249], v127 offset:0
    ds_read_b64_tr_b16 a[250:251], v127 offset:512
    ds_read_b64_tr_b16 a[252:253], v127 offset:2048
    ds_read_b64_tr_b16 a[254:255], v127 offset:2560
    s_waitcnt lgkmcnt(0)
    s_waitcnt lgkmcnt(0)
    s_cmp_eq_u32 s77, 1
    s_cbranch_scc1 L_sm_19
    s_waitcnt vmcnt(8)
L_sm_19:
    s_mov_b32 s35, 0x20000
    buffer_load_dwordx4 a[4:7], v116, s[16:19], s35 offen
    s_mov_b32 s35, 0x28000
    buffer_load_dwordx4 a[12:15], v116, s[16:19], s35 offen
    s_mov_b32 s35, 0x30000
    buffer_load_dwordx4 a[36:39], v116, s[16:19], s35 offen
    s_mov_b32 s35, 0x38000
    buffer_load_dwordx4 a[44:47], v116, s[16:19], s35 offen
    s_mov_b32 s35, 0x60000
    buffer_load_dwordx4 a[68:71], v116, s[16:19], s35 offen
    s_mov_b32 s35, 0x68000
    buffer_load_dwordx4 a[76:79], v116, s[16:19], s35 offen
    s_mov_b32 s35, 0x70000
    buffer_load_dwordx4 a[100:103], v116, s[16:19], s35 offen
    s_mov_b32 s35, 0x78000
    buffer_load_dwordx4 a[108:111], v116, s[16:19], s35 offen
    s_waitcnt vmcnt(16)
    s_barrier
    ds_write_b128 v122, v[40:43] offset:0
    ds_write_b128 v122, v[44:47] offset:1024
    ds_write_b128 v122, v[48:51] offset:2048
    ds_write_b128 v122, v[52:55] offset:3072
    ds_write_b128 v123, v[56:59] offset:4096
    ds_write_b128 v123, v[60:63] offset:5120
    ds_write_b128 v123, v[64:67] offset:6144
    ds_write_b128 v123, v[68:71] offset:7168
    v_xor_b32 v126, 0x0, v125
    ds_read_b64_tr_b16 v[224:225], v126 offset:0
    ds_read_b64_tr_b16 v[226:227], v126 offset:512
    ds_read_b64_tr_b16 v[228:229], v126 offset:2048
    ds_read_b64_tr_b16 v[230:231], v126 offset:2560
    v_xor_b32 v127, 0x40, v125
    ds_read_b64_tr_b16 v[248:249], v127 offset:0
    ds_read_b64_tr_b16 v[250:251], v127 offset:512
    ds_read_b64_tr_b16 v[252:253], v127 offset:2048
    ds_read_b64_tr_b16 v[254:255], v127 offset:2560
    v_xor_b32 v126, 0x80, v125
    ds_read_b64_tr_b16 v[56:57], v126 offset:0
    ds_read_b64_tr_b16 v[58:59], v126 offset:512
    ds_read_b64_tr_b16 v[60:61], v126 offset:2048
    ds_read_b64_tr_b16 v[62:63], v126 offset:2560
    v_xor_b32 v127, 0xc0, v125
    ds_read_b64_tr_b16 v[64:65], v127 offset:0
    ds_read_b64_tr_b16 v[66:67], v127 offset:512
    ds_read_b64_tr_b16 v[68:69], v127 offset:2048
    ds_read_b64_tr_b16 v[70:71], v127 offset:2560
    s_waitcnt lgkmcnt(0)
    ds_write_b128 v7, v[56:59] offset:20480
    ds_write_b128 v7, v[60:63] offset:21504
    ds_write_b128 v7, v[64:67] offset:26624
    ds_write_b128 v7, v[68:71] offset:27648
    s_waitcnt lgkmcnt(0)
    s_cmp_eq_u32 s77, 1
    s_cbranch_scc1 L_sm_20
    s_waitcnt vmcnt(8)
L_sm_20:
    s_mov_b32 s35, 0x80000
    buffer_load_dwordx4 a[16:19], v116, s[16:19], s35 offen
    s_mov_b32 s35, 0x88000
    buffer_load_dwordx4 a[24:27], v116, s[16:19], s35 offen
    s_mov_b32 s35, 0x90000
    buffer_load_dwordx4 a[48:51], v116, s[16:19], s35 offen
    s_mov_b32 s35, 0x98000
    buffer_load_dwordx4 a[56:59], v116, s[16:19], s35 offen
    s_mov_b32 s35, 0xc0000
    buffer_load_dwordx4 a[80:83], v116, s[16:19], s35 offen
    s_mov_b32 s35, 0xc8000
    buffer_load_dwordx4 a[88:91], v116, s[16:19], s35 offen
    s_mov_b32 s35, 0xd0000
    buffer_load_dwordx4 a[112:115], v116, s[16:19], s35 offen
    s_mov_b32 s35, 0xd8000
    buffer_load_dwordx4 a[120:123], v116, s[16:19], s35 offen
    s_waitcnt vmcnt(16)
    s_barrier
    ds_write_b128 v118, a[0:3] offset:0
    ds_write_b128 v119, a[8:11] offset:1024
    ds_write_b128 v118, a[32:35] offset:2048
    ds_write_b128 v119, a[40:43] offset:3072
    ds_write_b128 v120, a[64:67] offset:4096
    ds_write_b128 v121, a[72:75] offset:5120
    ds_write_b128 v120, a[96:99] offset:6144
    ds_write_b128 v121, a[104:107] offset:7168
    s_waitcnt lgkmcnt(0)
    s_barrier
    v_xor_b32 v126, 0x0, v124
    ds_read_b64_tr_b16 a[0:1], v126 offset:0
    ds_read_b64_tr_b16 a[2:3], v126 offset:512
    v_xor_b32 v127, 0x20, v124
    ds_read_b64_tr_b16 a[8:9], v127 offset:0
    ds_read_b64_tr_b16 a[10:11], v127 offset:512
    v_xor_b32 v126, 0x2000, v124
    ds_read_b64_tr_b16 a[32:33], v126 offset:0
    ds_read_b64_tr_b16 a[34:35], v126 offset:512
    v_xor_b32 v127, 0x2020, v124
    ds_read_b64_tr_b16 a[40:41], v127 offset:0
    ds_read_b64_tr_b16 a[42:43], v127 offset:512
    v_xor_b32 v126, 0x4000, v124
    ds_read_b64_tr_b16 a[64:65], v126 offset:0
    ds_read_b64_tr_b16 a[66:67], v126 offset:512
    v_xor_b32 v127, 0x4020, v124
    ds_read_b64_tr_b16 a[72:73], v127 offset:0
    ds_read_b64_tr_b16 a[74:75], v127 offset:512
    v_xor_b32 v126, 0x6000, v124
    ds_read_b64_tr_b16 a[96:97], v126 offset:0
    ds_read_b64_tr_b16 a[98:99], v126 offset:512
    v_xor_b32 v127, 0x6020, v124
    ds_read_b64_tr_b16 a[104:105], v127 offset:0
    ds_read_b64_tr_b16 a[106:107], v127 offset:512
    s_waitcnt lgkmcnt(0)
    s_cmp_eq_u32 s77, 1
    s_cbranch_scc1 L_sm_21
    s_waitcnt vmcnt(8)
L_sm_21:
    s_mov_b32 s35, 0xa0000
    buffer_load_dwordx4 a[20:23], v116, s[16:19], s35 offen
    s_mov_b32 s35, 0xa8000
    buffer_load_dwordx4 a[28:31], v116, s[16:19], s35 offen
    s_mov_b32 s35, 0xb0000
    buffer_load_dwordx4 a[52:55], v116, s[16:19], s35 offen
    s_mov_b32 s35, 0xb8000
    buffer_load_dwordx4 a[60:63], v116, s[16:19], s35 offen
    s_mov_b32 s35, 0xe0000
    buffer_load_dwordx4 a[84:87], v116, s[16:19], s35 offen
    s_mov_b32 s35, 0xe8000
    buffer_load_dwordx4 a[92:95], v116, s[16:19], s35 offen
    s_mov_b32 s35, 0xf0000
    buffer_load_dwordx4 a[116:119], v116, s[16:19], s35 offen
    s_mov_b32 s35, 0xf8000
    buffer_load_dwordx4 a[124:127], v116, s[16:19], s35 offen
    s_waitcnt vmcnt(16)
    s_barrier
    ds_write_b128 v118, a[4:7] offset:0
    ds_write_b128 v119, a[12:15] offset:1024
    ds_write_b128 v118, a[36:39] offset:2048
    ds_write_b128 v119, a[44:47] offset:3072
    ds_write_b128 v120, a[68:71] offset:4096
    ds_write_b128 v121, a[76:79] offset:5120
    ds_write_b128 v120, a[100:103] offset:6144
    ds_write_b128 v121, a[108:111] offset:7168
    s_waitcnt lgkmcnt(0)
    s_barrier
    v_xor_b32 v126, 0x0, v124
    ds_read_b64_tr_b16 a[4:5], v126 offset:0
    ds_read_b64_tr_b16 a[6:7], v126 offset:512
    v_xor_b32 v127, 0x20, v124
    ds_read_b64_tr_b16 a[12:13], v127 offset:0
    ds_read_b64_tr_b16 a[14:15], v127 offset:512
    v_xor_b32 v126, 0x2000, v124
    ds_read_b64_tr_b16 a[36:37], v126 offset:0
    ds_read_b64_tr_b16 a[38:39], v126 offset:512
    v_xor_b32 v127, 0x2020, v124
    ds_read_b64_tr_b16 a[44:45], v127 offset:0
    ds_read_b64_tr_b16 a[46:47], v127 offset:512
    v_xor_b32 v126, 0x4000, v124
    ds_read_b64_tr_b16 a[68:69], v126 offset:0
    ds_read_b64_tr_b16 a[70:71], v126 offset:512
    v_xor_b32 v127, 0x4020, v124
    ds_read_b64_tr_b16 a[76:77], v127 offset:0
    ds_read_b64_tr_b16 a[78:79], v127 offset:512
    v_xor_b32 v126, 0x6000, v124
    ds_read_b64_tr_b16 a[100:101], v126 offset:0
    ds_read_b64_tr_b16 a[102:103], v126 offset:512
    v_xor_b32 v127, 0x6020, v124
    ds_read_b64_tr_b16 a[108:109], v127 offset:0
    ds_read_b64_tr_b16 a[110:111], v127 offset:512
    s_waitcnt lgkmcnt(0)
    s_cmp_eq_u32 s77, 1
    s_cbranch_scc1 L_sm_22
    s_waitcnt vmcnt(8)
L_sm_22:
    s_xor_b32 s35, 0x10000, s73
    buffer_load_dwordx4 v[72:75], v117, s[28:31], s35 offen
    s_xor_b32 s35, 0x11000, s73
    buffer_load_dwordx4 v[76:79], v117, s[28:31], s35 offen
    s_xor_b32 s35, 0x12000, s73
    buffer_load_dwordx4 v[80:83], v117, s[28:31], s35 offen
    s_xor_b32 s35, 0x13000, s73
    buffer_load_dwordx4 v[84:87], v117, s[28:31], s35 offen
    s_xor_b32 s35, 0x14000, s73
    buffer_load_dwordx4 v[88:91], v117, s[28:31], s35 offen
    s_xor_b32 s35, 0x15000, s73
    buffer_load_dwordx4 v[92:95], v117, s[28:31], s35 offen
    s_xor_b32 s35, 0x16000, s73
    buffer_load_dwordx4 v[96:99], v117, s[28:31], s35 offen
    s_xor_b32 s35, 0x17000, s73
    buffer_load_dwordx4 v[100:103], v117, s[28:31], s35 offen
    s_waitcnt vmcnt(16)
    s_barrier
    ds_write_b128 v118, a[16:19] offset:0
    ds_write_b128 v119, a[24:27] offset:1024
    ds_write_b128 v118, a[48:51] offset:2048
    ds_write_b128 v119, a[56:59] offset:3072
    ds_write_b128 v120, a[80:83] offset:4096
    ds_write_b128 v121, a[88:91] offset:5120
    ds_write_b128 v120, a[112:115] offset:6144
    ds_write_b128 v121, a[120:123] offset:7168
    s_waitcnt lgkmcnt(0)
    s_barrier
    v_xor_b32 v126, 0x0, v124
    ds_read_b64_tr_b16 a[16:17], v126 offset:0
    ds_read_b64_tr_b16 a[18:19], v126 offset:512
    v_xor_b32 v127, 0x20, v124
    ds_read_b64_tr_b16 a[24:25], v127 offset:0
    ds_read_b64_tr_b16 a[26:27], v127 offset:512
    v_xor_b32 v126, 0x2000, v124
    ds_read_b64_tr_b16 a[48:49], v126 offset:0
    ds_read_b64_tr_b16 a[50:51], v126 offset:512
    v_xor_b32 v127, 0x2020, v124
    ds_read_b64_tr_b16 a[56:57], v127 offset:0
    ds_read_b64_tr_b16 a[58:59], v127 offset:512
    v_xor_b32 v126, 0x4000, v124
    ds_read_b64_tr_b16 a[80:81], v126 offset:0
    ds_read_b64_tr_b16 a[82:83], v126 offset:512
    v_xor_b32 v127, 0x4020, v124
    ds_read_b64_tr_b16 a[88:89], v127 offset:0
    ds_read_b64_tr_b16 a[90:91], v127 offset:512
    v_xor_b32 v126, 0x6000, v124
    ds_read_b64_tr_b16 a[112:113], v126 offset:0
    ds_read_b64_tr_b16 a[114:115], v126 offset:512
    v_xor_b32 v127, 0x6020, v124
    ds_read_b64_tr_b16 a[120:121], v127 offset:0
    ds_read_b64_tr_b16 a[122:123], v127 offset:512
    s_waitcnt lgkmcnt(0)
    s_cmp_eq_u32 s77, 1
    s_cbranch_scc1 L_sm_23
    s_waitcnt vmcnt(8)
L_sm_23:
    s_xor_b32 s35, 0x18000, s73
    buffer_load_dwordx4 v[40:43], v117, s[28:31], s35 offen
    s_xor_b32 s35, 0x19000, s73
    buffer_load_dwordx4 v[44:47], v117, s[28:31], s35 offen
    s_xor_b32 s35, 0x1a000, s73
    buffer_load_dwordx4 v[48:51], v117, s[28:31], s35 offen
    s_xor_b32 s35, 0x1b000, s73
    buffer_load_dwordx4 v[52:55], v117, s[28:31], s35 offen
    s_xor_b32 s35, 0x1c000, s73
    buffer_load_dwordx4 v[56:59], v117, s[28:31], s35 offen
    s_xor_b32 s35, 0x1d000, s73
    buffer_load_dwordx4 v[60:63], v117, s[28:31], s35 offen
    s_xor_b32 s35, 0x1e000, s73
    buffer_load_dwordx4 v[64:67], v117, s[28:31], s35 offen
    s_xor_b32 s35, 0x1f000, s73
    buffer_load_dwordx4 v[68:71], v117, s[28:31], s35 offen
    s_waitcnt vmcnt(16)
    s_barrier
    ds_write_b128 v118, a[20:23] offset:0
    ds_write_b128 v119, a[28:31] offset:1024
    ds_write_b128 v118, a[52:55] offset:2048
    ds_write_b128 v119, a[60:63] offset:3072
    ds_write_b128 v120, a[84:87] offset:4096
    ds_write_b128 v121, a[92:95] offset:5120
    ds_write_b128 v120, a[116:119] offset:6144
    ds_write_b128 v121, a[124:127] offset:7168
    s_waitcnt lgkmcnt(0)
    s_barrier
    v_xor_b32 v126, 0x0, v124
    ds_read_b64_tr_b16 a[20:21], v126 offset:0
    ds_read_b64_tr_b16 a[22:23], v126 offset:512
    v_xor_b32 v127, 0x20, v124
    ds_read_b64_tr_b16 a[28:29], v127 offset:0
    ds_read_b64_tr_b16 a[30:31], v127 offset:512
    v_xor_b32 v126, 0x2000, v124
    ds_read_b64_tr_b16 a[52:53], v126 offset:0
    ds_read_b64_tr_b16 a[54:55], v126 offset:512
    v_xor_b32 v127, 0x2020, v124
    ds_read_b64_tr_b16 a[60:61], v127 offset:0
    ds_read_b64_tr_b16 a[62:63], v127 offset:512
    v_xor_b32 v126, 0x4000, v124
    ds_read_b64_tr_b16 a[84:85], v126 offset:0
    ds_read_b64_tr_b16 a[86:87], v126 offset:512
    v_xor_b32 v127, 0x4020, v124
    ds_read_b64_tr_b16 a[92:93], v127 offset:0
    ds_read_b64_tr_b16 a[94:95], v127 offset:512
    v_xor_b32 v126, 0x6000, v124
    ds_read_b64_tr_b16 a[116:117], v126 offset:0
    ds_read_b64_tr_b16 a[118:119], v126 offset:512
    v_xor_b32 v127, 0x6020, v124
    ds_read_b64_tr_b16 a[124:125], v127 offset:0
    ds_read_b64_tr_b16 a[126:127], v127 offset:512
    s_waitcnt lgkmcnt(0)
    s_cmp_eq_u32 s77, 1
    s_cbranch_scc1 L_sm_24
    s_waitcnt vmcnt(8)
L_sm_24:
    s_mov_b32 s35, 0x0
    buffer_load_dwordx4 a[128:131], v116, s[20:23], s35 offen
    s_mov_b32 s35, 0x8000
    buffer_load_dwordx4 a[136:139], v116, s[20:23], s35 offen
    s_mov_b32 s35, 0x10000
    buffer_load_dwordx4 v[104:107], v116, s[20:23], s35 offen
    s_mov_b32 s35, 0x18000
    buffer_load_dwordx4 v[108:111], v116, s[20:23], s35 offen
    s_mov_b32 s35, 0x40000
    buffer_load_dwordx4 a[160:163], v116, s[20:23], s35 offen
    s_mov_b32 s35, 0x48000
    buffer_load_dwordx4 a[168:171], v116, s[20:23], s35 offen
    s_mov_b32 s35, 0x50000
    buffer_load_dwordx4 a[192:195], v116, s[20:23], s35 offen
    s_mov_b32 s35, 0x58000
    buffer_load_dwordx4 a[200:203], v116, s[20:23], s35 offen
    s_waitcnt vmcnt(16)
    s_barrier
    ds_write_b128 v122, v[72:75] offset:0
    ds_write_b128 v122, v[76:79] offset:1024
    ds_write_b128 v122, v[80:83] offset:2048
    ds_write_b128 v122, v[84:87] offset:3072
    ds_write_b128 v123, v[88:91] offset:4096
    ds_write_b128 v123, v[92:95] offset:5120
    ds_write_b128 v123, v[96:99] offset:6144
    ds_write_b128 v123, v[100:103] offset:7168
    v_xor_b32 v126, 0x0, v125
    ds_read_b64_tr_b16 v[232:233], v126 offset:0
    ds_read_b64_tr_b16 v[234:235], v126 offset:512
    ds_read_b64_tr_b16 v[236:237], v126 offset:2048
    ds_read_b64_tr_b16 v[238:239], v126 offset:2560
    v_xor_b32 v127, 0x40, v125
    ds_read_b64_tr_b16 v[80:81], v127 offset:0
    ds_read_b64_tr_b16 v[82:83], v127 offset:512
    ds_read_b64_tr_b16 v[84:85], v127 offset:2048
    ds_read_b64_tr_b16 v[86:87], v127 offset:2560
    v_xor_b32 v126, 0x80, v125
    ds_read_b64_tr_b16 v[88:89], v126 offset:0
    ds_read_b64_tr_b16 v[90:91], v126 offset:512
    ds_read_b64_tr_b16 v[92:93], v126 offset:2048
    ds_read_b64_tr_b16 v[94:95], v126 offset:2560
    v_xor_b32 v127, 0xc0, v125
    ds_read_b64_tr_b16 v[96:97], v127 offset:0
    ds_read_b64_tr_b16 v[98:99], v127 offset:512
    ds_read_b64_tr_b16 v[100:101], v127 offset:2048
    ds_read_b64_tr_b16 v[102:103], v127 offset:2560
    s_waitcnt lgkmcnt(0)
    ds_write_b128 v7, v[80:83] offset:16384
    ds_write_b128 v7, v[84:87] offset:17408
    ds_write_b128 v7, v[88:91] offset:22528
    ds_write_b128 v7, v[92:95] offset:23552
    ds_write_b128 v7, v[96:99] offset:28672
    ds_write_b128 v7, v[100:103] offset:29696
    s_waitcnt lgkmcnt(0)
    s_cmp_eq_u32 s77, 1
    s_cbranch_scc1 L_sm_25
    s_waitcnt vmcnt(8)
L_sm_25:
    s_mov_b32 s35, 0x20000
    buffer_load_dwordx4 a[132:135], v116, s[20:23], s35 offen
    s_mov_b32 s35, 0x28000
    buffer_load_dwordx4 a[140:143], v116, s[20:23], s35 offen
    s_mov_b32 s35, 0x30000
    buffer_load_dwordx4 v[32:35], v116, s[20:23], s35 offen
    s_mov_b32 s35, 0x38000
    buffer_load_dwordx4 v[36:39], v116, s[20:23], s35 offen
    s_mov_b32 s35, 0x60000
    buffer_load_dwordx4 a[164:167], v116, s[20:23], s35 offen
    s_mov_b32 s35, 0x68000
    buffer_load_dwordx4 a[172:175], v116, s[20:23], s35 offen
    s_mov_b32 s35, 0x70000
    buffer_load_dwordx4 a[196:199], v116, s[20:23], s35 offen
    s_mov_b32 s35, 0x78000
    buffer_load_dwordx4 a[204:207], v116, s[20:23], s35 offen
    s_waitcnt vmcnt(16)
    s_barrier
    ds_write_b128 v122, v[40:43] offset:0
    ds_write_b128 v122, v[44:47] offset:1024
    ds_write_b128 v122, v[48:51] offset:2048
    ds_write_b128 v122, v[52:55] offset:3072
    ds_write_b128 v123, v[56:59] offset:4096
    ds_write_b128 v123, v[60:63] offset:5120
    ds_write_b128 v123, v[64:67] offset:6144
    ds_write_b128 v123, v[68:71] offset:7168
    v_xor_b32 v126, 0x0, v125
    ds_read_b64_tr_b16 v[240:241], v126 offset:0
    ds_read_b64_tr_b16 v[242:243], v126 offset:512
    ds_read_b64_tr_b16 v[244:245], v126 offset:2048
    ds_read_b64_tr_b16 v[246:247], v126 offset:2560
    v_xor_b32 v127, 0x40, v125
    ds_read_b64_tr_b16 v[48:49], v127 offset:0
    ds_read_b64_tr_b16 v[50:51], v127 offset:512
    ds_read_b64_tr_b16 v[52:53], v127 offset:2048
    ds_read_b64_tr_b16 v[54:55], v127 offset:2560
    v_xor_b32 v126, 0x80, v125
    ds_read_b64_tr_b16 v[56:57], v126 offset:0
    ds_read_b64_tr_b16 v[58:59], v126 offset:512
    ds_read_b64_tr_b16 v[60:61], v126 offset:2048
    ds_read_b64_tr_b16 v[62:63], v126 offset:2560
    v_xor_b32 v127, 0xc0, v125
    ds_read_b64_tr_b16 v[64:65], v127 offset:0
    ds_read_b64_tr_b16 v[66:67], v127 offset:512
    ds_read_b64_tr_b16 v[68:69], v127 offset:2048
    ds_read_b64_tr_b16 v[70:71], v127 offset:2560
    s_waitcnt lgkmcnt(0)
    ds_write_b128 v7, v[48:51] offset:18432
    ds_write_b128 v7, v[52:55] offset:19456
    ds_write_b128 v7, v[56:59] offset:24576
    ds_write_b128 v7, v[60:63] offset:25600
    ds_write_b128 v7, v[64:67] offset:30720
    ds_write_b128 v7, v[68:71] offset:31744
    s_waitcnt lgkmcnt(0)
    s_cmp_eq_u32 s77, 1
    s_cbranch_scc1 L_sm_26
    s_waitcnt vmcnt(8)
L_sm_26:
    s_mov_b32 s35, 0x80000
    buffer_load_dwordx4 a[144:147], v116, s[20:23], s35 offen
    s_mov_b32 s35, 0x88000
    buffer_load_dwordx4 a[152:155], v116, s[20:23], s35 offen
    s_mov_b32 s35, 0x90000
    buffer_load_dwordx4 v[40:43], v116, s[20:23], s35 offen
    s_mov_b32 s35, 0x98000
    buffer_load_dwordx4 v[44:47], v116, s[20:23], s35 offen
    s_mov_b32 s35, 0xc0000
    buffer_load_dwordx4 a[176:179], v116, s[20:23], s35 offen
    s_mov_b32 s35, 0xc8000
    buffer_load_dwordx4 a[184:187], v116, s[20:23], s35 offen
    s_mov_b32 s35, 0xd0000
    buffer_load_dwordx4 a[208:211], v116, s[20:23], s35 offen
    s_mov_b32 s35, 0xd8000
    buffer_load_dwordx4 a[216:219], v116, s[20:23], s35 offen
    s_waitcnt vmcnt(16)
    s_barrier
    ds_write_b128 v118, a[128:131] offset:0
    ds_write_b128 v119, a[136:139] offset:1024
    ds_write_b128 v118, v[104:107] offset:2048
    ds_write_b128 v119, v[108:111] offset:3072
    ds_write_b128 v120, a[160:163] offset:4096
    ds_write_b128 v121, a[168:171] offset:5120
    ds_write_b128 v120, a[192:195] offset:6144
    ds_write_b128 v121, a[200:203] offset:7168
    s_waitcnt lgkmcnt(0)
    s_barrier
    v_xor_b32 v126, 0x0, v124
    ds_read_b64_tr_b16 a[128:129], v126 offset:0
    ds_read_b64_tr_b16 a[130:131], v126 offset:512
    v_xor_b32 v127, 0x20, v124
    ds_read_b64_tr_b16 a[136:137], v127 offset:0
    ds_read_b64_tr_b16 a[138:139], v127 offset:512
    v_xor_b32 v126, 0x2000, v124
    ds_read_b64_tr_b16 v[104:105], v126 offset:0
    ds_read_b64_tr_b16 v[106:107], v126 offset:512
    v_xor_b32 v127, 0x2020, v124
    ds_read_b64_tr_b16 v[108:109], v127 offset:0
    ds_read_b64_tr_b16 v[110:111], v127 offset:512
    v_xor_b32 v126, 0x4000, v124
    ds_read_b64_tr_b16 a[160:161], v126 offset:0
    ds_read_b64_tr_b16 a[162:163], v126 offset:512
    v_xor_b32 v127, 0x4020, v124
    ds_read_b64_tr_b16 a[168:169], v127 offset:0
    ds_read_b64_tr_b16 a[170:171], v127 offset:512
    v_xor_b32 v126, 0x6000, v124
    ds_read_b64_tr_b16 a[192:193], v126 offset:0
    ds_read_b64_tr_b16 a[194:195], v126 offset:512
    v_xor_b32 v127, 0x6020, v124
    ds_read_b64_tr_b16 a[200:201], v127 offset:0
    ds_read_b64_tr_b16 a[202:203], v127 offset:512
    s_waitcnt lgkmcnt(0)
    ds_write_b128 v7, v[104:107] offset:0
    ds_write_b128 v7, v[108:111] offset:2048
    s_waitcnt lgkmcnt(0)
    s_cmp_eq_u32 s77, 1
    s_cbranch_scc1 L_sm_27
    s_waitcnt vmcnt(8)
L_sm_27:
    s_mov_b32 s35, 0xa0000
    buffer_load_dwordx4 a[148:151], v116, s[20:23], s35 offen
    s_mov_b32 s35, 0xa8000
    buffer_load_dwordx4 a[156:159], v116, s[20:23], s35 offen
    s_mov_b32 s35, 0xb0000
    buffer_load_dwordx4 v[48:51], v116, s[20:23], s35 offen
    s_mov_b32 s35, 0xb8000
    buffer_load_dwordx4 v[52:55], v116, s[20:23], s35 offen
    s_mov_b32 s35, 0xe0000
    buffer_load_dwordx4 a[180:183], v116, s[20:23], s35 offen
    s_mov_b32 s35, 0xe8000
    buffer_load_dwordx4 a[188:191], v116, s[20:23], s35 offen
    s_mov_b32 s35, 0xf0000
    buffer_load_dwordx4 a[212:215], v116, s[20:23], s35 offen
    s_mov_b32 s35, 0xf8000
    buffer_load_dwordx4 a[220:223], v116, s[20:23], s35 offen
    s_waitcnt vmcnt(16)
    s_barrier
    ds_write_b128 v118, a[132:135] offset:0
    ds_write_b128 v119, a[140:143] offset:1024
    ds_write_b128 v118, v[32:35] offset:2048
    ds_write_b128 v119, v[36:39] offset:3072
    ds_write_b128 v120, a[164:167] offset:4096
    ds_write_b128 v121, a[172:175] offset:5120
    ds_write_b128 v120, a[196:199] offset:6144
    ds_write_b128 v121, a[204:207] offset:7168
    s_waitcnt lgkmcnt(0)
    s_barrier
    v_xor_b32 v126, 0x0, v124
    ds_read_b64_tr_b16 a[132:133], v126 offset:0
    ds_read_b64_tr_b16 a[134:135], v126 offset:512
    v_xor_b32 v127, 0x20, v124
    ds_read_b64_tr_b16 a[140:141], v127 offset:0
    ds_read_b64_tr_b16 a[142:143], v127 offset:512
    v_xor_b32 v126, 0x2000, v124
    ds_read_b64_tr_b16 v[32:33], v126 offset:0
    ds_read_b64_tr_b16 v[34:35], v126 offset:512
    v_xor_b32 v127, 0x2020, v124
    ds_read_b64_tr_b16 v[36:37], v127 offset:0
    ds_read_b64_tr_b16 v[38:39], v127 offset:512
    v_xor_b32 v126, 0x4000, v124
    ds_read_b64_tr_b16 a[164:165], v126 offset:0
    ds_read_b64_tr_b16 a[166:167], v126 offset:512
    v_xor_b32 v127, 0x4020, v124
    ds_read_b64_tr_b16 a[172:173], v127 offset:0
    ds_read_b64_tr_b16 a[174:175], v127 offset:512
    v_xor_b32 v126, 0x6000, v124
    ds_read_b64_tr_b16 a[196:197], v126 offset:0
    ds_read_b64_tr_b16 a[198:199], v126 offset:512
    v_xor_b32 v127, 0x6020, v124
    ds_read_b64_tr_b16 a[204:205], v127 offset:0
    ds_read_b64_tr_b16 a[206:207], v127 offset:512
    s_waitcnt lgkmcnt(0)
    ds_write_b128 v7, v[32:35] offset:1024
    ds_write_b128 v7, v[36:39] offset:3072
    s_waitcnt lgkmcnt(0)
    s_cmp_eq_u32 s77, 1
    s_cbranch_scc1 L_sm_28
    s_waitcnt vmcnt(8)
L_sm_28:
    s_mov_b32 s35, 0x0
    buffer_load_dwordx4 v[128:131], v116, s[24:27], s35 offen
    s_mov_b32 s35, 0x8000
    buffer_load_dwordx4 v[136:139], v116, s[24:27], s35 offen
    s_mov_b32 s35, 0x10000
    buffer_load_dwordx4 v[56:59], v116, s[24:27], s35 offen
    s_mov_b32 s35, 0x18000
    buffer_load_dwordx4 v[60:63], v116, s[24:27], s35 offen
    s_mov_b32 s35, 0x40000
    buffer_load_dwordx4 v[160:163], v116, s[24:27], s35 offen
    s_mov_b32 s35, 0x48000
    buffer_load_dwordx4 v[168:171], v116, s[24:27], s35 offen
    s_mov_b32 s35, 0x50000
    buffer_load_dwordx4 v[192:195], v116, s[24:27], s35 offen
    s_mov_b32 s35, 0x58000
    buffer_load_dwordx4 v[200:203], v116, s[24:27], s35 offen
    s_waitcnt vmcnt(16)
    s_barrier
    ds_write_b128 v118, a[144:147] offset:0
    ds_write_b128 v119, a[152:155] offset:1024
    ds_write_b128 v118, v[40:43] offset:2048
    ds_write_b128 v119, v[44:47] offset:3072
    ds_write_b128 v120, a[176:179] offset:4096
    ds_write_b128 v121, a[184:187] offset:5120
    ds_write_b128 v120, a[208:211] offset:6144
    ds_write_b128 v121, a[216:219] offset:7168
    s_waitcnt lgkmcnt(0)
    s_barrier
    v_xor_b32 v126, 0x0, v124
    ds_read_b64_tr_b16 a[144:145], v126 offset:0
    ds_read_b64_tr_b16 a[146:147], v126 offset:512
    v_xor_b32 v127, 0x20, v124
    ds_read_b64_tr_b16 a[152:153], v127 offset:0
    ds_read_b64_tr_b16 a[154:155], v127 offset:512
    v_xor_b32 v126, 0x2000, v124
    ds_read_b64_tr_b16 v[40:41], v126 offset:0
    ds_read_b64_tr_b16 v[42:43], v126 offset:512
    v_xor_b32 v127, 0x2020, v124
    ds_read_b64_tr_b16 v[44:45], v127 offset:0
    ds_read_b64_tr_b16 v[46:47], v127 offset:512
    v_xor_b32 v126, 0x4000, v124
    ds_read_b64_tr_b16 a[176:177], v126 offset:0
    ds_read_b64_tr_b16 a[178:179], v126 offset:512
    v_xor_b32 v127, 0x4020, v124
    ds_read_b64_tr_b16 a[184:185], v127 offset:0
    ds_read_b64_tr_b16 a[186:187], v127 offset:512
    v_xor_b32 v126, 0x6000, v124
    ds_read_b64_tr_b16 a[208:209], v126 offset:0
    ds_read_b64_tr_b16 a[210:211], v126 offset:512
    v_xor_b32 v127, 0x6020, v124
    ds_read_b64_tr_b16 a[216:217], v127 offset:0
    ds_read_b64_tr_b16 a[218:219], v127 offset:512
    s_waitcnt lgkmcnt(0)
    ds_write_b128 v7, v[40:43] offset:4096
    ds_write_b128 v7, v[44:47] offset:6144
    s_waitcnt lgkmcnt(0)
    s_cmp_eq_u32 s77, 1
    s_cbranch_scc1 L_sm_29
    s_waitcnt vmcnt(8)
L_sm_29:
    s_mov_b32 s35, 0x20000
    buffer_load_dwordx4 v[132:135], v116, s[24:27], s35 offen
    s_mov_b32 s35, 0x28000
    buffer_load_dwordx4 v[140:143], v116, s[24:27], s35 offen
    s_mov_b32 s35, 0x30000
    buffer_load_dwordx4 v[40:43], v116, s[24:27], s35 offen
    s_mov_b32 s35, 0x38000
    buffer_load_dwordx4 v[44:47], v116, s[24:27], s35 offen
    s_mov_b32 s35, 0x60000
    buffer_load_dwordx4 v[164:167], v116, s[24:27], s35 offen
    s_mov_b32 s35, 0x68000
    buffer_load_dwordx4 v[172:175], v116, s[24:27], s35 offen
    s_mov_b32 s35, 0x70000
    buffer_load_dwordx4 v[196:199], v116, s[24:27], s35 offen
    s_mov_b32 s35, 0x78000
    buffer_load_dwordx4 v[204:207], v116, s[24:27], s35 offen
    s_waitcnt vmcnt(16)
    s_barrier
    ds_write_b128 v118, a[148:151] offset:0
    ds_write_b128 v119, a[156:159] offset:1024
    ds_write_b128 v118, v[48:51] offset:2048
    ds_write_b128 v119, v[52:55] offset:3072
    ds_write_b128 v120, a[180:183] offset:4096
    ds_write_b128 v121, a[188:191] offset:5120
    ds_write_b128 v120, a[212:215] offset:6144
    ds_write_b128 v121, a[220:223] offset:7168
    s_waitcnt lgkmcnt(0)
    s_barrier
    v_xor_b32 v126, 0x0, v124
    ds_read_b64_tr_b16 a[148:149], v126 offset:0
    ds_read_b64_tr_b16 a[150:151], v126 offset:512
    v_xor_b32 v127, 0x20, v124
    ds_read_b64_tr_b16 a[156:157], v127 offset:0
    ds_read_b64_tr_b16 a[158:159], v127 offset:512
    v_xor_b32 v126, 0x2000, v124
    ds_read_b64_tr_b16 v[48:49], v126 offset:0
    ds_read_b64_tr_b16 v[50:51], v126 offset:512
    v_xor_b32 v127, 0x2020, v124
    ds_read_b64_tr_b16 v[52:53], v127 offset:0
    ds_read_b64_tr_b16 v[54:55], v127 offset:512
    v_xor_b32 v126, 0x4000, v124
    ds_read_b64_tr_b16 a[180:181], v126 offset:0
    ds_read_b64_tr_b16 a[182:183], v126 offset:512
    v_xor_b32 v127, 0x4020, v124
    ds_read_b64_tr_b16 a[188:189], v127 offset:0
    ds_read_b64_tr_b16 a[190:191], v127 offset:512
    v_xor_b32 v126, 0x6000, v124
    ds_read_b64_tr_b16 a[212:213], v126 offset:0
    ds_read_b64_tr_b16 a[214:215], v126 offset:512
    v_xor_b32 v127, 0x6020, v124
    ds_read_b64_tr_b16 a[220:221], v127 offset:0
    ds_read_b64_tr_b16 a[222:223], v127 offset:512
    s_waitcnt lgkmcnt(0)
    ds_write_b128 v7, v[48:51] offset:5120
    ds_write_b128 v7, v[52:55] offset:7168
    s_waitcnt lgkmcnt(0)
    s_cmp_eq_u32 s77, 1
    s_cbranch_scc1 L_sm_30
    s_waitcnt vmcnt(8)
L_sm_30:
    s_mov_b32 s35, 0x80000
    buffer_load_dwordx4 v[144:147], v116, s[24:27], s35 offen
    s_mov_b32 s35, 0x88000
    buffer_load_dwordx4 v[152:155], v116, s[24:27], s35 offen
    s_mov_b32 s35, 0x90000
    buffer_load_dwordx4 v[48:51], v116, s[24:27], s35 offen
    s_mov_b32 s35, 0x98000
    buffer_load_dwordx4 v[52:55], v116, s[24:27], s35 offen
    s_mov_b32 s35, 0xc0000
    buffer_load_dwordx4 v[176:179], v116, s[24:27], s35 offen
    s_mov_b32 s35, 0xc8000
    buffer_load_dwordx4 v[184:187], v116, s[24:27], s35 offen
    s_mov_b32 s35, 0xd0000
    buffer_load_dwordx4 v[208:211], v116, s[24:27], s35 offen
    s_mov_b32 s35, 0xd8000
    buffer_load_dwordx4 v[216:219], v116, s[24:27], s35 offen
    s_waitcnt vmcnt(16)
    s_barrier
    ds_write_b128 v118, v[128:131] offset:0
    ds_write_b128 v119, v[136:139] offset:1024
    ds_write_b128 v118, v[56:59] offset:2048
    ds_write_b128 v119, v[60:63] offset:3072
    ds_write_b128 v120, v[160:163] offset:4096
    ds_write_b128 v121, v[168:171] offset:5120
    ds_write_b128 v120, v[192:195] offset:6144
    ds_write_b128 v121, v[200:203] offset:7168
    s_waitcnt lgkmcnt(0)
    s_barrier
    v_xor_b32 v126, 0x0, v124
    ds_read_b64_tr_b16 v[128:129], v126 offset:0
    ds_read_b64_tr_b16 v[130:131], v126 offset:512
    v_xor_b32 v127, 0x20, v124
    ds_read_b64_tr_b16 v[136:137], v127 offset:0
    ds_read_b64_tr_b16 v[138:139], v127 offset:512
    v_xor_b32 v126, 0x2000, v124
    ds_read_b64_tr_b16 v[56:57], v126 offset:0
    ds_read_b64_tr_b16 v[58:59], v126 offset:512
    v_xor_b32 v127, 0x2020, v124
    ds_read_b64_tr_b16 v[60:61], v127 offset:0
    ds_read_b64_tr_b16 v[62:63], v127 offset:512
    v_xor_b32 v126, 0x4000, v124
    ds_read_b64_tr_b16 v[160:161], v126 offset:0
    ds_read_b64_tr_b16 v[162:163], v126 offset:512
    v_xor_b32 v127, 0x4020, v124
    ds_read_b64_tr_b16 v[168:169], v127 offset:0
    ds_read_b64_tr_b16 v[170:171], v127 offset:512
    v_xor_b32 v126, 0x6000, v124
    ds_read_b64_tr_b16 v[192:193], v126 offset:0
    ds_read_b64_tr_b16 v[194:195], v126 offset:512
    v_xor_b32 v127, 0x6020, v124
    ds_read_b64_tr_b16 v[200:201], v127 offset:0
    ds_read_b64_tr_b16 v[202:203], v127 offset:512
    s_waitcnt lgkmcnt(0)
    ds_write_b128 v7, v[56:59] offset:8192
    ds_write_b128 v7, v[60:63] offset:10240
    s_waitcnt lgkmcnt(0)
    s_mov_b32 s12, s66
    s_mov_b32 s13, s67
    s_mov_b32 s14, 0x2000
    s_mov_b32 s15, 0x00020000
    s_lshl_b32 s35, s32, 8
    v_bfe_u32 v115, v13, 2, 2
    v_mul_u32_u24 v115, 2048, v115
    v_bfe_u32 v15, v13, 0, 1
    v_mul_u32_u24 v15, 1024, v15
    v_add_u32 v115, v115, v15
    v_bfe_u32 v15, v13, 1, 1
    v_mul_u32_u24 v15, 64, v15
    v_add_u32 v115, v115, v15
    v_bfe_u32 v15, v13, 4, 2
    v_mul_u32_u24 v15, 16, v15
    v_add_u32 v115, v115, v15
    v_add_u32 v115, s35, v115
    buffer_load_dwordx2 v[112:113], off, s[4:7], s40 sc1
    buffer_load_dword v114, off, s[8:11], 0 offset:0 sc1
    buffer_load_dwordx4 v[32:35], v115, s[12:15], 0 offen
    buffer_load_dwordx4 v[36:39], v115, s[12:15], 0 offen offset:128
    s_cmp_eq_u32 s77, 1
    s_cbranch_scc1 L_sm_31
    s_waitcnt vmcnt(8)
L_sm_31:
    s_mov_b32 s35, 0xa0000
    buffer_load_dwordx4 v[148:151], v116, s[24:27], s35 offen
    s_mov_b32 s35, 0xa8000
    buffer_load_dwordx4 v[156:159], v116, s[24:27], s35 offen
    s_mov_b32 s35, 0xb0000
    buffer_load_dwordx4 v[56:59], v116, s[24:27], s35 offen
    s_mov_b32 s35, 0xb8000
    buffer_load_dwordx4 v[60:63], v116, s[24:27], s35 offen
    s_mov_b32 s35, 0xe0000
    buffer_load_dwordx4 v[180:183], v116, s[24:27], s35 offen
    s_mov_b32 s35, 0xe8000
    buffer_load_dwordx4 v[188:191], v116, s[24:27], s35 offen
    s_mov_b32 s35, 0xf0000
    buffer_load_dwordx4 v[212:215], v116, s[24:27], s35 offen
    s_mov_b32 s35, 0xf8000
    buffer_load_dwordx4 v[220:223], v116, s[24:27], s35 offen
    s_waitcnt vmcnt(20)
    s_barrier
    ds_write_b128 v118, v[132:135] offset:0
    ds_write_b128 v119, v[140:143] offset:1024
    ds_write_b128 v118, v[40:43] offset:2048
    ds_write_b128 v119, v[44:47] offset:3072
    ds_write_b128 v120, v[164:167] offset:4096
    ds_write_b128 v121, v[172:175] offset:5120
    ds_write_b128 v120, v[196:199] offset:6144
    ds_write_b128 v121, v[204:207] offset:7168
    s_waitcnt lgkmcnt(0)
    s_barrier
    v_xor_b32 v126, 0x0, v124
    ds_read_b64_tr_b16 v[132:133], v126 offset:0
    ds_read_b64_tr_b16 v[134:135], v126 offset:512
    v_xor_b32 v127, 0x20, v124
    ds_read_b64_tr_b16 v[140:141], v127 offset:0
    ds_read_b64_tr_b16 v[142:143], v127 offset:512
    v_xor_b32 v126, 0x2000, v124
    ds_read_b64_tr_b16 v[40:41], v126 offset:0
    ds_read_b64_tr_b16 v[42:43], v126 offset:512
    v_xor_b32 v127, 0x2020, v124
    ds_read_b64_tr_b16 v[44:45], v127 offset:0
    ds_read_b64_tr_b16 v[46:47], v127 offset:512
    v_xor_b32 v126, 0x4000, v124
    ds_read_b64_tr_b16 v[164:165], v126 offset:0
    ds_read_b64_tr_b16 v[166:167], v126 offset:512
    v_xor_b32 v127, 0x4020, v124
    ds_read_b64_tr_b16 v[172:173], v127 offset:0
    ds_read_b64_tr_b16 v[174:175], v127 offset:512
    v_xor_b32 v126, 0x6000, v124
    ds_read_b64_tr_b16 v[196:197], v126 offset:0
    ds_read_b64_tr_b16 v[198:199], v126 offset:512
    v_xor_b32 v127, 0x6020, v124
    ds_read_b64_tr_b16 v[204:205], v127 offset:0
    ds_read_b64_tr_b16 v[206:207], v127 offset:512
    s_waitcnt lgkmcnt(0)
    ds_write_b128 v7, v[40:43] offset:9216
    ds_write_b128 v7, v[44:47] offset:11264
    s_waitcnt lgkmcnt(0)
    s_waitcnt vmcnt(12)
    s_barrier
    ds_write_b128 v118, v[144:147] offset:0
    ds_write_b128 v119, v[152:155] offset:1024
    ds_write_b128 v118, v[48:51] offset:2048
    ds_write_b128 v119, v[52:55] offset:3072
    ds_write_b128 v120, v[176:179] offset:4096
    ds_write_b128 v121, v[184:187] offset:5120
    ds_write_b128 v120, v[208:211] offset:6144
    ds_write_b128 v121, v[216:219] offset:7168
    s_waitcnt lgkmcnt(0)
    s_barrier
    v_xor_b32 v126, 0x0, v124
    ds_read_b64_tr_b16 v[144:145], v126 offset:0
    ds_read_b64_tr_b16 v[146:147], v126 offset:512
    v_xor_b32 v127, 0x20, v124
    ds_read_b64_tr_b16 v[152:153], v127 offset:0
    ds_read_b64_tr_b16 v[154:155], v127 offset:512
    v_xor_b32 v126, 0x2000, v124
    ds_read_b64_tr_b16 v[48:49], v126 offset:0
    ds_read_b64_tr_b16 v[50:51], v126 offset:512
    v_xor_b32 v127, 0x2020, v124
    ds_read_b64_tr_b16 v[52:53], v127 offset:0
    ds_read_b64_tr_b16 v[54:55], v127 offset:512
    v_xor_b32 v126, 0x4000, v124
    ds_read_b64_tr_b16 v[176:177], v126 offset:0
    ds_read_b64_tr_b16 v[178:179], v126 offset:512
    v_xor_b32 v127, 0x4020, v124
    ds_read_b64_tr_b16 v[184:185], v127 offset:0
    ds_read_b64_tr_b16 v[186:187], v127 offset:512
    v_xor_b32 v126, 0x6000, v124
    ds_read_b64_tr_b16 v[208:209], v126 offset:0
    ds_read_b64_tr_b16 v[210:211], v126 offset:512
    v_xor_b32 v127, 0x6020, v124
    ds_read_b64_tr_b16 v[216:217], v127 offset:0
    ds_read_b64_tr_b16 v[218:219], v127 offset:512
    s_waitcnt lgkmcnt(0)
    ds_write_b128 v7, v[48:51] offset:12288
    ds_write_b128 v7, v[52:55] offset:14336
    s_waitcnt lgkmcnt(0)
    s_waitcnt vmcnt(11)
    v_min_u32 v112, v112, v113
    s_nop 0
    v_readfirstlane_b32 s35, v112
    s_cmp_ge_u32 s35, 1
    s_cselect_b32 s57, 1, 0
    s_cselect_b32 s36, s86, 0x40000000
    buffer_load_dwordx4 v[104:107], v0, s[4:7], s36 offen
    buffer_load_dwordx4 v[108:111], v0, s[4:7], s36 offen offset:1024
    s_waitcnt vmcnt(2)
    s_barrier
    ds_write_b128 v118, v[148:151] offset:0
    ds_write_b128 v119, v[156:159] offset:1024
    ds_write_b128 v118, v[56:59] offset:2048
    ds_write_b128 v119, v[60:63] offset:3072
    ds_write_b128 v120, v[180:183] offset:4096
    ds_write_b128 v121, v[188:191] offset:5120
    ds_write_b128 v120, v[212:215] offset:6144
    ds_write_b128 v121, v[220:223] offset:7168
    s_waitcnt lgkmcnt(0)
    s_barrier
    v_xor_b32 v126, 0x0, v124
    ds_read_b64_tr_b16 v[148:149], v126 offset:0
    ds_read_b64_tr_b16 v[150:151], v126 offset:512
    v_xor_b32 v127, 0x20, v124
    ds_read_b64_tr_b16 v[156:157], v127 offset:0
    ds_read_b64_tr_b16 v[158:159], v127 offset:512
    v_xor_b32 v126, 0x2000, v124
    ds_read_b64_tr_b16 v[56:57], v126 offset:0
    ds_read_b64_tr_b16 v[58:59], v126 offset:512
    v_xor_b32 v127, 0x2020, v124
    ds_read_b64_tr_b16 v[60:61], v127 offset:0
    ds_read_b64_tr_b16 v[62:63], v127 offset:512
    v_xor_b32 v126, 0x4000, v124
    ds_read_b64_tr_b16 v[180:181], v126 offset:0
    ds_read_b64_tr_b16 v[182:183], v126 offset:512
    v_xor_b32 v127, 0x4020, v124
    ds_read_b64_tr_b16 v[188:189], v127 offset:0
    ds_read_b64_tr_b16 v[190:191], v127 offset:512
    v_xor_b32 v126, 0x6000, v124
    ds_read_b64_tr_b16 v[212:213], v126 offset:0
    ds_read_b64_tr_b16 v[214:215], v126 offset:512
    v_xor_b32 v127, 0x6020, v124
    ds_read_b64_tr_b16 v[220:221], v127 offset:0
    ds_read_b64_tr_b16 v[222:223], v127 offset:512
    s_waitcnt lgkmcnt(0)
    ds_write_b128 v7, v[56:59] offset:13312
    ds_write_b128 v7, v[60:63] offset:15360
    s_waitcnt lgkmcnt(0)
    s_waitcnt lgkmcnt(0)
    s_barrier
    s_cmp_eq_u32 s57, 1
    s_cbranch_scc1 L_kok_32
    s_mov_b32 s54, 0
    s_cmp_lg_u32 s41, 0
    s_cbranch_scc1 L_kvd_34
L_kvp_33:
    buffer_load_dword v12, off, s[4:7], s40 offset:0 sc1
    s_waitcnt vmcnt(0)
    v_readfirstlane_b32 s35, v12
    s_cmp_ge_u32 s35, 1
    s_cbranch_scc1 L_kvd_34
    s_sleep 1
    s_add_u32 s54, s54, 1
    s_cmp_lt_u32 s54, 131072
    s_cbranch_scc1 L_kvp_33
    s_mov_b32 s41, 1
L_kvd_34:
    s_mov_b32 s54, 0
    s_cmp_lg_u32 s41, 0
    s_cbranch_scc1 L_kvd_36
L_kvp_35:
    buffer_load_dword v12, off, s[4:7], s40 offset:4 sc1
    s_waitcnt vmcnt(0)
    v_readfirstlane_b32 s35, v12
    s_cmp_ge_u32 s35, 1
    s_cbranch_scc1 L_kvd_36
    s_sleep 1
    s_add_u32 s54, s54, 1
    s_cmp_lt_u32 s54, 131072
    s_cbranch_scc1 L_kvp_35
    s_mov_b32 s41, 1
L_kvd_36:
    buffer_load_dwordx4 v[104:107], v0, s[4:7], s86 offen
    buffer_load_dwordx4 v[108:111], v0, s[4:7], s86 offen offset:1024
L_kok_32:
    s_waitcnt vmcnt(0)
    ds_write_b128 v6, v[32:35]
    ds_write_b128 v6, v[36:39] offset:1024
    v_mov_b64 v[56:57], v[32:33]
    v_mov_b64 v[58:59], v[34:35]
    v_mov_b64 v[60:61], v[36:37]
    v_mov_b64 v[62:63], v[38:39]
    v_readfirstlane_b32 s39, v114
    ds_write_b128 v6, v[104:107] offset:8192
    ds_write_b128 v6, v[108:111] offset:9216
    v_mov_b32 v112, 0
    v_mov_b32 v113, 0
    v_mov_b32 v114, 0
    v_mov_b32 v115, 0
    v_mov_b32 v116, 0
    v_mov_b32 v117, 0
    v_mov_b32 v118, 0
    v_mov_b32 v119, 0
    v_mov_b32 v120, 0
    v_mov_b32 v121, 0
    v_mov_b32 v122, 0
    v_mov_b32 v123, 0
    v_mov_b32 v124, 0
    v_mov_b32 v125, 0
    v_mov_b32 v126, 0
    v_mov_b32 v127, 0
    v_mov_b32 v88, 0
    v_mov_b32 v89, 0
    v_mov_b32 v90, 0
    v_mov_b32 v91, 0
    v_mov_b32 v92, 0
    v_mov_b32 v93, 0
    v_mov_b32 v94, 0
    v_mov_b32 v95, 0
    s_cmp_eq_u32 s32, 0
    s_cselect_b32 s67, 0x40000000, s40
    s_add_u32 s78, s67, 8
    s_and_b32 s35, s39, 0xff
    s_cmp_ge_u32 s35, 32
    s_cbranch_scc1 L_cok_37
    v_mov_b32 v15, 0
    s_mov_b32 s37, 0
    s_mov_b32 s38, 0
    s_mov_b32 s36, 0
    s_cmp_lg_u32 s41, 0
    s_cbranch_scc1 L_wdci_39
L_wci_38:
    buffer_load_dword v12, v15, s[8:11], s37 offen sc1
    s_waitcnt vmcnt(0)
    v_readfirstlane_b32 s35, v12
    s_lshr_b32 s35, s35, s38
    s_and_b32 s35, s35, 0xff
    s_cmp_ge_u32 s35, 32
    s_cbranch_scc1 L_wdci_39
    s_sleep 1
    s_add_u32 s36, s36, 1
    s_cmp_lt_u32 s36, 131072
    s_cbranch_scc1 L_wci_38
    s_mov_b32 s41, 1
L_wdci_39:
    buffer_load_dword v12, v15, s[8:11], 0 offen offset:0 sc1
    s_waitcnt vmcnt(0)
    v_readfirstlane_b32 s39, v12
L_cok_37:
    s_getreg_b32 s35, hwreg(HW_REG_XCC_ID, 0, 4)
    s_mul_i32 s36, s35, s35
    s_lshl_b32 s36, s36, 22
    s_lshl_b32 s35, s35, 13
    s_add_u32 s35, s35, s36
    s_add_u32 s35, s35, 32
    s_cmp_eq_u32 s35, s39
    s_cselect_b32 s57, 1, 0
    s_mov_b32 m0, s88
    s_mov_b32 s45, 0
    s_load_dwordx2 s[28:29], s[0:1], 88
    s_waitcnt vmcnt(0) lgkmcnt(0)
    s_barrier
    v_xor_b32 v14, 0x800, v6
    v_xor_b32 v15, 0x1000, v6
    v_xor_b32 v30, 0x1800, v6
    ds_read_b128 v[32:35], v7 offset:0
    ds_read_b128 v[36:39], v7 offset:1024
    ds_read_b128 v[40:43], v7 offset:2048
    ds_read_b128 v[44:47], v7 offset:3072
    ds_read_b128 v[96:99], v7 offset:4096
    ds_read_b128 v[100:103], v7 offset:5120
    s_cmp_eq_u32 s57, 1
    s_cbranch_scc0 L_own1_s
    s_branch L_own1_f
.p2align 8
    s_nop 0
    s_nop 0
L_top_f:
    s_barrier
    v_xor_b32 v14, 0x800, v6
    v_xor_b32 v15, 0x1000, v6
    v_xor_b32 v30, 0x1800, v6
    s_mov_b32 s54, 0
    s_mov_b32 m0, s87
    s_nop 0
    buffer_load_dwordx4 v0, s[4:7], s51 offen lds
    buffer_load_dwordx4 v0, s[4:7], s51 offen offset:1024 lds
    s_mov_b32 m0, s88
    ds_read_b128 v[32:35], v7 offset:0
    ds_read_b128 v[36:39], v7 offset:1024
    ds_read_b128 v[40:43], v7 offset:2048
    ds_read_b128 v[44:47], v7 offset:3072
    ds_read_b128 v[96:99], v7 offset:4096
    ds_read_b128 v[100:103], v7 offset:5120
    s_sleep 1
    s_sleep 1
    buffer_load_dwordx4 v[48:51], v0, s[4:7], s85 offen sc1
    buffer_load_dwordx4 v[52:55], v0, s[4:7], s85 offen offset:1024 sc1
    s_sleep 1
    s_sleep 1
    s_sleep 1
    buffer_load_dwordx4 v[56:59], v0, s[4:7], s85 offen sc1
    buffer_load_dwordx4 v[60:63], v0, s[4:7], s85 offen offset:1024 sc1
L_spec_f:
    s_waitcnt vmcnt(2)
    ds_write_b128 v6, v[48:51]
    ds_write_b128 v6, v[52:55] offset:1024
    v_smfmac_f32_16x16x64_bf16 v[112:115], v[48:51], a[0:7], v2
    v_max3_u32 v64, v48, v50, v52
    v_smfmac_f32_16x16x64_bf16 v[116:119], v[48:51], a[8:15], v2
    v_max_u32 v64, v64, v54
    v_smfmac_f32_16x16x64_bf16 v[112:115], v[52:55], a[16:23], v2
    v_cmp_eq_u32 vcc, -1, v64
    s_add_u32 s54, s54, 1
    s_cbranch_vccnz L_retry0_f
    v_smfmac_f32_16x16x64_bf16 v[116:119], v[52:55], a[24:31], v2
    s_waitcnt lgkmcnt(0)
    s_barrier
    v_smfmac_f32_16x16x64_bf16 v[88:91], v[48:51], a[128:135], v2
    ds_read_b128 v[64:67], v14 offset:0
    v_smfmac_f32_16x16x64_bf16 v[92:95], v[48:51], a[136:143], v2
    ds_read_b128 v[68:71], v14 offset:1024
    v_smfmac_f32_16x16x64_bf16 v[88:91], v[52:55], a[144:151], v2
    ds_read_b128 v[72:75], v15 offset:0
    v_smfmac_f32_16x16x64_bf16 v[92:95], v[52:55], a[152:159], v2
    ds_read_b128 v[76:79], v15 offset:1024
    v_smfmac_f32_16x16x64_bf16 v[120:123], v[48:51], v[128:135], v2
    s_add_u32 s38, s51, 8192
    ds_read_b128 v[80:83], v30 offset:0
    v_smfmac_f32_16x16x64_bf16 v[124:127], v[48:51], v[136:143], v2
    buffer_load_dwordx4 v0, s[4:7], s38 offen lds
    ds_read_b128 v[84:87], v30 offset:1024
    v_smfmac_f32_16x16x64_bf16 v[120:123], v[52:55], v[144:151], v2
    buffer_load_dwordx4 v0, s[4:7], s38 offen offset:1024 lds
    v_smfmac_f32_16x16x64_bf16 v[124:127], v[52:55], v[152:159], v2
L_common_f:
    s_waitcnt lgkmcnt(5)
    v_smfmac_f32_16x16x64_bf16 v[112:115], v[64:67], a[32:39], v2
    v_smfmac_f32_16x16x64_bf16 v[116:119], v[64:67], a[40:47], v2
    buffer_load_dword v12, off, s[4:7], s78 sc1
    s_waitcnt lgkmcnt(4)
    v_smfmac_f32_16x16x64_bf16 v[112:115], v[68:71], a[48:55], v2
    buffer_load_dword v13, v11, s[4:7], s84 offen
    v_smfmac_f32_16x16x64_bf16 v[116:119], v[68:71], a[56:63], v2
    s_add_u32 s38, s84, 4096
    s_waitcnt lgkmcnt(3)
    v_smfmac_f32_16x16x64_bf16 v[112:115], v[72:75], a[64:71], v2
    buffer_load_dword v13, v11, s[4:7], s38 offen
    ds_read_b128 v[104:107], v7 offset:6144
    s_and_b32 s39, s45, 3
    v_smfmac_f32_16x16x64_bf16 v[116:119], v[72:75], a[72:79], v2
    s_waitcnt vmcnt(5)
    ds_read_b128 v[108:111], v7 offset:7168
    s_lshl_b32 s49, s39, 13
    s_waitcnt lgkmcnt(4)
    v_smfmac_f32_16x16x64_bf16 v[112:115], v[76:79], a[80:87], v2
    ds_read_b128 v[48:51], v0 offset:16384
    s_add_u32 s49, s49, 0x100000
    v_smfmac_f32_16x16x64_bf16 v[116:119], v[76:79], a[88:95], v2
    ds_read_b128 v[52:55], v0 offset:20480
    s_add_u32 s85, s49, s69
    s_waitcnt lgkmcnt(5)
    v_smfmac_f32_16x16x64_bf16 v[112:115], v[80:83], a[96:103], v2
    ds_read_b128 v[56:59], v0 offset:17408
    s_xor_b32 s56, s49, 0x4000
    v_smfmac_f32_16x16x64_bf16 v[116:119], v[80:83], a[104:111], v2
    ds_read_b128 v[60:63], v0 offset:21504
    s_xor_b32 s55, s55, 1
    s_waitcnt lgkmcnt(6)
    v_smfmac_f32_16x16x64_bf16 v[112:115], v[84:87], a[112:119], v2
    v_smfmac_f32_16x16x64_bf16 v[116:119], v[84:87], a[120:127], v2
    v_smfmac_f32_16x16x64_bf16 v[88:91], v[64:67], v[32:39], v2
    v_add_f32 v112, v112, v114
    v_smfmac_f32_16x16x64_bf16 v[92:95], v[64:67], v[40:47], v2
    ds_read_b128 v[32:35], v7 offset:8192
    v_add_f32 v113, v113, v115
    v_smfmac_f32_16x16x64_bf16 v[88:91], v[68:71], v[96:103], v2
    ds_read_b128 v[36:39], v7 offset:9216
    s_waitcnt lgkmcnt(6)
    v_cvt_pk_bf16_f32 v114, v112, v113
    v_smfmac_f32_16x16x64_bf16 v[92:95], v[68:71], v[104:111], v2
    ds_read_b128 v[40:43], v7 offset:10240
    v_add_f32 v116, v116, v118
    v_smfmac_f32_16x16x64_bf16 v[88:91], v[72:75], a[160:167], v2
    ds_read_b128 v[44:47], v7 offset:11264
    v_add_f32 v117, v117, v119
    v_smfmac_f32_16x16x64_bf16 v[92:95], v[72:75], a[168:175], v2
    ds_read_b128 v[96:99], v7 offset:12288
    v_cvt_pk_bf16_f32 v115, v116, v117
    v_smfmac_f32_16x16x64_bf16 v[88:91], v[76:79], a[176:183], v2
    ds_write2st64_b32 v3, v114, v115 offset0:0 offset1:1
    v_smfmac_f32_16x16x64_bf16 v[92:95], v[76:79], a[184:191], v2
    ds_read_b128 v[100:103], v7 offset:13312
    v_smfmac_f32_16x16x64_bf16 v[88:91], v[80:83], a[192:199], v2
    ds_read_b128 v[104:107], v7 offset:14336
    v_mov_b64_e64 v[112:113], 0
    v_smfmac_f32_16x16x64_bf16 v[92:95], v[80:83], a[200:207], v2
    ds_read_b128 v[108:111], v7 offset:15360
    v_mov_b64_e64 v[114:115], 0
    v_smfmac_f32_16x16x64_bf16 v[88:91], v[84:87], a[208:215], v2
    s_waitcnt lgkmcnt(3)
    s_barrier
    v_mov_b64_e64 v[116:117], 0
    v_smfmac_f32_16x16x64_bf16 v[92:95], v[84:87], a[216:223], v2
    s_cmp_eq_u32 s45, 63
    s_cselect_b32 s50, 0x40000000, s50
    v_mov_b64_e64 v[118:119], 0
    v_smfmac_f32_16x16x64_bf16 v[120:123], v[64:67], v[32:39], v2
    v_add_f32 v88, v88, v90
    v_smfmac_f32_16x16x64_bf16 v[124:127], v[64:67], v[40:47], v2
    ds_read_b64_tr_b16 v[64:65], v4 offset:0
    s_waitcnt lgkmcnt(3)
    v_add_f32 v89, v89, v91
    v_smfmac_f32_16x16x64_bf16 v[120:123], v[68:71], v[96:103], v2
    ds_read_b64_tr_b16 v[66:67], v4 offset:128
    ds_read_b128 v[32:35], v0 offset:18432
    s_waitcnt lgkmcnt(3)
    v_cvt_pk_bf16_f32 v90, v88, v89
    v_smfmac_f32_16x16x64_bf16 v[124:127], v[68:71], v[104:111], v2
    ds_read_b64_tr_b16 v[68:69], v4 offset:512
    ds_read_b128 v[36:39], v0 offset:22528
    v_add_f32 v92, v92, v94
    v_smfmac_f32_16x16x64_bf16 v[120:123], v[72:75], v[160:167], v2
    ds_read_b64_tr_b16 v[70:71], v4 offset:640
    ds_read_b128 v[40:43], v0 offset:19456
    v_add_f32 v93, v93, v95
    v_smfmac_f32_16x16x64_bf16 v[124:127], v[72:75], v[168:175], v2
    ds_read_b64_tr_b16 v[72:73], v4 offset:1024
    ds_read_b128 v[44:47], v0 offset:23552
    v_cvt_pk_bf16_f32 v91, v92, v93
    v_smfmac_f32_16x16x64_bf16 v[120:123], v[76:79], v[176:183], v2
    ds_write2st64_b32 v1, v90, v91 offset0:0 offset1:2
    v_smfmac_f32_16x16x64_bf16 v[124:127], v[76:79], v[184:191], v2
    ds_read_b64_tr_b16 v[74:75], v4 offset:1152
    buffer_store_dword v90, v3, s[4:7], s50 offen sc1
    v_smfmac_f32_16x16x64_bf16 v[120:123], v[80:83], v[192:199], v2
    ds_read_b64_tr_b16 v[76:77], v4 offset:1536
    buffer_store_dword v91, v3, s[4:7], s50 offen offset:256 sc1
    v_smfmac_f32_16x16x64_bf16 v[124:127], v[80:83], v[200:207], v2
    ds_read_b64_tr_b16 v[78:79], v4 offset:1664
    v_smfmac_f32_16x16x64_bf16 v[120:123], v[84:87], v[208:215], v2
    s_waitcnt lgkmcnt(3)
    s_barrier
    ds_read_b64_tr_b16 v[80:81], v21 offset:2048
    v_smfmac_f32_16x16x64_bf16 v[124:127], v[84:87], v[216:223], v2
    ds_read_b64_tr_b16 v[82:83], v21 offset:2304
    v_mfma_f32_16x16x32_bf16 v[96:99], v[48:51], v[64:67], 0
    ds_read_b64_tr_b16 v[84:85], v21 offset:3072
    v_add_f32 v120, v120, v122
    v_mfma_f32_16x16x32_bf16 v[100:103], v[52:55], v[64:67], 0
    ds_read_b64_tr_b16 v[86:87], v21 offset:3328
    v_add_f32 v121, v121, v123
    v_mfma_f32_16x16x32_bf16 v[96:99], v[56:59], v[68:71], v[96:99]
    ds_read_b64_tr_b16 v[88:89], v21 offset:6144
    v_cvt_pk_bf16_f32 v30, v120, v121
    v_mfma_f32_16x16x32_bf16 v[100:103], v[60:63], v[68:71], v[100:103]
    ds_read_b64_tr_b16 v[90:91], v21 offset:6400
    v_add_f32 v124, v124, v126
    s_waitcnt lgkmcnt(6)
    v_mfma_f32_16x16x32_bf16 v[96:99], v[32:35], v[72:75], v[96:99]
    ds_read_b64_tr_b16 v[92:93], v21 offset:7168
    v_add_f32 v125, v125, v127
    v_mfma_f32_16x16x32_bf16 v[100:103], v[36:39], v[72:75], v[100:103]
    ds_read_b64_tr_b16 v[94:95], v21 offset:7424
    v_cvt_pk_bf16_f32 v20, v124, v125
    v_mfma_f32_16x16x32_bf16 v[96:99], v[40:43], v[76:79], v[96:99]
    buffer_store_dword v30, v3, s[4:7], s50 offen offset:2048 sc1
    buffer_store_dword v20, v3, s[4:7], s50 offen offset:2304 sc1
    v_mfma_f32_16x16x32_bf16 v[100:103], v[44:47], v[76:79], v[100:103]
    s_cmp_eq_u32 s45, 63
    s_cbranch_scc1 L_last_f
    s_waitcnt lgkmcnt(4)
    v_mfma_f32_16x16x32_bf16 v[104:107], v[80:83], v[64:67], 0
    ds_read_b128 v[48:51], v7 offset:16384
    v_mfma_f32_16x16x32_bf16 v[104:107], v[84:87], v[68:71], v[104:107]
    ds_read_b128 v[52:55], v7 offset:17408
    v_max3_f32 v14, v96, v97, v98
    s_waitcnt lgkmcnt(2)
    v_mfma_f32_16x16x32_bf16 v[104:107], v[88:91], v[72:75], v[104:107]
    ds_read_b128 v[56:59], v7 offset:18432
    v_max3_f32 v15, v99, v100, v101
    v_mfma_f32_16x16x32_bf16 v[104:107], v[92:95], v[76:79], v[104:107]
    ds_read_b128 v[60:63], v7 offset:19456
    v_max3_f32 v14, v14, v102, v103
    s_waitcnt vmcnt(7)
    ds_read_b128 v[80:83], v6 offset:16384
    ds_read_b128 v[84:87], v6 offset:17408
    ds_read_b128 v[32:35], v7 offset:20480
    ds_read_b128 v[36:39], v7 offset:21504
    v_mov_b64 v[122:123], 0
    v_max3_f32 v14, v14, v15, v104
    v_max_f32 v106, v14, v105
    v_max_f32 v107, v14, v105
    ds_read_b128 v[40:43], v7 offset:22528
    v_mov_b64_e64 v[120:121], 0
    v_permlane16_swap_b32 v106, v107
    v_max_f32_e64 v14, v106, v107
    v_max_f32_e64 v15, v106, v107
    ds_read_b128 v[44:47], v7 offset:23552
    s_nop 0
    v_permlane32_swap_b32 v14, v15
    v_max_f32_e64 v14, v14, v15
    v_mul_f32_e64 v14, s53, v14
    v_pk_fma_f32 v[96:97], v[96:97], s[52:53], v[14:15] op_sel_hi:[1,0,0]
    v_pk_fma_f32 v[98:99], v[98:99], s[52:53], v[14:15] op_sel_hi:[1,0,0]
    v_exp_f32 v96, v96
    v_exp_f32 v97, v97
    v_pk_fma_f32 v[100:101], v[100:101], s[52:53], v[14:15] op_sel_hi:[1,0,0]
    v_exp_f32 v98, v98
    v_cvt_pk_bf16_f32 v124, v96, v97
    v_exp_f32 v99, v99
    v_pk_fma_f32 v[102:103], v[102:103], s[52:53], v[14:15] op_sel_hi:[1,0,0]
    v_exp_f32 v100, v100
    v_cvt_pk_bf16_f32 v125, v98, v99
    v_exp_f32_e64 v101, v101
    v_pk_fma_f32 v[104:105], v[104:105], s[52:53], v[14:15] op_sel_hi:[1,0,0]
    v_exp_f32_e64 v102, v102
    v_cvt_pk_bf16_f32 v126, v100, v101
    v_exp_f32_e64 v103, v103
    v_exp_f32_e64 v104, v104
    v_cvt_pk_bf16_f32 v127, v102, v103
    v_exp_f32_e64 v105, v105
    s_waitcnt lgkmcnt(4)
    v_mfma_f32_16x16x32_bf16 v[108:111], v[22:25], v[124:127], 0
    v_cvt_pk_bf16_f32 v26, v104, v105
    v_mfma_f32_16x16x32_bf16 v[96:99], v[80:83], v[124:127], 0
    ds_read_b128 v[64:67], v7 offset:24576
    v_mfma_f32_16x16x32_bf16 v[100:103], v[84:87], v[124:127], 0
    v_mfma_f32_16x16x32_bf16 v[108:111], v[22:25], v[26:29], v[108:111]
    v_mfma_f32_16x16x32_bf16 v[96:99], v[30:33], v[26:29], v[96:99]
    v_mov_b64 v[124:125], 0
    v_mfma_f32_16x16x32_bf16 v[100:103], v[20:23], v[26:29], v[100:103]
    ds_read_b128 v[68:71], v7 offset:25600
    v_rcp_f32 v14, v108
    ds_read_b128 v[72:75], v7 offset:26624
    v_mov_b64 v[126:127], 0
    v_pk_mul_f32 v[96:97], v[96:97], v[14:15] op_sel_hi:[1,0]
    v_pk_mul_f32 v[98:99], v[98:99], v[14:15] op_sel_hi:[1,0]
    v_pk_mul_f32 v[100:101], v[100:101], v[14:15] op_sel_hi:[1,0]
    v_cvt_pk_bf16_f32 v104, v96, v97
    v_pk_mul_f32 v[102:103], v[102:103], v[14:15] op_sel_hi:[1,0]
    v_cvt_pk_bf16_f32 v105, v98, v99
    v_cvt_pk_bf16_f32 v106, v100, v101
    v_cvt_pk_bf16_f32 v107, v102, v103
    ds_write_b128 v5, v[104:107] offset:0
    v_xor_b32 v14, 0x200, v5
    v_xor_b32 v15, 0x400, v5
    v_xor_b32 v30, 0x600, v5
    v_smfmac_f32_16x16x64_bf16 v[112:115], v[104:107], a[224:231], v31
    v_smfmac_f32_16x16x64_bf16 v[116:119], v[104:107], a[232:239], v31
    s_waitcnt lgkmcnt(0)
    s_barrier
    ds_read_b128 v[96:99], v14
    ds_read_b128 v[100:103], v15
    ds_read_b128 v[108:111], v30
    v_smfmac_f32_16x16x64_bf16 v[120:123], v[104:107], a[240:247], v31
    ds_read_b128 v[76:79], v7 offset:27648
    ds_read_b128 v[80:83], v7 offset:28672
    v_smfmac_f32_16x16x64_bf16 v[124:127], v[104:107], a[248:255], v31
    ds_read_b128 v[84:87], v7 offset:29696
    ds_read_b128 v[88:91], v7 offset:30720
    s_waitcnt lgkmcnt(6)
    v_smfmac_f32_16x16x64_bf16 v[112:115], v[96:99], v[224:231], v31
    ds_read_b128 v[92:95], v7 offset:31744
    s_waitcnt lgkmcnt(6)
    v_smfmac_f32_16x16x64_bf16 v[112:115], v[100:103], v[232:239], v31
    s_waitcnt lgkmcnt(5)
    v_smfmac_f32_16x16x64_bf16 v[112:115], v[108:111], v[240:247], v31
    v_smfmac_f32_16x16x64_bf16 v[116:119], v[96:99], v[248:255], v31
    v_smfmac_f32_16x16x64_bf16 v[116:119], v[100:103], v[48:55], v31
    v_cvt_pk_bf16_f32 v112, v112, v113
    v_smfmac_f32_16x16x64_bf16 v[116:119], v[108:111], v[56:63], v31
    v_cvt_pk_bf16_f32 v113, v114, v115
    v_smfmac_f32_16x16x64_bf16 v[120:123], v[96:99], v[32:39], v31
    v_and_or_b32 v112, v112, -2, s55
    v_smfmac_f32_16x16x64_bf16 v[120:123], v[100:103], v[40:47], v31
    buffer_store_dwordx2 v[112:113], v8, s[4:7], 0 offen
    v_cvt_pk_bf16_f32 v116, v116, v117
    v_smfmac_f32_16x16x64_bf16 v[120:123], v[108:111], v[64:71], v31
    s_waitcnt lgkmcnt(4)
    v_cvt_pk_bf16_f32 v117, v118, v119
    v_smfmac_f32_16x16x64_bf16 v[124:127], v[96:99], v[72:79], v31
    s_waitcnt lgkmcnt(2)
    v_and_or_b32 v116, v116, -2, s55
    v_smfmac_f32_16x16x64_bf16 v[124:127], v[100:103], v[80:87], v31
    buffer_store_dwordx2 v[116:117], v8, s[4:7], s47 offen
    s_waitcnt lgkmcnt(0)
    v_cvt_pk_bf16_f32 v120, v120, v121
    v_smfmac_f32_16x16x64_bf16 v[124:127], v[108:111], v[88:95], v31
    v_cvt_pk_bf16_f32 v121, v122, v123
    v_and_or_b32 v120, v120, -2, s55
    buffer_store_dwordx2 v[120:121], v8, s[4:7], s70 offen
    s_nop 5
    v_cvt_pk_bf16_f32 v124, v124, v125
    v_cvt_pk_bf16_f32 v125, v126, v127
    v_and_or_b32 v124, v124, -2, s55
    buffer_store_dwordx2 v[124:125], v8, s[4:7], s71 offen
L_red_f:
    s_barrier
    s_cmp_lg_u32 s32, 0
    s_cbranch_scc1 L_notred_40
    v_mov_b64 v[112:113], 0
    v_mov_b64 v[114:115], 0
    v_mov_b64 v[116:117], 0
    v_mov_b64 v[118:119], 0
    v_mov_b64 v[120:121], 0
    v_mov_b64 v[122:123], 0
    v_mov_b64 v[124:125], 0
    v_mov_b64 v[126:127], 0
    v_mov_b64 v[88:89], 0
    v_mov_b64 v[90:91], 0
    v_mov_b64 v[92:93], 0
    v_mov_b64 v[94:95], 0
    v_xor_b32_e64 v11, 1, v11
    s_add_u32 s45, s45, 1
    s_add_u32 s50, s50, 0x20000
    s_add_u32 s51, s51, 0x80000
    s_add_u32 s84, s84, 0x80000
    s_add_u32 s80, s80, 4
    s_cmp_eq_u32 s80, 20
    s_cselect_b32 s80, 0, s80
    s_addc_u32 s81, s81, 0
    s_add_u32 s78, s67, s80
    s_cmp_lt_u32 s45, 62
    s_cselect_b32 s79, s81, 0
    s_mov_b32 s54, 0
    s_sleep 1
    buffer_load_dwordx4 v[32:35], v9, s[4:7], 0 offen offset:0 sc1
    buffer_load_dwordx4 v[36:39], v9, s[4:7], 0 offen offset:1024 sc1
    buffer_load_dwordx4 v[40:43], v9, s[4:7], 0 offen offset:2048 sc1
    buffer_load_dwordx4 v[44:47], v9, s[4:7], 0 offen offset:3072 sc1
    buffer_load_dwordx4 v[48:51], v9, s[4:7], s48 offen offset:0 sc1
    buffer_load_dwordx4 v[52:55], v9, s[4:7], s48 offen offset:1024 sc1
    buffer_load_dwordx4 v[56:59], v9, s[4:7], s48 offen offset:2048 sc1
    buffer_load_dwordx4 v[60:63], v9, s[4:7], s48 offen offset:3072 sc1
    s_sleep 1
    s_sleep 1
    s_sleep 1
    buffer_load_dwordx4 v[64:67], v9, s[4:7], 0 offen offset:0 sc1
    buffer_load_dwordx4 v[68:71], v9, s[4:7], 0 offen offset:1024 sc1
    buffer_load_dwordx4 v[72:75], v9, s[4:7], 0 offen offset:2048 sc1
    buffer_load_dwordx4 v[76:79], v9, s[4:7], 0 offen offset:3072 sc1
    buffer_load_dwordx4 v[80:83], v9, s[4:7], s48 offen offset:0 sc1
    buffer_load_dwordx4 v[84:87], v9, s[4:7], s48 offen offset:1024 sc1
    buffer_load_dwordx4 v[104:107], v9, s[4:7], s48 offen offset:2048 sc1
    buffer_load_dwordx4 v[108:111], v9, s[4:7], s48 offen offset:3072 sc1
    s_waitcnt vmcnt(15)
    v_mfma_f32_16x16x32_bf16 v[96:99], v[32:35], v[16:19], 0
    v_bitop3_b32 v14, v32, v34, v11 bitop3:0x7e
    s_waitcnt vmcnt(14)
    v_mfma_f32_16x16x32_bf16 v[96:99], v[36:39], v[16:19], v[96:99]
    v_bitop3_b32 v15, v36, v38, v11 bitop3:0x7e
    s_waitcnt vmcnt(13)
    v_mfma_f32_16x16x32_bf16 v[96:99], v[40:43], v[16:19], v[96:99]
    v_bitop3_b32 v30, v40, v42, v11 bitop3:0x7e
    v_or3_b32 v14, v14, v15, v30
    s_waitcnt vmcnt(12)
    v_mfma_f32_16x16x32_bf16 v[96:99], v[44:47], v[16:19], v[96:99]
    v_bitop3_b32 v15, v44, v46, v11 bitop3:0x7e
    s_waitcnt vmcnt(11)
    v_mfma_f32_16x16x32_bf16 v[96:99], v[48:51], v[16:19], v[96:99]
    v_bitop3_b32 v30, v48, v50, v11 bitop3:0x7e
    v_or3_b32 v14, v14, v15, v30
    s_waitcnt vmcnt(10)
    v_mfma_f32_16x16x32_bf16 v[96:99], v[52:55], v[16:19], v[96:99]
    v_bitop3_b32 v15, v52, v54, v11 bitop3:0x7e
    s_waitcnt vmcnt(9)
    v_mfma_f32_16x16x32_bf16 v[96:99], v[56:59], v[16:19], v[96:99]
    v_bitop3_b32 v30, v56, v58, v11 bitop3:0x7e
    v_or3_b32 v14, v14, v15, v30
    s_waitcnt vmcnt(8)
    v_mfma_f32_16x16x32_bf16 v[96:99], v[60:63], v[16:19], v[96:99]
    v_bitop3_b32 v15, v60, v62, v11 bitop3:0x7e
    v_bitop3_b32 v14, v14, v15, 1 bitop3:0xa8
    v_cmp_ne_u32 vcc, 0, v14
    s_cbranch_vccnz L_rfail_43
L_redok_42:
    s_cmp_eq_u32 s45, 63
    s_nop 2
    v_cvt_pk_bf16_f32 v100, v96, v97
    v_cvt_pk_bf16_f32 v101, v98, v99
    buffer_store_dwordx2 v[100:101], v10, s[4:7], s49 offen
    s_cbranch_scc1 L_cfq0_f
    s_branch L_top_f
L_rfail_43:
    s_waitcnt vmcnt(7)
    v_mfma_f32_16x16x32_bf16 v[96:99], v[64:67], v[16:19], 0
    v_bitop3_b32 v14, v64, v66, v11 bitop3:0x7e
    s_waitcnt vmcnt(6)
    v_mfma_f32_16x16x32_bf16 v[96:99], v[68:71], v[16:19], v[96:99]
    v_bitop3_b32 v15, v68, v70, v11 bitop3:0x7e
    s_waitcnt vmcnt(5)
    v_mfma_f32_16x16x32_bf16 v[96:99], v[72:75], v[16:19], v[96:99]
    v_bitop3_b32 v30, v72, v74, v11 bitop3:0x7e
    v_or3_b32 v14, v14, v15, v30
    s_waitcnt vmcnt(4)
    v_mfma_f32_16x16x32_bf16 v[96:99], v[76:79], v[16:19], v[96:99]
    v_bitop3_b32 v15, v76, v78, v11 bitop3:0x7e
    s_waitcnt vmcnt(3)
    v_mfma_f32_16x16x32_bf16 v[96:99], v[80:83], v[16:19], v[96:99]
    v_bitop3_b32 v30, v80, v82, v11 bitop3:0x7e
    v_or3_b32 v14, v14, v15, v30
    s_waitcnt vmcnt(2)
    v_mfma_f32_16x16x32_bf16 v[96:99], v[84:87], v[16:19], v[96:99]
    v_bitop3_b32 v15, v84, v86, v11 bitop3:0x7e
    s_waitcnt vmcnt(1)
    v_mfma_f32_16x16x32_bf16 v[96:99], v[104:107], v[16:19], v[96:99]
    v_bitop3_b32 v30, v104, v106, v11 bitop3:0x7e
    v_or3_b32 v14, v14, v15, v30
    s_waitcnt vmcnt(0)
    v_mfma_f32_16x16x32_bf16 v[96:99], v[108:111], v[16:19], v[96:99]
    v_bitop3_b32 v15, v108, v110, v11 bitop3:0x7e
    v_bitop3_b32 v14, v14, v15, 1 bitop3:0xa8
    v_cmp_ne_u32 vcc, 0, v14
    s_cbranch_vccz L_redok_42
    buffer_load_dwordx4 v[32:35], v9, s[4:7], 0 offen offset:0 sc1
    buffer_load_dwordx4 v[36:39], v9, s[4:7], 0 offen offset:1024 sc1
    buffer_load_dwordx4 v[40:43], v9, s[4:7], 0 offen offset:2048 sc1
    buffer_load_dwordx4 v[44:47], v9, s[4:7], 0 offen offset:3072 sc1
    buffer_load_dwordx4 v[48:51], v9, s[4:7], s48 offen offset:0 sc1
    buffer_load_dwordx4 v[52:55], v9, s[4:7], s48 offen offset:1024 sc1
    buffer_load_dwordx4 v[56:59], v9, s[4:7], s48 offen offset:2048 sc1
    buffer_load_dwordx4 v[60:63], v9, s[4:7], s48 offen offset:3072 sc1
    s_sleep 1
    s_sleep 1
    s_sleep 1
    buffer_load_dwordx4 v[64:67], v9, s[4:7], 0 offen offset:0 sc1
    buffer_load_dwordx4 v[68:71], v9, s[4:7], 0 offen offset:1024 sc1
    buffer_load_dwordx4 v[72:75], v9, s[4:7], 0 offen offset:2048 sc1
    buffer_load_dwordx4 v[76:79], v9, s[4:7], 0 offen offset:3072 sc1
    buffer_load_dwordx4 v[80:83], v9, s[4:7], s48 offen offset:0 sc1
    buffer_load_dwordx4 v[84:87], v9, s[4:7], s48 offen offset:1024 sc1
    buffer_load_dwordx4 v[104:107], v9, s[4:7], s48 offen offset:2048 sc1
    buffer_load_dwordx4 v[108:111], v9, s[4:7], s48 offen offset:3072 sc1
    s_waitcnt vmcnt(15)
    v_mfma_f32_16x16x32_bf16 v[96:99], v[32:35], v[16:19], 0
    v_bitop3_b32 v14, v32, v34, v11 bitop3:0x7e
    s_waitcnt vmcnt(14)
    v_mfma_f32_16x16x32_bf16 v[96:99], v[36:39], v[16:19], v[96:99]
    v_bitop3_b32 v15, v36, v38, v11 bitop3:0x7e
    s_waitcnt vmcnt(13)
    v_mfma_f32_16x16x32_bf16 v[96:99], v[40:43], v[16:19], v[96:99]
    v_bitop3_b32 v30, v40, v42, v11 bitop3:0x7e
    v_or3_b32 v14, v14, v15, v30
    s_waitcnt vmcnt(12)
    v_mfma_f32_16x16x32_bf16 v[96:99], v[44:47], v[16:19], v[96:99]
    v_bitop3_b32 v15, v44, v46, v11 bitop3:0x7e
    s_waitcnt vmcnt(11)
    v_mfma_f32_16x16x32_bf16 v[96:99], v[48:51], v[16:19], v[96:99]
    v_bitop3_b32 v30, v48, v50, v11 bitop3:0x7e
    v_or3_b32 v14, v14, v15, v30
    s_waitcnt vmcnt(10)
    v_mfma_f32_16x16x32_bf16 v[96:99], v[52:55], v[16:19], v[96:99]
    v_bitop3_b32 v15, v52, v54, v11 bitop3:0x7e
    s_waitcnt vmcnt(9)
    v_mfma_f32_16x16x32_bf16 v[96:99], v[56:59], v[16:19], v[96:99]
    v_bitop3_b32 v30, v56, v58, v11 bitop3:0x7e
    v_or3_b32 v14, v14, v15, v30
    s_waitcnt vmcnt(8)
    v_mfma_f32_16x16x32_bf16 v[96:99], v[60:63], v[16:19], v[96:99]
    v_bitop3_b32 v15, v60, v62, v11 bitop3:0x7e
    v_bitop3_b32 v14, v14, v15, 1 bitop3:0xa8
    v_cmp_ne_u32 vcc, 0, v14
    s_cbranch_vccz L_redok_42
L_red_41:
    s_waitcnt vmcnt(7)
    v_mfma_f32_16x16x32_bf16 v[96:99], v[64:67], v[16:19], 0
    buffer_load_dwordx4 v[32:35], v9, s[4:7], 0 offen offset:0 sc1
    v_bitop3_b32 v14, v64, v66, v11 bitop3:0x7e
    s_waitcnt vmcnt(7)
    v_mfma_f32_16x16x32_bf16 v[96:99], v[68:71], v[16:19], v[96:99]
    buffer_load_dwordx4 v[36:39], v9, s[4:7], 0 offen offset:1024 sc1
    v_bitop3_b32 v15, v68, v70, v11 bitop3:0x7e
    s_waitcnt vmcnt(7)
    v_mfma_f32_16x16x32_bf16 v[96:99], v[72:75], v[16:19], v[96:99]
    buffer_load_dwordx4 v[40:43], v9, s[4:7], 0 offen offset:2048 sc1
    v_bitop3_b32 v30, v72, v74, v11 bitop3:0x7e
    v_or3_b32 v14, v14, v15, v30
    s_waitcnt vmcnt(7)
    v_mfma_f32_16x16x32_bf16 v[96:99], v[76:79], v[16:19], v[96:99]
    buffer_load_dwordx4 v[44:47], v9, s[4:7], 0 offen offset:3072 sc1
    v_bitop3_b32 v15, v76, v78, v11 bitop3:0x7e
    s_waitcnt vmcnt(7)
    v_mfma_f32_16x16x32_bf16 v[96:99], v[80:83], v[16:19], v[96:99]
    buffer_load_dwordx4 v[48:51], v9, s[4:7], s48 offen offset:0 sc1
    v_bitop3_b32 v30, v80, v82, v11 bitop3:0x7e
    v_or3_b32 v14, v14, v15, v30
    s_waitcnt vmcnt(7)
    v_mfma_f32_16x16x32_bf16 v[96:99], v[84:87], v[16:19], v[96:99]
    buffer_load_dwordx4 v[52:55], v9, s[4:7], s48 offen offset:1024 sc1
    v_bitop3_b32 v15, v84, v86, v11 bitop3:0x7e
    s_waitcnt vmcnt(7)
    v_mfma_f32_16x16x32_bf16 v[96:99], v[104:107], v[16:19], v[96:99]
    buffer_load_dwordx4 v[56:59], v9, s[4:7], s48 offen offset:2048 sc1
    v_bitop3_b32 v30, v104, v106, v11 bitop3:0x7e
    v_or3_b32 v14, v14, v15, v30
    s_waitcnt vmcnt(7)
    v_mfma_f32_16x16x32_bf16 v[96:99], v[108:111], v[16:19], v[96:99]
    buffer_load_dwordx4 v[60:63], v9, s[4:7], s48 offen offset:3072 sc1
    v_bitop3_b32 v15, v108, v110, v11 bitop3:0x7e
    v_bitop3_b32 v14, v14, v15, 1 bitop3:0xa8
    v_cmp_ne_u32 vcc, 0, v14
    s_cbranch_vccz L_redok2_44
    s_waitcnt vmcnt(7)
    v_mfma_f32_16x16x32_bf16 v[96:99], v[32:35], v[16:19], 0
    buffer_load_dwordx4 v[64:67], v9, s[4:7], 0 offen offset:0 sc1
    v_bitop3_b32 v14, v32, v34, v11 bitop3:0x7e
    s_waitcnt vmcnt(7)
    v_mfma_f32_16x16x32_bf16 v[96:99], v[36:39], v[16:19], v[96:99]
    buffer_load_dwordx4 v[68:71], v9, s[4:7], 0 offen offset:1024 sc1
    v_bitop3_b32 v15, v36, v38, v11 bitop3:0x7e
    s_waitcnt vmcnt(7)
    v_mfma_f32_16x16x32_bf16 v[96:99], v[40:43], v[16:19], v[96:99]
    buffer_load_dwordx4 v[72:75], v9, s[4:7], 0 offen offset:2048 sc1
    v_bitop3_b32 v30, v40, v42, v11 bitop3:0x7e
    v_or3_b32 v14, v14, v15, v30
    s_waitcnt vmcnt(7)
    v_mfma_f32_16x16x32_bf16 v[96:99], v[44:47], v[16:19], v[96:99]
    buffer_load_dwordx4 v[76:79], v9, s[4:7], 0 offen offset:3072 sc1
    v_bitop3_b32 v15, v44, v46, v11 bitop3:0x7e
    s_waitcnt vmcnt(7)
    v_mfma_f32_16x16x32_bf16 v[96:99], v[48:51], v[16:19], v[96:99]
    buffer_load_dwordx4 v[80:83], v9, s[4:7], s48 offen offset:0 sc1
    v_bitop3_b32 v30, v48, v50, v11 bitop3:0x7e
    v_or3_b32 v14, v14, v15, v30
    s_waitcnt vmcnt(7)
    v_mfma_f32_16x16x32_bf16 v[96:99], v[52:55], v[16:19], v[96:99]
    buffer_load_dwordx4 v[84:87], v9, s[4:7], s48 offen offset:1024 sc1
    v_bitop3_b32 v15, v52, v54, v11 bitop3:0x7e
    s_waitcnt vmcnt(7)
    v_mfma_f32_16x16x32_bf16 v[96:99], v[56:59], v[16:19], v[96:99]
    buffer_load_dwordx4 v[104:107], v9, s[4:7], s48 offen offset:2048 sc1
    v_bitop3_b32 v30, v56, v58, v11 bitop3:0x7e
    v_or3_b32 v14, v14, v15, v30
    s_waitcnt vmcnt(7)
    v_mfma_f32_16x16x32_bf16 v[96:99], v[60:63], v[16:19], v[96:99]
    buffer_load_dwordx4 v[108:111], v9, s[4:7], s48 offen offset:3072 sc1
    v_bitop3_b32 v15, v60, v62, v11 bitop3:0x7e
    v_bitop3_b32 v14, v14, v15, 1 bitop3:0xa8
    v_cmp_ne_u32 vcc, 0, v14
    s_cbranch_vccz L_redok2_44
    s_add_u32 s54, s54, 1
    s_cmp_lg_u32 s41, 0
    s_cbranch_scc1 L_redok2_44
    s_cmp_lt_u32 s54, 65536
    s_cbranch_scc1 L_red_41
    s_mov_b32 s41, 1
L_redok2_44:
    s_waitcnt vmcnt(0)
    s_branch L_redok_42
L_notred_40:
    s_mov_b32 s54, 0
    s_waitcnt vmcnt(10)
    v_readfirstlane_b32 s35, v12
    v_mov_b64 v[112:113], 0
    v_mov_b64 v[114:115], 0
    v_mov_b64 v[116:117], 0
    v_mov_b64 v[118:119], 0
    v_mov_b64 v[120:121], 0
    v_mov_b64 v[122:123], 0
    v_mov_b64 v[124:125], 0
    v_mov_b64 v[126:127], 0
    v_mov_b64 v[88:89], 0
    v_mov_b64 v[90:91], 0
    v_mov_b64 v[92:93], 0
    v_mov_b64 v[94:95], 0
    s_cmp_ge_u32 s35, s79
    s_cbranch_scc1 L_fok_45
    s_cmp_lg_u32 s41, 0
    s_cbranch_scc1 L_fok_45
    s_mov_b32 s54, 0
L_fsp_46:
    buffer_load_dword v12, off, s[4:7], s78 sc1
    s_waitcnt vmcnt(0)
    v_readfirstlane_b32 s35, v12
    s_cmp_ge_u32 s35, s79
    s_cbranch_scc1 L_fok_45
    s_sleep 1
    s_add_u32 s54, s54, 1
    s_cmp_lt_u32 s54, 131072
    s_cbranch_scc1 L_fsp_46
    s_mov_b32 s41, 1
L_fok_45:
    s_sub_u32 s35, s45, 57
    s_cmp_lt_u32 s35, 6
    s_cbranch_scc1 L_cfa_f
L_cfar_f:
    s_add_u32 s45, s45, 1
    s_add_u32 s50, s50, 0x20000
    s_add_u32 s51, s51, 0x80000
    s_add_u32 s84, s84, 0x80000
    s_add_u32 s80, s80, 4
    s_cmp_eq_u32 s80, 20
    s_cselect_b32 s80, 0, s80
    s_addc_u32 s81, s81, 0
    s_add_u32 s78, s67, s80
    s_cmp_lt_u32 s45, 62
    s_cselect_b32 s79, s81, 0
    s_cmp_eq_u32 s45, 62
    s_cselect_b32 s78, 0x121f80, s78
    s_cselect_b32 s79, 32, s79
    s_cmp_eq_u32 s45, 63
    s_cselect_b32 s84, 0x40000000, s84
    s_cselect_b32 s78, 0x40000000, s78
    buffer_store_dwordx4 v[16:19], v10, s[4:7], s56 offen
    s_branch L_top_f
L_retry0_f:
    s_mov_b64 exec, vcc
    buffer_load_dwordx4 v[48:51], v0, s[4:7], s85 offen sc1
    buffer_load_dwordx4 v[52:55], v0, s[4:7], s85 offen offset:1024 sc1
    s_mov_b64 exec, -1
    s_nop 3
    v_mov_b64 v[112:113], 0
    v_mov_b64 v[114:115], 0
    v_mov_b64 v[116:117], 0
    v_mov_b64 v[118:119], 0
    s_waitcnt vmcnt(2)
    ds_write_b128 v6, v[56:59]
    v_max3_u32 v64, v56, v58, v60
    ds_write_b128 v6, v[60:63] offset:1024
    v_max_u32 v64, v64, v62
    v_cmp_eq_u32 vcc, -1, v64
    s_add_u32 s54, s54, 1
    s_cbranch_vccz L_own1_f
    s_mov_b64 exec, vcc
    buffer_load_dwordx4 v[56:59], v0, s[4:7], s85 offen sc1
    buffer_load_dwordx4 v[60:63], v0, s[4:7], s85 offen offset:1024 sc1
    s_mov_b64 exec, -1
    s_cmp_lg_u32 s41, 0
    s_cbranch_scc1 L_own1_f
    s_cmp_lt_u32 s54, 65536
    s_cbranch_scc1 L_spec_f
    s_mov_b32 s41, 1
L_own1_f:
    v_smfmac_f32_16x16x64_bf16 v[112:115], v[56:59], a[0:7], v2
    v_smfmac_f32_16x16x64_bf16 v[116:119], v[56:59], a[8:15], v2
    v_smfmac_f32_16x16x64_bf16 v[112:115], v[60:63], a[16:23], v2
    v_smfmac_f32_16x16x64_bf16 v[116:119], v[60:63], a[24:31], v2
    s_waitcnt lgkmcnt(0)
    s_barrier
    v_smfmac_f32_16x16x64_bf16 v[88:91], v[56:59], a[128:135], v2
    ds_read_b128 v[64:67], v14 offset:0
    v_smfmac_f32_16x16x64_bf16 v[92:95], v[56:59], a[136:143], v2
    ds_read_b128 v[68:71], v14 offset:1024
    v_smfmac_f32_16x16x64_bf16 v[88:91], v[60:63], a[144:151], v2
    ds_read_b128 v[72:75], v15 offset:0
    v_smfmac_f32_16x16x64_bf16 v[92:95], v[60:63], a[152:159], v2
    ds_read_b128 v[76:79], v15 offset:1024
    v_smfmac_f32_16x16x64_bf16 v[120:123], v[56:59], v[128:135], v2
    s_add_u32 s38, s51, 8192
    ds_read_b128 v[80:83], v30 offset:0
    v_smfmac_f32_16x16x64_bf16 v[124:127], v[56:59], v[136:143], v2
    buffer_load_dwordx4 v0, s[4:7], s38 offen lds
    ds_read_b128 v[84:87], v30 offset:1024
    v_smfmac_f32_16x16x64_bf16 v[120:123], v[60:63], v[144:151], v2
    buffer_load_dwordx4 v0, s[4:7], s38 offen offset:1024 lds
    v_smfmac_f32_16x16x64_bf16 v[124:127], v[60:63], v[152:159], v2
    s_branch L_common_f
L_cfa_f:
    s_cmp_eq_u32 s45, 62
    s_cbranch_scc1 L_cfq_47
    s_add_u32 s35, s45, 3
    s_and_b32 s35, s35, 3
    s_lshl_b32 s35, s35, 18
    s_add_u32 s35, s35, 0x97e000
    s_cmp_eq_u32 s45, 61
    s_cselect_b32 s35, 0x3f3e000, s35
    s_lshl_b32 s36, s44, 13
    s_sub_u32 s35, s35, s36
    s_cmp_eq_u32 s32, 1
    s_cselect_b32 s84, s35, s84
    s_branch L_cfar_f
L_cfq_47:
    s_lshl_b32 s35, s44, 13
    s_lshr_b32 s36, s32, 1
    s_lshl_b32 s36, s36, 12
    s_add_u32 s35, s35, s36
    s_and_b32 s36, s32, 1
    s_lshl_b32 s36, s36, 7
    s_add_u32 s35, s35, s36
    s_add_u32 s35, s35, 0x3fc0000
    v_and_b32 v14, 0x370, v0
    buffer_load_dwordx4 a[0:3], v14, s[4:7], s35 offen offset:0
    buffer_load_dwordx4 a[4:7], v14, s[4:7], s35 offen offset:1024
    buffer_load_dwordx4 a[8:11], v14, s[4:7], s35 offen offset:2048
    buffer_load_dwordx4 a[12:15], v14, s[4:7], s35 offen offset:3072
    s_branch L_cfar_f
L_cfq0_f:
    s_lshl_b32 s35, s44, 13
    s_lshr_b32 s36, s32, 1
    s_lshl_b32 s36, s36, 12
    s_add_u32 s35, s35, s36
    s_and_b32 s36, s32, 1
    s_lshl_b32 s36, s36, 7
    s_add_u32 s35, s35, s36
    s_add_u32 s35, s35, 0x3fc0000
    v_and_b32 v14, 0x370, v0
    buffer_load_dwordx4 a[0:3], v14, s[4:7], s35 offen offset:0
    buffer_load_dwordx4 a[4:7], v14, s[4:7], s35 offen offset:1024
    buffer_load_dwordx4 a[8:11], v14, s[4:7], s35 offen offset:2048
    buffer_load_dwordx4 a[12:15], v14, s[4:7], s35 offen offset:3072
    s_branch L_top_f
L_last_f:
    s_lshl_b32 s35, s32, 9
    v_lshrrev_b32 v113, 2, v0
    v_add_u32 v112, s35, v113
    ds_write_b32 v112, v30 offset:4096
    ds_write_b32 v112, v20 offset:4352
    v_bfe_u32 v114, v0, 4, 3
    v_lshrrev_b32 v115, 6, v0
    v_and_b32 v115, 12, v115
    v_sub_u32 v114, v114, v115
    s_lshl_b32 s35, s32, 3
    v_add_u32 v114, s35, v114
    s_mov_b32 s30, 0x200000
    s_mov_b32 s31, 0x00020000
    s_waitcnt vmcnt(4) lgkmcnt(0)
    s_barrier
    v_mfma_f32_16x16x32_bf16 v[96:99], v[48:51], a[0:3], 0
    ds_read_b32 v64, v113 offset:4096
    v_cmp_le_i32 s[12:13], 0, v114
    v_mfma_f32_16x16x32_bf16 v[100:103], v[52:55], a[0:3], 0
    ds_read_b32 v66, v113 offset:4352
    v_cmp_le_i32 s[14:15], 1, v114
    v_mfma_f32_16x16x32_bf16 v[96:99], v[56:59], a[4:7], v[96:99]
    ds_read_b32 v68, v113 offset:4608
    v_cmp_le_i32 s[16:17], 2, v114
    v_mfma_f32_16x16x32_bf16 v[100:103], v[60:63], a[4:7], v[100:103]
    ds_read_b32 v70, v113 offset:4864
    v_cmp_le_i32 s[18:19], 3, v114
    v_mfma_f32_16x16x32_bf16 v[96:99], v[32:35], a[8:11], v[96:99]
    ds_read_b32 v72, v113 offset:5120
    v_cmp_le_i32 s[20:21], 16, v114
    v_mfma_f32_16x16x32_bf16 v[100:103], v[36:39], a[8:11], v[100:103]
    ds_read_b32 v74, v113 offset:5376
    v_cmp_le_i32 s[22:23], 17, v114
    v_mfma_f32_16x16x32_bf16 v[96:99], v[40:43], a[12:15], v[96:99]
    ds_read_b32 v76, v113 offset:5632
    v_cmp_le_i32 s[24:25], 18, v114
    v_mfma_f32_16x16x32_bf16 v[100:103], v[44:47], a[12:15], v[100:103]
    ds_read_b32 v78, v113 offset:5888
    v_cmp_le_i32 s[26:27], 19, v114
    v_mfma_f32_16x16x32_bf16 v[104:107], v[80:83], a[0:3], 0
    s_waitcnt lgkmcnt(0)
    ds_read_b128 a[160:163], v0 offset:24576
    ds_read_b128 a[164:167], v0 offset:25600
    v_mov_b32 v65, 0
    v_mov_b32 v67, 0
    v_mfma_f32_16x16x32_bf16 v[104:107], v[84:87], a[4:7], v[104:107]
    ds_read_b128 a[168:171], v0 offset:26624
    ds_read_b128 a[172:175], v0 offset:27648
    v_mov_b32 v69, 0
    v_mov_b32 v71, 0
    v_mfma_f32_16x16x32_bf16 v[104:107], v[88:91], a[8:11], v[104:107]
    ds_read_b128 a[176:179], v0 offset:28672
    ds_read_b128 a[180:183], v0 offset:29696
    v_mov_b32 v73, 0
    v_mov_b32 v75, 0
    v_mfma_f32_16x16x32_bf16 v[104:107], v[92:95], a[12:15], v[104:107]
    ds_read_b128 a[184:187], v0 offset:30720
    ds_read_b128 a[188:191], v0 offset:31744
    v_mov_b32 v77, 0
    v_mov_b32 v79, 0
    v_mov_b32 v112, 0xff800000
    v_cndmask_b32 v96, v112, v96, s[12:13]
    v_cndmask_b32 v97, v112, v97, s[14:15]
    v_cndmask_b32 v98, v112, v98, s[16:17]
    v_cndmask_b32 v99, v112, v99, s[18:19]
    v_cndmask_b32 v100, v112, v100, s[20:21]
    v_cndmask_b32 v101, v112, v101, s[22:23]
    v_cndmask_b32 v102, v112, v102, s[24:25]
    v_cndmask_b32 v103, v112, v103, s[26:27]
    v_max3_f32 v14, v96, v97, v98
    v_max3_f32 v15, v99, v100, v101
    v_max3_f32 v14, v14, v102, v103
    v_max3_f32 v14, v14, v15, v104
    v_max_f32 v112, v14, v105
    v_max_f32 v115, v14, v105
    v_mov_b64 v[128:129], 0
    v_mov_b64 v[130:131], 0
    v_permlane16_swap_b32 v112, v115
    v_max_f32 v14, v112, v115
    v_max_f32 v15, v112, v115
    v_mov_b64 v[132:133], 0
    v_mov_b64 v[134:135], 0
    v_permlane32_swap_b32 v14, v15
    v_max_f32 v14, v14, v15
    v_mul_f32 v14, s53, v14
    s_waitcnt lgkmcnt(0)
    v_pk_fma_f32 v[96:97], v[96:97], s[52:53], v[14:15] op_sel_hi:[1,0,0]
    ds_read_b128 a[96:99], v7 offset:16384
    v_pk_fma_f32 v[98:99], v[98:99], s[52:53], v[14:15] op_sel_hi:[1,0,0]
    ds_read_b128 a[100:103], v7 offset:17408
    v_pk_fma_f32 v[100:101], v[100:101], s[52:53], v[14:15] op_sel_hi:[1,0,0]
    ds_read_b128 a[104:107], v7 offset:18432
    v_pk_fma_f32 v[102:103], v[102:103], s[52:53], v[14:15] op_sel_hi:[1,0,0]
    ds_read_b128 a[108:111], v7 offset:19456
    v_pk_fma_f32 v[104:105], v[104:105], s[52:53], v[14:15] op_sel_hi:[1,0,0]
    ds_read_b128 a[112:115], v7 offset:20480
    v_exp_f32 v96, v96
    ds_read_b128 a[116:119], v7 offset:21504
    v_exp_f32 v97, v97
    ds_read_b128 a[120:123], v7 offset:22528
    v_exp_f32 v98, v98
    v_cvt_pk_bf16_f32 v124, v96, v97
    ds_read_b128 a[124:127], v7 offset:23552
    v_exp_f32 v99, v99
    ds_read_b128 a[128:131], v7 offset:24576
    v_exp_f32 v100, v100
    v_cvt_pk_bf16_f32 v125, v98, v99
    ds_read_b128 a[132:135], v7 offset:25600
    v_exp_f32 v101, v101
    ds_read_b128 a[136:139], v7 offset:26624
    v_exp_f32 v102, v102
    v_cvt_pk_bf16_f32 v126, v100, v101
    ds_read_b128 a[140:143], v7 offset:27648
    v_exp_f32 v103, v103
    ds_read_b128 a[144:147], v7 offset:28672
    v_exp_f32 v104, v104
    v_cvt_pk_bf16_f32 v127, v102, v103
    v_exp_f32 v105, v105
    v_mfma_f32_16x16x32_bf16 v[120:123], v[22:25], v[124:127], 0
    v_cvt_pk_bf16_f32 v26, v104, v105
    v_mfma_f32_16x16x32_bf16 v[192:195], a[160:163], v[124:127], 0
    v_and_b32 v112, 0x1ff, v5
    ds_read_b128 a[148:151], v7 offset:29696
    v_mfma_f32_16x16x32_bf16 v[196:199], a[164:167], v[124:127], 0
    v_mfma_f32_16x16x32_bf16 v[120:123], v[22:25], v[26:29], v[120:123]
    s_lshl_b32 s35, s32, 11
    v_add_u32 v112, s35, v112
    ds_read_b128 a[152:155], v7 offset:30720
    v_mfma_f32_16x16x32_bf16 v[200:203], a[168:171], v[124:127], 0
    v_mov_b64 v[136:137], 0
    ds_read_b128 a[156:159], v7 offset:31744
    v_mfma_f32_16x16x32_bf16 v[204:207], a[172:175], v[124:127], 0
    v_mov_b64 v[138:139], 0
    v_mfma_f32_16x16x32_bf16 v[208:211], a[176:179], v[124:127], 0
    v_mov_b64 v[140:141], 0
    v_mfma_f32_16x16x32_bf16 v[212:215], a[180:183], v[124:127], 0
    v_rcp_f32 v14, v120
    v_mfma_f32_16x16x32_bf16 v[216:219], a[184:187], v[124:127], 0
    v_mov_b64 v[142:143], 0
    v_mfma_f32_16x16x32_bf16 v[220:223], a[188:191], v[124:127], 0
    v_mov_b64 v[144:145], 0
    v_mfma_f32_16x16x32_bf16 v[192:195], v[64:67], v[26:29], v[192:195]
    v_mov_b64 v[146:147], 0
    v_mov_b64 v[148:149], 0
    v_mfma_f32_16x16x32_bf16 v[196:199], v[66:69], v[26:29], v[196:199]
    v_mov_b64 v[150:151], 0
    v_mov_b64 v[152:153], 0
    v_mfma_f32_16x16x32_bf16 v[200:203], v[68:71], v[26:29], v[200:203]
    v_mov_b64 v[154:155], 0
    v_mov_b64 v[156:157], 0
    v_mfma_f32_16x16x32_bf16 v[204:207], v[70:73], v[26:29], v[204:207]
    v_pk_mul_f32 v[192:193], v[192:193], v[14:15] op_sel_hi:[1,0]
    v_pk_mul_f32 v[194:195], v[194:195], v[14:15] op_sel_hi:[1,0]
    v_mfma_f32_16x16x32_bf16 v[208:211], v[72:75], v[26:29], v[208:211]
    v_cvt_pk_bf16_f32 v96, v192, v193
    v_cvt_pk_bf16_f32 v97, v194, v195
    v_mfma_f32_16x16x32_bf16 v[212:215], v[74:77], v[26:29], v[212:215]
    v_pk_mul_f32 v[196:197], v[196:197], v[14:15] op_sel_hi:[1,0]
    v_pk_mul_f32 v[198:199], v[198:199], v[14:15] op_sel_hi:[1,0]
    v_mfma_f32_16x16x32_bf16 v[216:219], v[76:79], v[26:29], v[216:219]
    v_cvt_pk_bf16_f32 v98, v196, v197
    v_cvt_pk_bf16_f32 v99, v198, v199
    v_mfma_f32_16x16x32_bf16 v[220:223], v[78:81], v[26:29], v[220:223]
    v_pk_mul_f32 v[200:201], v[200:201], v[14:15] op_sel_hi:[1,0]
    v_pk_mul_f32 v[202:203], v[202:203], v[14:15] op_sel_hi:[1,0]
    v_cvt_pk_bf16_f32 v100, v200, v201
    v_cvt_pk_bf16_f32 v101, v202, v203
    v_pk_mul_f32 v[204:205], v[204:205], v[14:15] op_sel_hi:[1,0]
    v_pk_mul_f32 v[206:207], v[206:207], v[14:15] op_sel_hi:[1,0]
    v_cvt_pk_bf16_f32 v102, v204, v205
    v_cvt_pk_bf16_f32 v103, v206, v207
    ds_write_b128 v112, v[96:99] offset:8192
    ds_write_b128 v112, v[100:103] offset:8704
    v_pk_mul_f32 v[208:209], v[208:209], v[14:15] op_sel_hi:[1,0]
    v_pk_mul_f32 v[210:211], v[210:211], v[14:15] op_sel_hi:[1,0]
    v_cvt_pk_bf16_f32 v104, v208, v209
    v_cvt_pk_bf16_f32 v105, v210, v211
    v_pk_mul_f32 v[212:213], v[212:213], v[14:15] op_sel_hi:[1,0]
    v_pk_mul_f32 v[214:215], v[214:215], v[14:15] op_sel_hi:[1,0]
    v_cvt_pk_bf16_f32 v106, v212, v213
    v_cvt_pk_bf16_f32 v107, v214, v215
    ds_write_b128 v112, v[104:107] offset:9216
    v_pk_mul_f32 v[216:217], v[216:217], v[14:15] op_sel_hi:[1,0]
    v_pk_mul_f32 v[218:219], v[218:219], v[14:15] op_sel_hi:[1,0]
    v_cvt_pk_bf16_f32 v108, v216, v217
    v_cvt_pk_bf16_f32 v109, v218, v219
    v_mov_b64 v[158:159], 0
    v_mov_b64 v[160:161], 0
    v_pk_mul_f32 v[220:221], v[220:221], v[14:15] op_sel_hi:[1,0]
    v_pk_mul_f32 v[222:223], v[222:223], v[14:15] op_sel_hi:[1,0]
    v_cvt_pk_bf16_f32 v110, v220, v221
    v_cvt_pk_bf16_f32 v111, v222, v223
    ds_write_b128 v112, v[108:111] offset:9728
    v_xor_b32 v114, 0x200, v5
    v_xor_b32 v115, 0x400, v5
    v_xor_b32 v113, 0x600, v5
    v_mov_b64 v[162:163], 0
    v_mov_b64 v[164:165], 0
    v_mov_b64 v[166:167], 0
    v_mov_b64 v[168:169], 0
    v_mov_b64 v[170:171], 0
    v_mov_b64 v[172:173], 0
    v_mov_b64 v[174:175], 0
    v_mov_b64 v[176:177], 0
    v_mov_b64 v[178:179], 0
    v_mov_b64 v[180:181], 0
    v_mov_b64 v[182:183], 0
    v_mov_b64 v[184:185], 0
    v_mov_b64 v[186:187], 0
    v_mov_b64 v[188:189], 0
    v_mov_b64 v[190:191], 0
    s_waitcnt lgkmcnt(0)
    s_barrier
    ds_read_b128 v[32:35], v5 offset:4096
    ds_read_b128 v[36:39], v114 offset:4096
    ds_read_b128 v[40:43], v115 offset:4096
    ds_read_b128 v[44:47], v113 offset:4096
    ds_read_b128 v[48:51], v5 offset:6144
    ds_read_b128 v[52:55], v114 offset:6144
    ds_read_b128 v[56:59], v115 offset:6144
    ds_read_b128 v[60:63], v113 offset:6144
    v_mov_b32 v116, 0x3f80
    s_waitcnt lgkmcnt(7)
    v_smfmac_f32_16x16x64_bf16 v[128:131], v[32:35], a[224:231], v31
    v_bfe_u32 v15, v0, 4, 4
    v_smfmac_f32_16x16x64_bf16 v[132:135], v[32:35], a[232:239], v31
    v_and_b32 v14, 1, v15
    v_smfmac_f32_16x16x64_bf16 v[136:139], v[32:35], a[240:247], v31
    v_lshlrev_b32 v14, 4, v14
    v_smfmac_f32_16x16x64_bf16 v[140:143], v[32:35], a[248:255], v31
    s_waitcnt lgkmcnt(6)
    v_lshlrev_b32 v14, v14, v116
    v_smfmac_f32_16x16x64_bf16 v[128:131], v[36:39], v[224:231], v31
    ds_read_b128 v[64:67], v5 offset:8192
    v_lshrrev_b32 v15, 1, v15
    v_smfmac_f32_16x16x64_bf16 v[132:135], v[36:39], v[248:255], v31
    v_cmp_eq_u32 vcc, 0, v15
    v_smfmac_f32_16x16x64_bf16 v[136:139], v[36:39], a[112:119], v31
    ds_read_b128 v[68:71], v114 offset:8192
    v_cndmask_b32 v116, 0, v14, vcc
    v_smfmac_f32_16x16x64_bf16 v[140:143], v[36:39], a[136:143], v31
    v_cmp_eq_u32 vcc, 1, v15
    s_waitcnt lgkmcnt(7)
    v_smfmac_f32_16x16x64_bf16 v[128:131], v[40:43], v[232:239], v31
    ds_read_b128 v[72:75], v115 offset:8192
    v_cndmask_b32 v117, 0, v14, vcc
    v_smfmac_f32_16x16x64_bf16 v[132:135], v[40:43], a[96:103], v31
    v_cmp_eq_u32 vcc, 2, v15
    v_smfmac_f32_16x16x64_bf16 v[136:139], v[40:43], a[120:127], v31
    ds_read_b128 v[76:79], v113 offset:8192
    v_cndmask_b32 v118, 0, v14, vcc
    v_smfmac_f32_16x16x64_bf16 v[140:143], v[40:43], a[144:151], v31
    v_cmp_eq_u32 vcc, 3, v15
    s_waitcnt lgkmcnt(8)
    v_smfmac_f32_16x16x64_bf16 v[128:131], v[44:47], v[240:247], v31
    v_cndmask_b32 v119, 0, v14, vcc
    v_smfmac_f32_16x16x64_bf16 v[132:135], v[44:47], a[104:111], v31
    v_and_b32 v120, 0x70, v0
    v_smfmac_f32_16x16x64_bf16 v[136:139], v[44:47], a[128:135], v31
    v_lshrrev_b32 v121, 2, v120
    v_smfmac_f32_16x16x64_bf16 v[140:143], v[44:47], a[152:159], v31
    s_lshl_b32 s56, s32, 5
    s_add_u32 s56, s56, 0x5801f80
    buffer_load_dword a84, v121, s[4:7], s56 offen
    s_lshl_b32 s56, s32, 14
    s_lshl_b32 s81, s44, 6
    s_add_u32 s56, s56, s81
    s_add_u32 s56, s56, 0xb10000
    v_lshlrev_b32 v120, 7, v120
    v_lshrrev_b32 v122, 8, v0
    v_lshlrev_b32 v122, 4, v122
    v_add_u32 v120, v120, v122
    buffer_load_dwordx4 a[80:83], v120, s[4:7], s56 offen
    s_waitcnt lgkmcnt(7)
    v_smfmac_f32_16x16x64_bf16 v[144:147], v[48:51], a[224:231], v31
    v_smfmac_f32_16x16x64_bf16 v[148:151], v[48:51], a[232:239], v31
    v_smfmac_f32_16x16x64_bf16 v[152:155], v[48:51], a[240:247], v31
    s_mov_b32 s35, 0xa00000
    v_cvt_pk_bf16_f32 v128, v128, v129
    v_smfmac_f32_16x16x64_bf16 v[156:159], v[48:51], a[248:255], v31
    s_waitcnt lgkmcnt(6)
    v_cvt_pk_bf16_f32 v129, v130, v131
    v_smfmac_f32_16x16x64_bf16 v[144:147], v[52:55], v[224:231], v31
    ds_read_b128 v[80:83], v5 offset:10240
    v_or_b32 v128, 1, v128
    v_smfmac_f32_16x16x64_bf16 v[148:151], v[52:55], v[248:255], v31
    buffer_store_dwordx2 v[128:129], v8, s[4:7], s35 offen
    v_smfmac_f32_16x16x64_bf16 v[152:155], v[52:55], a[112:119], v31
    ds_read_b128 v[84:87], v114 offset:10240
    s_mov_b32 s36, 0xa04000
    v_cvt_pk_bf16_f32 v132, v132, v133
    v_smfmac_f32_16x16x64_bf16 v[156:159], v[52:55], a[136:143], v31
    s_waitcnt lgkmcnt(7)
    v_cvt_pk_bf16_f32 v133, v134, v135
    v_smfmac_f32_16x16x64_bf16 v[144:147], v[56:59], v[232:239], v31
    ds_read_b128 v[88:91], v115 offset:10240
    v_or_b32 v132, 1, v132
    v_smfmac_f32_16x16x64_bf16 v[148:151], v[56:59], a[96:103], v31
    buffer_store_dwordx2 v[132:133], v8, s[4:7], s36 offen
    v_smfmac_f32_16x16x64_bf16 v[152:155], v[56:59], a[120:127], v31
    ds_read_b128 v[92:95], v113 offset:10240
    s_mov_b32 s37, 0xa08000
    v_cvt_pk_bf16_f32 v136, v136, v137
    v_smfmac_f32_16x16x64_bf16 v[156:159], v[56:59], a[144:151], v31
    s_waitcnt lgkmcnt(8)
    v_cvt_pk_bf16_f32 v137, v138, v139
    v_smfmac_f32_16x16x64_bf16 v[144:147], v[60:63], v[240:247], v31
    v_or_b32 v136, 1, v136
    v_smfmac_f32_16x16x64_bf16 v[148:151], v[60:63], a[104:111], v31
    buffer_store_dwordx2 v[136:137], v8, s[4:7], s37 offen
    v_smfmac_f32_16x16x64_bf16 v[152:155], v[60:63], a[128:135], v31
    s_mov_b32 s38, 0xa0c000
    v_cvt_pk_bf16_f32 v140, v140, v141
    v_smfmac_f32_16x16x64_bf16 v[156:159], v[60:63], a[152:159], v31
    v_cvt_pk_bf16_f32 v141, v142, v143
    v_or_b32 v140, 1, v140
    buffer_store_dwordx2 v[140:141], v8, s[4:7], s38 offen
    s_lshl_b32 s56, s32, 18
    s_add_u32 s56, s56, 0xa00000
    s_add_u32 s81, s56, 4096
    s_waitcnt lgkmcnt(7)
    v_smfmac_f32_16x16x64_bf16 v[160:163], v[64:67], a[224:231], v31
    v_smfmac_f32_16x16x64_bf16 v[164:167], v[64:67], a[232:239], v31
    v_smfmac_f32_16x16x64_bf16 v[168:171], v[64:67], a[240:247], v31
    s_mov_b32 s35, 0xa40000
    v_cvt_pk_bf16_f32 v144, v144, v145
    v_smfmac_f32_16x16x64_bf16 v[172:175], v[64:67], a[248:255], v31
    s_waitcnt lgkmcnt(6)
    v_cvt_pk_bf16_f32 v145, v146, v147
    v_smfmac_f32_16x16x64_bf16 v[160:163], v[68:71], v[224:231], v31
    v_or_b32 v144, 1, v144
    v_smfmac_f32_16x16x64_bf16 v[164:167], v[68:71], v[248:255], v31
    buffer_store_dwordx2 v[144:145], v8, s[4:7], s35 offen
    v_smfmac_f32_16x16x64_bf16 v[168:171], v[68:71], a[112:119], v31
    s_mov_b32 s36, 0xa44000
    v_cvt_pk_bf16_f32 v148, v148, v149
    v_smfmac_f32_16x16x64_bf16 v[172:175], v[68:71], a[136:143], v31
    s_waitcnt lgkmcnt(5)
    v_cvt_pk_bf16_f32 v149, v150, v151
    v_smfmac_f32_16x16x64_bf16 v[160:163], v[72:75], v[232:239], v31
    v_or_b32 v148, 1, v148
    v_smfmac_f32_16x16x64_bf16 v[164:167], v[72:75], a[96:103], v31
    buffer_store_dwordx2 v[148:149], v8, s[4:7], s36 offen
    v_smfmac_f32_16x16x64_bf16 v[168:171], v[72:75], a[120:127], v31
    s_mov_b32 s37, 0xa48000
    v_cvt_pk_bf16_f32 v152, v152, v153
    v_smfmac_f32_16x16x64_bf16 v[172:175], v[72:75], a[144:151], v31
    s_waitcnt lgkmcnt(4)
    v_cvt_pk_bf16_f32 v153, v154, v155
    v_smfmac_f32_16x16x64_bf16 v[160:163], v[76:79], v[240:247], v31
    v_or_b32 v152, 1, v152
    v_smfmac_f32_16x16x64_bf16 v[164:167], v[76:79], a[104:111], v31
    buffer_store_dwordx2 v[152:153], v8, s[4:7], s37 offen
    v_smfmac_f32_16x16x64_bf16 v[168:171], v[76:79], a[128:135], v31
    s_mov_b32 s38, 0xa4c000
    v_cvt_pk_bf16_f32 v156, v156, v157
    v_smfmac_f32_16x16x64_bf16 v[172:175], v[76:79], a[152:159], v31
    v_cvt_pk_bf16_f32 v157, v158, v159
    v_or_b32 v156, 1, v156
    buffer_store_dwordx2 v[156:157], v8, s[4:7], s38 offen
    v_bfe_u32 v112, v0, 4, 4
    v_lshlrev_b32 v113, 10, v112
    v_lshrrev_b32 v112, 3, v112
    v_lshlrev_b32 v112, 30, v112
    v_add_u32 v113, v113, v112
    v_lshrrev_b32 v112, 8, v0
    v_lshlrev_b32 v112, 3, v112
    v_add_u32 v113, v113, v112
    s_lshl_b32 s79, s32, 13
    s_lshl_b32 s54, s44, 5
    s_add_u32 s79, s79, s54
    s_add_u32 s79, s79, 0x1f8000
    s_mov_b32 s54, 0
    s_cmp_ge_u32 s32, 2
    s_cbranch_scc1 L_cfb_48
    s_waitcnt lgkmcnt(3)
    v_smfmac_f32_16x16x64_bf16 v[176:179], v[80:83], a[224:231], v31
    buffer_load_dwordx4 v[192:195], v9, s[4:7], s56 offen offset:0 sc1
    v_smfmac_f32_16x16x64_bf16 v[180:183], v[80:83], a[232:239], v31
    v_smfmac_f32_16x16x64_bf16 v[184:187], v[80:83], a[240:247], v31
    s_mov_b32 s35, 0xa80000
    buffer_load_dwordx4 v[196:199], v9, s[4:7], s56 offen offset:1024 sc1
    v_cvt_pk_bf16_f32 v160, v160, v161
    v_smfmac_f32_16x16x64_bf16 v[188:191], v[80:83], a[248:255], v31
    s_waitcnt lgkmcnt(2)
    v_cvt_pk_bf16_f32 v161, v162, v163
    v_smfmac_f32_16x16x64_bf16 v[176:179], v[84:87], v[224:231], v31
    buffer_load_dwordx4 v[200:203], v9, s[4:7], s56 offen offset:2048 sc1
    v_or_b32 v160, 1, v160
    v_smfmac_f32_16x16x64_bf16 v[180:183], v[84:87], v[248:255], v31
    buffer_store_dwordx2 v[160:161], v8, s[4:7], s35 offen
    v_smfmac_f32_16x16x64_bf16 v[184:187], v[84:87], a[112:119], v31
    s_mov_b32 s36, 0xa84000
    buffer_load_dwordx4 v[204:207], v9, s[4:7], s56 offen offset:3072 sc1
    v_cvt_pk_bf16_f32 v164, v164, v165
    v_smfmac_f32_16x16x64_bf16 v[188:191], v[84:87], a[136:143], v31
    s_waitcnt lgkmcnt(1)
    v_cvt_pk_bf16_f32 v165, v166, v167
    v_smfmac_f32_16x16x64_bf16 v[176:179], v[88:91], v[232:239], v31
    buffer_load_dwordx4 v[208:211], v9, s[4:7], s81 offen offset:0 sc1
    v_or_b32 v164, 1, v164
    v_smfmac_f32_16x16x64_bf16 v[180:183], v[88:91], a[96:103], v31
    buffer_store_dwordx2 v[164:165], v8, s[4:7], s36 offen
    v_smfmac_f32_16x16x64_bf16 v[184:187], v[88:91], a[120:127], v31
    s_mov_b32 s37, 0xa88000
    buffer_load_dwordx4 v[212:215], v9, s[4:7], s81 offen offset:1024 sc1
    v_cvt_pk_bf16_f32 v168, v168, v169
    v_smfmac_f32_16x16x64_bf16 v[188:191], v[88:91], a[144:151], v31
    s_waitcnt lgkmcnt(0)
    v_cvt_pk_bf16_f32 v169, v170, v171
    v_smfmac_f32_16x16x64_bf16 v[176:179], v[92:95], v[240:247], v31
    buffer_load_dwordx4 v[216:219], v9, s[4:7], s81 offen offset:2048 sc1
    v_or_b32 v168, 1, v168
    v_smfmac_f32_16x16x64_bf16 v[180:183], v[92:95], a[104:111], v31
    buffer_store_dwordx2 v[168:169], v8, s[4:7], s37 offen
    v_smfmac_f32_16x16x64_bf16 v[184:187], v[92:95], a[128:135], v31
    s_mov_b32 s38, 0xa8c000
    buffer_load_dwordx4 v[220:223], v9, s[4:7], s81 offen offset:3072 sc1
    v_cvt_pk_bf16_f32 v172, v172, v173
    v_smfmac_f32_16x16x64_bf16 v[188:191], v[92:95], a[152:159], v31
    v_cvt_pk_bf16_f32 v173, v174, v175
    v_or_b32 v172, 1, v172
    buffer_store_dwordx2 v[172:173], v8, s[4:7], s38 offen
    s_nop 3
    s_mov_b32 s35, 0xac0000
    v_cvt_pk_bf16_f32 v176, v176, v177
    s_nop 0
    v_cvt_pk_bf16_f32 v177, v178, v179
    v_or_b32 v176, 1, v176
    buffer_store_dwordx2 v[176:177], v8, s[4:7], s35 offen
    s_mov_b32 s36, 0xac4000
    v_cvt_pk_bf16_f32 v180, v180, v181
    s_nop 0
    v_cvt_pk_bf16_f32 v181, v182, v183
    v_or_b32 v180, 1, v180
    buffer_store_dwordx2 v[180:181], v8, s[4:7], s36 offen
    s_mov_b32 s37, 0xac8000
    v_cvt_pk_bf16_f32 v184, v184, v185
    s_nop 0
    v_cvt_pk_bf16_f32 v185, v186, v187
    v_or_b32 v184, 1, v184
    buffer_store_dwordx2 v[184:185], v8, s[4:7], s37 offen
    s_mov_b32 s38, 0xacc000
    v_cvt_pk_bf16_f32 v188, v188, v189
    s_nop 0
    v_cvt_pk_bf16_f32 v189, v190, v191
    v_or_b32 v188, 1, v188
    buffer_store_dwordx2 v[188:189], v8, s[4:7], s38 offen
    s_waitcnt vmcnt(15)
    v_mfma_f32_16x16x32_bf16 v[96:99], v[192:195], v[116:119], 0
    v_and_b32 v14, v192, v194
    s_waitcnt vmcnt(14)
    v_mfma_f32_16x16x32_bf16 v[96:99], v[196:199], v[116:119], v[96:99]
    v_bitop3_b32 v14, v14, v196, v198 bitop3:0x80
    s_waitcnt vmcnt(13)
    v_mfma_f32_16x16x32_bf16 v[96:99], v[200:203], v[116:119], v[96:99]
    v_bitop3_b32 v14, v14, v200, v202 bitop3:0x80
    s_waitcnt vmcnt(11)
    v_mfma_f32_16x16x32_bf16 v[96:99], v[204:207], v[116:119], v[96:99]
    v_bitop3_b32 v14, v14, v204, v206 bitop3:0x80
    s_waitcnt vmcnt(10)
    v_mfma_f32_16x16x32_bf16 v[96:99], v[208:211], v[116:119], v[96:99]
    v_bitop3_b32 v14, v14, v208, v210 bitop3:0x80
    s_waitcnt vmcnt(8)
    v_mfma_f32_16x16x32_bf16 v[96:99], v[212:215], v[116:119], v[96:99]
    v_bitop3_b32 v14, v14, v212, v214 bitop3:0x80
    s_waitcnt vmcnt(7)
    v_mfma_f32_16x16x32_bf16 v[96:99], v[216:219], v[116:119], v[96:99]
    v_bitop3_b32 v14, v14, v216, v218 bitop3:0x80
    s_waitcnt vmcnt(5)
    v_mfma_f32_16x16x32_bf16 v[96:99], v[220:223], v[116:119], v[96:99]
    v_bitop3_b32 v14, v14, v220, v222 bitop3:0x80
    v_and_b32 v14, 1, v14
    v_cmp_ne_u32 vcc, 1, v14
    s_cbranch_vccz L_cfok_50
    s_branch L_cfp_49
L_cfb_48:
    s_waitcnt lgkmcnt(3)
    v_smfmac_f32_16x16x64_bf16 v[176:179], v[80:83], a[224:231], v31
    v_smfmac_f32_16x16x64_bf16 v[180:183], v[80:83], a[232:239], v31
    v_smfmac_f32_16x16x64_bf16 v[184:187], v[80:83], a[240:247], v31
    s_mov_b32 s35, 0xa80000
    v_cvt_pk_bf16_f32 v160, v160, v161
    v_smfmac_f32_16x16x64_bf16 v[188:191], v[80:83], a[248:255], v31
    s_waitcnt lgkmcnt(2)
    v_cvt_pk_bf16_f32 v161, v162, v163
    v_smfmac_f32_16x16x64_bf16 v[176:179], v[84:87], v[224:231], v31
    v_or_b32 v160, 1, v160
    v_smfmac_f32_16x16x64_bf16 v[180:183], v[84:87], v[248:255], v31
    buffer_store_dwordx2 v[160:161], v8, s[4:7], s35 offen
    v_smfmac_f32_16x16x64_bf16 v[184:187], v[84:87], a[112:119], v31
    s_mov_b32 s36, 0xa84000
    v_cvt_pk_bf16_f32 v164, v164, v165
    v_smfmac_f32_16x16x64_bf16 v[188:191], v[84:87], a[136:143], v31
    s_waitcnt lgkmcnt(1)
    v_cvt_pk_bf16_f32 v165, v166, v167
    v_smfmac_f32_16x16x64_bf16 v[176:179], v[88:91], v[232:239], v31
    v_or_b32 v164, 1, v164
    v_smfmac_f32_16x16x64_bf16 v[180:183], v[88:91], a[96:103], v31
    buffer_store_dwordx2 v[164:165], v8, s[4:7], s36 offen
    v_smfmac_f32_16x16x64_bf16 v[184:187], v[88:91], a[120:127], v31
    s_mov_b32 s37, 0xa88000
    v_cvt_pk_bf16_f32 v168, v168, v169
    v_smfmac_f32_16x16x64_bf16 v[188:191], v[88:91], a[144:151], v31
    s_waitcnt lgkmcnt(0)
    v_cvt_pk_bf16_f32 v169, v170, v171
    v_smfmac_f32_16x16x64_bf16 v[176:179], v[92:95], v[240:247], v31
    v_or_b32 v168, 1, v168
    v_smfmac_f32_16x16x64_bf16 v[180:183], v[92:95], a[104:111], v31
    buffer_store_dwordx2 v[168:169], v8, s[4:7], s37 offen
    v_smfmac_f32_16x16x64_bf16 v[184:187], v[92:95], a[128:135], v31
    s_mov_b32 s38, 0xa8c000
    v_cvt_pk_bf16_f32 v172, v172, v173
    v_smfmac_f32_16x16x64_bf16 v[188:191], v[92:95], a[152:159], v31
    v_cvt_pk_bf16_f32 v173, v174, v175
    v_or_b32 v172, 1, v172
    buffer_store_dwordx2 v[172:173], v8, s[4:7], s38 offen
    s_nop 3
    s_mov_b32 s35, 0xac0000
    v_cvt_pk_bf16_f32 v176, v176, v177
    s_nop 0
    v_cvt_pk_bf16_f32 v177, v178, v179
    v_or_b32 v176, 1, v176
    buffer_store_dwordx2 v[176:177], v8, s[4:7], s35 offen
    s_mov_b32 s36, 0xac4000
    v_cvt_pk_bf16_f32 v180, v180, v181
    s_nop 0
    v_cvt_pk_bf16_f32 v181, v182, v183
    v_or_b32 v180, 1, v180
    buffer_store_dwordx2 v[180:181], v8, s[4:7], s36 offen
    s_mov_b32 s37, 0xac8000
    v_cvt_pk_bf16_f32 v184, v184, v185
    s_nop 0
    v_cvt_pk_bf16_f32 v185, v186, v187
    v_or_b32 v184, 1, v184
    buffer_store_dwordx2 v[184:185], v8, s[4:7], s37 offen
    s_mov_b32 s38, 0xacc000
    v_cvt_pk_bf16_f32 v188, v188, v189
    s_nop 0
    v_cvt_pk_bf16_f32 v189, v190, v191
    v_or_b32 v188, 1, v188
    buffer_store_dwordx2 v[188:189], v8, s[4:7], s38 offen
    s_cmp_eq_u32 s32, 2
    s_cbranch_scc1 L_cfp_49
    s_sleep 1
L_cfp_49:
    buffer_load_dwordx4 v[192:195], v9, s[4:7], s56 offen offset:0 sc1
    buffer_load_dwordx4 v[196:199], v9, s[4:7], s56 offen offset:1024 sc1
    buffer_load_dwordx4 v[200:203], v9, s[4:7], s56 offen offset:2048 sc1
    buffer_load_dwordx4 v[204:207], v9, s[4:7], s56 offen offset:3072 sc1
    buffer_load_dwordx4 v[208:211], v9, s[4:7], s81 offen offset:0 sc1
    buffer_load_dwordx4 v[212:215], v9, s[4:7], s81 offen offset:1024 sc1
    buffer_load_dwordx4 v[216:219], v9, s[4:7], s81 offen offset:2048 sc1
    buffer_load_dwordx4 v[220:223], v9, s[4:7], s81 offen offset:3072 sc1
    s_waitcnt vmcnt(7)
    v_mfma_f32_16x16x32_bf16 v[96:99], v[192:195], v[116:119], 0
    v_and_b32 v14, v192, v194
    s_waitcnt vmcnt(6)
    v_mfma_f32_16x16x32_bf16 v[96:99], v[196:199], v[116:119], v[96:99]
    v_bitop3_b32 v14, v14, v196, v198 bitop3:0x80
    s_waitcnt vmcnt(5)
    v_mfma_f32_16x16x32_bf16 v[96:99], v[200:203], v[116:119], v[96:99]
    v_bitop3_b32 v14, v14, v200, v202 bitop3:0x80
    s_waitcnt vmcnt(4)
    v_mfma_f32_16x16x32_bf16 v[96:99], v[204:207], v[116:119], v[96:99]
    v_bitop3_b32 v14, v14, v204, v206 bitop3:0x80
    s_waitcnt vmcnt(3)
    v_mfma_f32_16x16x32_bf16 v[96:99], v[208:211], v[116:119], v[96:99]
    v_bitop3_b32 v14, v14, v208, v210 bitop3:0x80
    s_waitcnt vmcnt(2)
    v_mfma_f32_16x16x32_bf16 v[96:99], v[212:215], v[116:119], v[96:99]
    v_bitop3_b32 v14, v14, v212, v214 bitop3:0x80
    s_waitcnt vmcnt(1)
    v_mfma_f32_16x16x32_bf16 v[96:99], v[216:219], v[116:119], v[96:99]
    v_bitop3_b32 v14, v14, v216, v218 bitop3:0x80
    s_waitcnt vmcnt(0)
    v_mfma_f32_16x16x32_bf16 v[96:99], v[220:223], v[116:119], v[96:99]
    v_bitop3_b32 v14, v14, v220, v222 bitop3:0x80
    v_and_b32 v14, 1, v14
    v_cmp_ne_u32 vcc, 1, v14
    s_cbranch_vccz L_cfok_50
    s_add_u32 s54, s54, 1
    s_cmp_lg_u32 s41, 0
    s_cbranch_scc1 L_cfok_50
    s_cmp_lt_u32 s54, 65536
    s_cbranch_scc1 L_cfp_49
    s_mov_b32 s41, 1
L_cfok_50:
    v_accvgpr_read_b32 v104, a80
    v_accvgpr_read_b32 v105, a81
    v_accvgpr_read_b32 v106, a82
    v_accvgpr_read_b32 v107, a83
    v_accvgpr_read_b32 v108, a84
    v_sub_f32 v96, v96, v104
    v_sub_f32 v97, v97, v105
    v_sub_f32 v98, v98, v106
    v_sub_f32 v99, v99, v107
    v_fma_f32 v96, v96, v108, v104
    v_fma_f32 v97, v97, v108, v105
    v_fma_f32 v98, v98, v108, v106
    v_fma_f32 v99, v99, v108, v107
    v_cvt_pk_bf16_f32 v100, v96, v97
    v_cvt_pk_bf16_f32 v101, v98, v99
    buffer_store_dwordx2 v[100:101], v113, s[28:31], s79 offen
    s_waitcnt vmcnt(0) lgkmcnt(0)
    s_branch L_role_end
.p2align 8
    s_nop 0
    s_nop 0
L_top_s:
    s_barrier
    v_xor_b32 v14, 0x800, v6
    v_xor_b32 v15, 0x1000, v6
    v_xor_b32 v30, 0x1800, v6
    s_mov_b32 s54, 0
    s_mov_b32 m0, s87
    s_nop 0
    buffer_load_dwordx4 v0, s[4:7], s51 offen lds
    buffer_load_dwordx4 v0, s[4:7], s51 offen offset:1024 lds
    s_mov_b32 m0, s88
    ds_read_b128 v[32:35], v7 offset:0
    ds_read_b128 v[36:39], v7 offset:1024
    ds_read_b128 v[40:43], v7 offset:2048
    ds_read_b128 v[44:47], v7 offset:3072
    ds_read_b128 v[96:99], v7 offset:4096
    ds_read_b128 v[100:103], v7 offset:5120
    s_sleep 1
    s_sleep 1
    buffer_load_dwordx4 v[48:51], v0, s[4:7], s85 offen sc1
    buffer_load_dwordx4 v[52:55], v0, s[4:7], s85 offen offset:1024 sc1
    s_sleep 1
    s_sleep 1
    s_sleep 1
    buffer_load_dwordx4 v[56:59], v0, s[4:7], s85 offen sc1
    buffer_load_dwordx4 v[60:63], v0, s[4:7], s85 offen offset:1024 sc1
L_spec_s:
    s_waitcnt vmcnt(2)
    ds_write_b128 v6, v[48:51]
    ds_write_b128 v6, v[52:55] offset:1024
    v_smfmac_f32_16x16x64_bf16 v[112:115], v[48:51], a[0:7], v2
    v_max3_u32 v64, v48, v50, v52
    v_smfmac_f32_16x16x64_bf16 v[116:119], v[48:51], a[8:15], v2
    v_max_u32 v64, v64, v54
    v_smfmac_f32_16x16x64_bf16 v[112:115], v[52:55], a[16:23], v2
    v_cmp_eq_u32 vcc, -1, v64
    s_add_u32 s54, s54, 1
    s_cbranch_vccnz L_retry0_s
    v_smfmac_f32_16x16x64_bf16 v[116:119], v[52:55], a[24:31], v2
    s_waitcnt lgkmcnt(0)
    s_barrier
    v_smfmac_f32_16x16x64_bf16 v[88:91], v[48:51], a[128:135], v2
    ds_read_b128 v[64:67], v14 offset:0
    v_smfmac_f32_16x16x64_bf16 v[92:95], v[48:51], a[136:143], v2
    ds_read_b128 v[68:71], v14 offset:1024
    v_smfmac_f32_16x16x64_bf16 v[88:91], v[52:55], a[144:151], v2
    ds_read_b128 v[72:75], v15 offset:0
    v_smfmac_f32_16x16x64_bf16 v[92:95], v[52:55], a[152:159], v2
    ds_read_b128 v[76:79], v15 offset:1024
    v_smfmac_f32_16x16x64_bf16 v[120:123], v[48:51], v[128:135], v2
    s_add_u32 s38, s51, 8192
    ds_read_b128 v[80:83], v30 offset:0
    v_smfmac_f32_16x16x64_bf16 v[124:127], v[48:51], v[136:143], v2
    buffer_load_dwordx4 v0, s[4:7], s38 offen lds
    ds_read_b128 v[84:87], v30 offset:1024
    v_smfmac_f32_16x16x64_bf16 v[120:123], v[52:55], v[144:151], v2
    buffer_load_dwordx4 v0, s[4:7], s38 offen offset:1024 lds
    v_smfmac_f32_16x16x64_bf16 v[124:127], v[52:55], v[152:159], v2
L_common_s:
    s_waitcnt lgkmcnt(5)
    v_smfmac_f32_16x16x64_bf16 v[112:115], v[64:67], a[32:39], v2
    v_smfmac_f32_16x16x64_bf16 v[116:119], v[64:67], a[40:47], v2
    buffer_load_dword v12, off, s[4:7], s78 sc1
    s_waitcnt lgkmcnt(4)
    v_smfmac_f32_16x16x64_bf16 v[112:115], v[68:71], a[48:55], v2
    buffer_load_dword v13, v11, s[4:7], s84 offen
    v_smfmac_f32_16x16x64_bf16 v[116:119], v[68:71], a[56:63], v2
    s_add_u32 s38, s84, 4096
    s_waitcnt lgkmcnt(3)
    v_smfmac_f32_16x16x64_bf16 v[112:115], v[72:75], a[64:71], v2
    buffer_load_dword v13, v11, s[4:7], s38 offen
    ds_read_b128 v[104:107], v7 offset:6144
    s_and_b32 s39, s45, 3
    v_smfmac_f32_16x16x64_bf16 v[116:119], v[72:75], a[72:79], v2
    s_waitcnt vmcnt(5)
    ds_read_b128 v[108:111], v7 offset:7168
    s_lshl_b32 s49, s39, 13
    s_waitcnt lgkmcnt(4)
    v_smfmac_f32_16x16x64_bf16 v[112:115], v[76:79], a[80:87], v2
    ds_read_b128 v[48:51], v0 offset:16384
    s_add_u32 s49, s49, 0x100000
    v_smfmac_f32_16x16x64_bf16 v[116:119], v[76:79], a[88:95], v2
    ds_read_b128 v[52:55], v0 offset:20480
    s_add_u32 s85, s49, s69
    s_waitcnt lgkmcnt(5)
    v_smfmac_f32_16x16x64_bf16 v[112:115], v[80:83], a[96:103], v2
    ds_read_b128 v[56:59], v0 offset:17408
    s_xor_b32 s56, s49, 0x4000
    v_smfmac_f32_16x16x64_bf16 v[116:119], v[80:83], a[104:111], v2
    ds_read_b128 v[60:63], v0 offset:21504
    s_xor_b32 s55, s55, 1
    s_waitcnt lgkmcnt(6)
    v_smfmac_f32_16x16x64_bf16 v[112:115], v[84:87], a[112:119], v2
    v_smfmac_f32_16x16x64_bf16 v[116:119], v[84:87], a[120:127], v2
    v_smfmac_f32_16x16x64_bf16 v[88:91], v[64:67], v[32:39], v2
    v_add_f32 v112, v112, v114
    v_smfmac_f32_16x16x64_bf16 v[92:95], v[64:67], v[40:47], v2
    ds_read_b128 v[32:35], v7 offset:8192
    v_add_f32 v113, v113, v115
    v_smfmac_f32_16x16x64_bf16 v[88:91], v[68:71], v[96:103], v2
    ds_read_b128 v[36:39], v7 offset:9216
    s_waitcnt lgkmcnt(6)
    v_cvt_pk_bf16_f32 v114, v112, v113
    v_smfmac_f32_16x16x64_bf16 v[92:95], v[68:71], v[104:111], v2
    ds_read_b128 v[40:43], v7 offset:10240
    v_add_f32 v116, v116, v118
    v_smfmac_f32_16x16x64_bf16 v[88:91], v[72:75], a[160:167], v2
    ds_read_b128 v[44:47], v7 offset:11264
    v_add_f32 v117, v117, v119
    v_smfmac_f32_16x16x64_bf16 v[92:95], v[72:75], a[168:175], v2
    ds_read_b128 v[96:99], v7 offset:12288
    v_cvt_pk_bf16_f32 v115, v116, v117
    v_smfmac_f32_16x16x64_bf16 v[88:91], v[76:79], a[176:183], v2
    ds_write2st64_b32 v3, v114, v115 offset0:0 offset1:1
    v_smfmac_f32_16x16x64_bf16 v[92:95], v[76:79], a[184:191], v2
    ds_read_b128 v[100:103], v7 offset:13312
    v_smfmac_f32_16x16x64_bf16 v[88:91], v[80:83], a[192:199], v2
    ds_read_b128 v[104:107], v7 offset:14336
    v_mov_b64 v[112:113], 0
    v_smfmac_f32_16x16x64_bf16 v[92:95], v[80:83], a[200:207], v2
    ds_read_b128 v[108:111], v7 offset:15360
    v_mov_b64 v[114:115], 0
    v_smfmac_f32_16x16x64_bf16 v[88:91], v[84:87], a[208:215], v2
    s_waitcnt lgkmcnt(3)
    s_barrier
    v_mov_b64 v[116:117], 0
    v_smfmac_f32_16x16x64_bf16 v[92:95], v[84:87], a[216:223], v2
    s_cmp_eq_u32 s45, 63
    s_cselect_b32 s50, 0x40000000, s50
    v_mov_b64 v[118:119], 0
    v_smfmac_f32_16x16x64_bf16 v[120:123], v[64:67], v[32:39], v2
    v_add_f32 v88, v88, v90
    v_smfmac_f32_16x16x64_bf16 v[124:127], v[64:67], v[40:47], v2
    ds_read_b64_tr_b16 v[64:65], v4 offset:0
    s_waitcnt lgkmcnt(3)
    v_add_f32 v89, v89, v91
    v_smfmac_f32_16x16x64_bf16 v[120:123], v[68:71], v[96:103], v2
    ds_read_b64_tr_b16 v[66:67], v4 offset:128
    ds_read_b128 v[32:35], v0 offset:18432
    s_waitcnt lgkmcnt(3)
    v_cvt_pk_bf16_f32 v90, v88, v89
    v_smfmac_f32_16x16x64_bf16 v[124:127], v[68:71], v[104:111], v2
    ds_read_b64_tr_b16 v[68:69], v4 offset:512
    ds_read_b128 v[36:39], v0 offset:22528
    v_add_f32 v92, v92, v94
    v_smfmac_f32_16x16x64_bf16 v[120:123], v[72:75], v[160:167], v2
    ds_read_b64_tr_b16 v[70:71], v4 offset:640
    ds_read_b128 v[40:43], v0 offset:19456
    v_add_f32 v93, v93, v95
    v_smfmac_f32_16x16x64_bf16 v[124:127], v[72:75], v[168:175], v2
    ds_read_b64_tr_b16 v[72:73], v4 offset:1024
    ds_read_b128 v[44:47], v0 offset:23552
    v_cvt_pk_bf16_f32 v91, v92, v93
    v_smfmac_f32_16x16x64_bf16 v[120:123], v[76:79], v[176:183], v2
    ds_write2st64_b32 v1, v90, v91 offset0:0 offset1:2
    v_smfmac_f32_16x16x64_bf16 v[124:127], v[76:79], v[184:191], v2
    ds_read_b64_tr_b16 v[74:75], v4 offset:1152
    buffer_store_dword v90, v3, s[4:7], s50 offen sc1
    v_smfmac_f32_16x16x64_bf16 v[120:123], v[80:83], v[192:199], v2
    ds_read_b64_tr_b16 v[76:77], v4 offset:1536
    buffer_store_dword v91, v3, s[4:7], s50 offen offset:256 sc1
    v_smfmac_f32_16x16x64_bf16 v[124:127], v[80:83], v[200:207], v2
    ds_read_b64_tr_b16 v[78:79], v4 offset:1664
    v_smfmac_f32_16x16x64_bf16 v[120:123], v[84:87], v[208:215], v2
    s_waitcnt lgkmcnt(3)
    s_barrier
    ds_read_b64_tr_b16 v[80:81], v21 offset:2048
    v_smfmac_f32_16x16x64_bf16 v[124:127], v[84:87], v[216:223], v2
    ds_read_b64_tr_b16 v[82:83], v21 offset:2304
    v_mfma_f32_16x16x32_bf16 v[96:99], v[48:51], v[64:67], 0
    ds_read_b64_tr_b16 v[84:85], v21 offset:3072
    v_add_f32 v120, v120, v122
    v_mfma_f32_16x16x32_bf16 v[100:103], v[52:55], v[64:67], 0
    ds_read_b64_tr_b16 v[86:87], v21 offset:3328
    v_add_f32 v121, v121, v123
    v_mfma_f32_16x16x32_bf16 v[96:99], v[56:59], v[68:71], v[96:99]
    ds_read_b64_tr_b16 v[88:89], v21 offset:6144
    v_cvt_pk_bf16_f32 v30, v120, v121
    v_mfma_f32_16x16x32_bf16 v[100:103], v[60:63], v[68:71], v[100:103]
    ds_read_b64_tr_b16 v[90:91], v21 offset:6400
    v_add_f32 v124, v124, v126
    s_waitcnt lgkmcnt(6)
    v_mfma_f32_16x16x32_bf16 v[96:99], v[32:35], v[72:75], v[96:99]
    ds_read_b64_tr_b16 v[92:93], v21 offset:7168
    v_add_f32 v125, v125, v127
    v_mfma_f32_16x16x32_bf16 v[100:103], v[36:39], v[72:75], v[100:103]
    ds_read_b64_tr_b16 v[94:95], v21 offset:7424
    v_cvt_pk_bf16_f32 v20, v124, v125
    v_mfma_f32_16x16x32_bf16 v[96:99], v[40:43], v[76:79], v[96:99]
    buffer_store_dword v30, v3, s[4:7], s50 offen offset:2048 sc1
    buffer_store_dword v20, v3, s[4:7], s50 offen offset:2304 sc1
    v_mfma_f32_16x16x32_bf16 v[100:103], v[44:47], v[76:79], v[100:103]
    s_cmp_eq_u32 s45, 63
    s_cbranch_scc1 L_last_s
    s_waitcnt lgkmcnt(4)
    v_mfma_f32_16x16x32_bf16 v[104:107], v[80:83], v[64:67], 0
    ds_read_b128 v[48:51], v7 offset:16384
    v_mfma_f32_16x16x32_bf16 v[104:107], v[84:87], v[68:71], v[104:107]
    ds_read_b128 v[52:55], v7 offset:17408
    v_max3_f32 v14, v96, v97, v98
    s_waitcnt lgkmcnt(2)
    v_mfma_f32_16x16x32_bf16 v[104:107], v[88:91], v[72:75], v[104:107]
    ds_read_b128 v[56:59], v7 offset:18432
    v_max3_f32 v15, v99, v100, v101
    v_mfma_f32_16x16x32_bf16 v[104:107], v[92:95], v[76:79], v[104:107]
    ds_read_b128 v[60:63], v7 offset:19456
    v_max3_f32 v14, v14, v102, v103
    s_waitcnt vmcnt(7)
    ds_read_b128 v[80:83], v6 offset:16384
    ds_read_b128 v[84:87], v6 offset:17408
    ds_read_b128 v[32:35], v7 offset:20480
    ds_read_b128 v[36:39], v7 offset:21504
    v_mov_b64 v[122:123], 0
    v_max3_f32 v14, v14, v15, v104
    v_max_f32 v106, v14, v105
    v_max_f32 v107, v14, v105
    ds_read_b128 v[40:43], v7 offset:22528
    v_mov_b64 v[120:121], 0
    v_permlane16_swap_b32 v106, v107
    v_max_f32 v14, v106, v107
    v_max_f32 v15, v106, v107
    ds_read_b128 v[44:47], v7 offset:23552
    s_nop 0
    v_permlane32_swap_b32 v14, v15
    v_max_f32 v14, v14, v15
    v_mul_f32 v14, s53, v14
    v_pk_fma_f32 v[96:97], v[96:97], s[52:53], v[14:15] op_sel_hi:[1,0,0]
    v_pk_fma_f32 v[98:99], v[98:99], s[52:53], v[14:15] op_sel_hi:[1,0,0]
    v_exp_f32 v96, v96
    v_exp_f32 v97, v97
    v_pk_fma_f32 v[100:101], v[100:101], s[52:53], v[14:15] op_sel_hi:[1,0,0]
    v_exp_f32 v98, v98
    v_cvt_pk_bf16_f32 v124, v96, v97
    v_exp_f32 v99, v99
    v_pk_fma_f32 v[102:103], v[102:103], s[52:53], v[14:15] op_sel_hi:[1,0,0]
    v_exp_f32 v100, v100
    v_cvt_pk_bf16_f32 v125, v98, v99
    v_exp_f32 v101, v101
    v_pk_fma_f32 v[104:105], v[104:105], s[52:53], v[14:15] op_sel_hi:[1,0,0]
    v_exp_f32 v102, v102
    v_cvt_pk_bf16_f32 v126, v100, v101
    v_exp_f32 v103, v103
    v_exp_f32 v104, v104
    v_cvt_pk_bf16_f32 v127, v102, v103
    v_exp_f32 v105, v105
    s_waitcnt lgkmcnt(4)
    v_mfma_f32_16x16x32_bf16 v[108:111], v[22:25], v[124:127], 0
    v_cvt_pk_bf16_f32 v26, v104, v105
    v_mfma_f32_16x16x32_bf16 v[96:99], v[80:83], v[124:127], 0
    ds_read_b128 v[64:67], v7 offset:24576
    v_mfma_f32_16x16x32_bf16 v[100:103], v[84:87], v[124:127], 0
    v_mfma_f32_16x16x32_bf16 v[108:111], v[22:25], v[26:29], v[108:111]
    v_mfma_f32_16x16x32_bf16 v[96:99], v[30:33], v[26:29], v[96:99]
    v_mov_b64 v[124:125], 0
    v_mfma_f32_16x16x32_bf16 v[100:103], v[20:23], v[26:29], v[100:103]
    ds_read_b128 v[68:71], v7 offset:25600
    v_rcp_f32 v14, v108
    ds_read_b128 v[72:75], v7 offset:26624
    v_mov_b64 v[126:127], 0
    v_pk_mul_f32 v[96:97], v[96:97], v[14:15] op_sel_hi:[1,0]
    v_pk_mul_f32 v[98:99], v[98:99], v[14:15] op_sel_hi:[1,0]
    v_pk_mul_f32 v[100:101], v[100:101], v[14:15] op_sel_hi:[1,0]
    v_cvt_pk_bf16_f32 v104, v96, v97
    v_pk_mul_f32 v[102:103], v[102:103], v[14:15] op_sel_hi:[1,0]
    v_cvt_pk_bf16_f32 v105, v98, v99
    v_cvt_pk_bf16_f32 v106, v100, v101
    v_cvt_pk_bf16_f32 v107, v102, v103
    ds_write_b128 v5, v[104:107] offset:0
    v_xor_b32 v14, 0x200, v5
    v_xor_b32 v15, 0x400, v5
    v_xor_b32 v30, 0x600, v5
    v_smfmac_f32_16x16x64_bf16 v[112:115], v[104:107], a[224:231], v31
    v_smfmac_f32_16x16x64_bf16 v[116:119], v[104:107], a[232:239], v31
    s_waitcnt lgkmcnt(0)
    s_barrier
    ds_read_b128 v[96:99], v14
    ds_read_b128 v[100:103], v15
    ds_read_b128 v[108:111], v30
    v_smfmac_f32_16x16x64_bf16 v[120:123], v[104:107], a[240:247], v31
    ds_read_b128 v[76:79], v7 offset:27648
    ds_read_b128 v[80:83], v7 offset:28672
    v_smfmac_f32_16x16x64_bf16 v[124:127], v[104:107], a[248:255], v31
    ds_read_b128 v[84:87], v7 offset:29696
    ds_read_b128 v[88:91], v7 offset:30720
    s_waitcnt lgkmcnt(6)
    v_smfmac_f32_16x16x64_bf16 v[112:115], v[96:99], v[224:231], v31
    ds_read_b128 v[92:95], v7 offset:31744
    s_waitcnt lgkmcnt(6)
    v_smfmac_f32_16x16x64_bf16 v[112:115], v[100:103], v[232:239], v31
    s_waitcnt lgkmcnt(5)
    v_smfmac_f32_16x16x64_bf16 v[112:115], v[108:111], v[240:247], v31
    v_smfmac_f32_16x16x64_bf16 v[116:119], v[96:99], v[248:255], v31
    v_smfmac_f32_16x16x64_bf16 v[116:119], v[100:103], v[48:55], v31
    v_cvt_pk_bf16_f32 v112, v112, v113
    v_smfmac_f32_16x16x64_bf16 v[116:119], v[108:111], v[56:63], v31
    v_cvt_pk_bf16_f32 v113, v114, v115
    v_smfmac_f32_16x16x64_bf16 v[120:123], v[96:99], v[32:39], v31
    v_and_or_b32 v112, v112, -2, s55
    v_smfmac_f32_16x16x64_bf16 v[120:123], v[100:103], v[40:47], v31
    buffer_store_dwordx2 v[112:113], v8, s[4:7], 0 offen sc1
    v_cvt_pk_bf16_f32 v116, v116, v117
    v_smfmac_f32_16x16x64_bf16 v[120:123], v[108:111], v[64:71], v31
    s_waitcnt lgkmcnt(4)
    v_cvt_pk_bf16_f32 v117, v118, v119
    v_smfmac_f32_16x16x64_bf16 v[124:127], v[96:99], v[72:79], v31
    s_waitcnt lgkmcnt(2)
    v_and_or_b32 v116, v116, -2, s55
    v_smfmac_f32_16x16x64_bf16 v[124:127], v[100:103], v[80:87], v31
    buffer_store_dwordx2 v[116:117], v8, s[4:7], s47 offen sc1
    s_waitcnt lgkmcnt(0)
    v_cvt_pk_bf16_f32 v120, v120, v121
    v_smfmac_f32_16x16x64_bf16 v[124:127], v[108:111], v[88:95], v31
    v_cvt_pk_bf16_f32 v121, v122, v123
    v_and_or_b32 v120, v120, -2, s55
    buffer_store_dwordx2 v[120:121], v8, s[4:7], s70 offen sc1
    s_nop 5
    v_cvt_pk_bf16_f32 v124, v124, v125
    v_cvt_pk_bf16_f32 v125, v126, v127
    v_and_or_b32 v124, v124, -2, s55
    buffer_store_dwordx2 v[124:125], v8, s[4:7], s71 offen sc1
L_red_s:
    s_barrier
    s_cmp_lg_u32 s32, 0
    s_cbranch_scc1 L_notred_53
    v_mov_b64 v[112:113], 0
    v_mov_b64 v[114:115], 0
    v_mov_b64 v[116:117], 0
    v_mov_b64 v[118:119], 0
    v_mov_b64 v[120:121], 0
    v_mov_b64 v[122:123], 0
    v_mov_b64 v[124:125], 0
    v_mov_b64 v[126:127], 0
    v_mov_b64 v[88:89], 0
    v_mov_b64 v[90:91], 0
    v_mov_b64 v[92:93], 0
    v_mov_b64 v[94:95], 0
    v_xor_b32 v11, 1, v11
    s_add_u32 s45, s45, 1
    s_add_u32 s50, s50, 0x20000
    s_add_u32 s51, s51, 0x80000
    s_add_u32 s84, s84, 0x80000
    s_add_u32 s80, s80, 4
    s_cmp_eq_u32 s80, 20
    s_cselect_b32 s80, 0, s80
    s_addc_u32 s81, s81, 0
    s_add_u32 s78, s67, s80
    s_cmp_lt_u32 s45, 62
    s_cselect_b32 s79, s81, 0
    s_mov_b32 s54, 0
    s_sleep 1
    buffer_load_dwordx4 v[32:35], v9, s[4:7], 0 offen offset:0 sc1
    buffer_load_dwordx4 v[36:39], v9, s[4:7], 0 offen offset:1024 sc1
    buffer_load_dwordx4 v[40:43], v9, s[4:7], 0 offen offset:2048 sc1
    buffer_load_dwordx4 v[44:47], v9, s[4:7], 0 offen offset:3072 sc1
    buffer_load_dwordx4 v[48:51], v9, s[4:7], s48 offen offset:0 sc1
    buffer_load_dwordx4 v[52:55], v9, s[4:7], s48 offen offset:1024 sc1
    buffer_load_dwordx4 v[56:59], v9, s[4:7], s48 offen offset:2048 sc1
    buffer_load_dwordx4 v[60:63], v9, s[4:7], s48 offen offset:3072 sc1
    s_sleep 1
    s_sleep 1
    s_sleep 1
    buffer_load_dwordx4 v[64:67], v9, s[4:7], 0 offen offset:0 sc1
    buffer_load_dwordx4 v[68:71], v9, s[4:7], 0 offen offset:1024 sc1
    buffer_load_dwordx4 v[72:75], v9, s[4:7], 0 offen offset:2048 sc1
    buffer_load_dwordx4 v[76:79], v9, s[4:7], 0 offen offset:3072 sc1
    buffer_load_dwordx4 v[80:83], v9, s[4:7], s48 offen offset:0 sc1
    buffer_load_dwordx4 v[84:87], v9, s[4:7], s48 offen offset:1024 sc1
    buffer_load_dwordx4 v[104:107], v9, s[4:7], s48 offen offset:2048 sc1
    buffer_load_dwordx4 v[108:111], v9, s[4:7], s48 offen offset:3072 sc1
    s_waitcnt vmcnt(15)
    v_mfma_f32_16x16x32_bf16 v[96:99], v[32:35], v[16:19], 0
    v_bitop3_b32 v14, v32, v34, v11 bitop3:0x7e
    s_waitcnt vmcnt(14)
    v_mfma_f32_16x16x32_bf16 v[96:99], v[36:39], v[16:19], v[96:99]
    v_bitop3_b32 v15, v36, v38, v11 bitop3:0x7e
    s_waitcnt vmcnt(13)
    v_mfma_f32_16x16x32_bf16 v[96:99], v[40:43], v[16:19], v[96:99]
    v_bitop3_b32 v30, v40, v42, v11 bitop3:0x7e
    v_or3_b32 v14, v14, v15, v30
    s_waitcnt vmcnt(12)
    v_mfma_f32_16x16x32_bf16 v[96:99], v[44:47], v[16:19], v[96:99]
    v_bitop3_b32 v15, v44, v46, v11 bitop3:0x7e
    s_waitcnt vmcnt(11)
    v_mfma_f32_16x16x32_bf16 v[96:99], v[48:51], v[16:19], v[96:99]
    v_bitop3_b32 v30, v48, v50, v11 bitop3:0x7e
    v_or3_b32 v14, v14, v15, v30
    s_waitcnt vmcnt(10)
    v_mfma_f32_16x16x32_bf16 v[96:99], v[52:55], v[16:19], v[96:99]
    v_bitop3_b32 v15, v52, v54, v11 bitop3:0x7e
    s_waitcnt vmcnt(9)
    v_mfma_f32_16x16x32_bf16 v[96:99], v[56:59], v[16:19], v[96:99]
    v_bitop3_b32 v30, v56, v58, v11 bitop3:0x7e
    v_or3_b32 v14, v14, v15, v30
    s_waitcnt vmcnt(8)
    v_mfma_f32_16x16x32_bf16 v[96:99], v[60:63], v[16:19], v[96:99]
    v_bitop3_b32 v15, v60, v62, v11 bitop3:0x7e
    v_bitop3_b32 v14, v14, v15, 1 bitop3:0xa8
    v_cmp_ne_u32 vcc, 0, v14
    s_cbranch_vccnz L_rfail_56
L_redok_55:
    s_cmp_eq_u32 s45, 63
    s_nop 2
    v_cvt_pk_bf16_f32 v100, v96, v97
    v_cvt_pk_bf16_f32 v101, v98, v99
    buffer_store_dwordx2 v[100:101], v10, s[4:7], s49 offen sc1
    s_cbranch_scc1 L_cfq0_s
    s_branch L_top_s
L_rfail_56:
    s_waitcnt vmcnt(7)
    v_mfma_f32_16x16x32_bf16 v[96:99], v[64:67], v[16:19], 0
    v_bitop3_b32 v14, v64, v66, v11 bitop3:0x7e
    s_waitcnt vmcnt(6)
    v_mfma_f32_16x16x32_bf16 v[96:99], v[68:71], v[16:19], v[96:99]
    v_bitop3_b32 v15, v68, v70, v11 bitop3:0x7e
    s_waitcnt vmcnt(5)
    v_mfma_f32_16x16x32_bf16 v[96:99], v[72:75], v[16:19], v[96:99]
    v_bitop3_b32 v30, v72, v74, v11 bitop3:0x7e
    v_or3_b32 v14, v14, v15, v30
    s_waitcnt vmcnt(4)
    v_mfma_f32_16x16x32_bf16 v[96:99], v[76:79], v[16:19], v[96:99]
    v_bitop3_b32 v15, v76, v78, v11 bitop3:0x7e
    s_waitcnt vmcnt(3)
    v_mfma_f32_16x16x32_bf16 v[96:99], v[80:83], v[16:19], v[96:99]
    v_bitop3_b32 v30, v80, v82, v11 bitop3:0x7e
    v_or3_b32 v14, v14, v15, v30
    s_waitcnt vmcnt(2)
    v_mfma_f32_16x16x32_bf16 v[96:99], v[84:87], v[16:19], v[96:99]
    v_bitop3_b32 v15, v84, v86, v11 bitop3:0x7e
    s_waitcnt vmcnt(1)
    v_mfma_f32_16x16x32_bf16 v[96:99], v[104:107], v[16:19], v[96:99]
    v_bitop3_b32 v30, v104, v106, v11 bitop3:0x7e
    v_or3_b32 v14, v14, v15, v30
    s_waitcnt vmcnt(0)
    v_mfma_f32_16x16x32_bf16 v[96:99], v[108:111], v[16:19], v[96:99]
    v_bitop3_b32 v15, v108, v110, v11 bitop3:0x7e
    v_bitop3_b32 v14, v14, v15, 1 bitop3:0xa8
    v_cmp_ne_u32 vcc, 0, v14
    s_cbranch_vccz L_redok_55
    buffer_load_dwordx4 v[32:35], v9, s[4:7], 0 offen offset:0 sc1
    buffer_load_dwordx4 v[36:39], v9, s[4:7], 0 offen offset:1024 sc1
    buffer_load_dwordx4 v[40:43], v9, s[4:7], 0 offen offset:2048 sc1
    buffer_load_dwordx4 v[44:47], v9, s[4:7], 0 offen offset:3072 sc1
    buffer_load_dwordx4 v[48:51], v9, s[4:7], s48 offen offset:0 sc1
    buffer_load_dwordx4 v[52:55], v9, s[4:7], s48 offen offset:1024 sc1
    buffer_load_dwordx4 v[56:59], v9, s[4:7], s48 offen offset:2048 sc1
    buffer_load_dwordx4 v[60:63], v9, s[4:7], s48 offen offset:3072 sc1
    s_sleep 1
    s_sleep 1
    s_sleep 1
    buffer_load_dwordx4 v[64:67], v9, s[4:7], 0 offen offset:0 sc1
    buffer_load_dwordx4 v[68:71], v9, s[4:7], 0 offen offset:1024 sc1
    buffer_load_dwordx4 v[72:75], v9, s[4:7], 0 offen offset:2048 sc1
    buffer_load_dwordx4 v[76:79], v9, s[4:7], 0 offen offset:3072 sc1
    buffer_load_dwordx4 v[80:83], v9, s[4:7], s48 offen offset:0 sc1
    buffer_load_dwordx4 v[84:87], v9, s[4:7], s48 offen offset:1024 sc1
    buffer_load_dwordx4 v[104:107], v9, s[4:7], s48 offen offset:2048 sc1
    buffer_load_dwordx4 v[108:111], v9, s[4:7], s48 offen offset:3072 sc1
    s_waitcnt vmcnt(15)
    v_mfma_f32_16x16x32_bf16 v[96:99], v[32:35], v[16:19], 0
    v_bitop3_b32 v14, v32, v34, v11 bitop3:0x7e
    s_waitcnt vmcnt(14)
    v_mfma_f32_16x16x32_bf16 v[96:99], v[36:39], v[16:19], v[96:99]
    v_bitop3_b32 v15, v36, v38, v11 bitop3:0x7e
    s_waitcnt vmcnt(13)
    v_mfma_f32_16x16x32_bf16 v[96:99], v[40:43], v[16:19], v[96:99]
    v_bitop3_b32 v30, v40, v42, v11 bitop3:0x7e
    v_or3_b32 v14, v14, v15, v30
    s_waitcnt vmcnt(12)
    v_mfma_f32_16x16x32_bf16 v[96:99], v[44:47], v[16:19], v[96:99]
    v_bitop3_b32 v15, v44, v46, v11 bitop3:0x7e
    s_waitcnt vmcnt(11)
    v_mfma_f32_16x16x32_bf16 v[96:99], v[48:51], v[16:19], v[96:99]
    v_bitop3_b32 v30, v48, v50, v11 bitop3:0x7e
    v_or3_b32 v14, v14, v15, v30
    s_waitcnt vmcnt(10)
    v_mfma_f32_16x16x32_bf16 v[96:99], v[52:55], v[16:19], v[96:99]
    v_bitop3_b32 v15, v52, v54, v11 bitop3:0x7e
    s_waitcnt vmcnt(9)
    v_mfma_f32_16x16x32_bf16 v[96:99], v[56:59], v[16:19], v[96:99]
    v_bitop3_b32 v30, v56, v58, v11 bitop3:0x7e
    v_or3_b32 v14, v14, v15, v30
    s_waitcnt vmcnt(8)
    v_mfma_f32_16x16x32_bf16 v[96:99], v[60:63], v[16:19], v[96:99]
    v_bitop3_b32 v15, v60, v62, v11 bitop3:0x7e
    v_bitop3_b32 v14, v14, v15, 1 bitop3:0xa8
    v_cmp_ne_u32 vcc, 0, v14
    s_cbranch_vccz L_redok_55
L_red_54:
    s_waitcnt vmcnt(7)
    v_mfma_f32_16x16x32_bf16 v[96:99], v[64:67], v[16:19], 0
    buffer_load_dwordx4 v[32:35], v9, s[4:7], 0 offen offset:0 sc1
    v_bitop3_b32 v14, v64, v66, v11 bitop3:0x7e
    s_waitcnt vmcnt(7)
    v_mfma_f32_16x16x32_bf16 v[96:99], v[68:71], v[16:19], v[96:99]
    buffer_load_dwordx4 v[36:39], v9, s[4:7], 0 offen offset:1024 sc1
    v_bitop3_b32 v15, v68, v70, v11 bitop3:0x7e
    s_waitcnt vmcnt(7)
    v_mfma_f32_16x16x32_bf16 v[96:99], v[72:75], v[16:19], v[96:99]
    buffer_load_dwordx4 v[40:43], v9, s[4:7], 0 offen offset:2048 sc1
    v_bitop3_b32 v30, v72, v74, v11 bitop3:0x7e
    v_or3_b32 v14, v14, v15, v30
    s_waitcnt vmcnt(7)
    v_mfma_f32_16x16x32_bf16 v[96:99], v[76:79], v[16:19], v[96:99]
    buffer_load_dwordx4 v[44:47], v9, s[4:7], 0 offen offset:3072 sc1
    v_bitop3_b32 v15, v76, v78, v11 bitop3:0x7e
    s_waitcnt vmcnt(7)
    v_mfma_f32_16x16x32_bf16 v[96:99], v[80:83], v[16:19], v[96:99]
    buffer_load_dwordx4 v[48:51], v9, s[4:7], s48 offen offset:0 sc1
    v_bitop3_b32 v30, v80, v82, v11 bitop3:0x7e
    v_or3_b32 v14, v14, v15, v30
    s_waitcnt vmcnt(7)
    v_mfma_f32_16x16x32_bf16 v[96:99], v[84:87], v[16:19], v[96:99]
    buffer_load_dwordx4 v[52:55], v9, s[4:7], s48 offen offset:1024 sc1
    v_bitop3_b32 v15, v84, v86, v11 bitop3:0x7e
    s_waitcnt vmcnt(7)
    v_mfma_f32_16x16x32_bf16 v[96:99], v[104:107], v[16:19], v[96:99]
    buffer_load_dwordx4 v[56:59], v9, s[4:7], s48 offen offset:2048 sc1
    v_bitop3_b32 v30, v104, v106, v11 bitop3:0x7e
    v_or3_b32 v14, v14, v15, v30
    s_waitcnt vmcnt(7)
    v_mfma_f32_16x16x32_bf16 v[96:99], v[108:111], v[16:19], v[96:99]
    buffer_load_dwordx4 v[60:63], v9, s[4:7], s48 offen offset:3072 sc1
    v_bitop3_b32 v15, v108, v110, v11 bitop3:0x7e
    v_bitop3_b32 v14, v14, v15, 1 bitop3:0xa8
    v_cmp_ne_u32 vcc, 0, v14
    s_cbranch_vccz L_redok2_57
    s_waitcnt vmcnt(7)
    v_mfma_f32_16x16x32_bf16 v[96:99], v[32:35], v[16:19], 0
    buffer_load_dwordx4 v[64:67], v9, s[4:7], 0 offen offset:0 sc1
    v_bitop3_b32 v14, v32, v34, v11 bitop3:0x7e
    s_waitcnt vmcnt(7)
    v_mfma_f32_16x16x32_bf16 v[96:99], v[36:39], v[16:19], v[96:99]
    buffer_load_dwordx4 v[68:71], v9, s[4:7], 0 offen offset:1024 sc1
    v_bitop3_b32 v15, v36, v38, v11 bitop3:0x7e
    s_waitcnt vmcnt(7)
    v_mfma_f32_16x16x32_bf16 v[96:99], v[40:43], v[16:19], v[96:99]
    buffer_load_dwordx4 v[72:75], v9, s[4:7], 0 offen offset:2048 sc1
    v_bitop3_b32 v30, v40, v42, v11 bitop3:0x7e
    v_or3_b32 v14, v14, v15, v30
    s_waitcnt vmcnt(7)
    v_mfma_f32_16x16x32_bf16 v[96:99], v[44:47], v[16:19], v[96:99]
    buffer_load_dwordx4 v[76:79], v9, s[4:7], 0 offen offset:3072 sc1
    v_bitop3_b32 v15, v44, v46, v11 bitop3:0x7e
    s_waitcnt vmcnt(7)
    v_mfma_f32_16x16x32_bf16 v[96:99], v[48:51], v[16:19], v[96:99]
    buffer_load_dwordx4 v[80:83], v9, s[4:7], s48 offen offset:0 sc1
    v_bitop3_b32 v30, v48, v50, v11 bitop3:0x7e
    v_or3_b32 v14, v14, v15, v30
    s_waitcnt vmcnt(7)
    v_mfma_f32_16x16x32_bf16 v[96:99], v[52:55], v[16:19], v[96:99]
    buffer_load_dwordx4 v[84:87], v9, s[4:7], s48 offen offset:1024 sc1
    v_bitop3_b32 v15, v52, v54, v11 bitop3:0x7e
    s_waitcnt vmcnt(7)
    v_mfma_f32_16x16x32_bf16 v[96:99], v[56:59], v[16:19], v[96:99]
    buffer_load_dwordx4 v[104:107], v9, s[4:7], s48 offen offset:2048 sc1
    v_bitop3_b32 v30, v56, v58, v11 bitop3:0x7e
    v_or3_b32 v14, v14, v15, v30
    s_waitcnt vmcnt(7)
    v_mfma_f32_16x16x32_bf16 v[96:99], v[60:63], v[16:19], v[96:99]
    buffer_load_dwordx4 v[108:111], v9, s[4:7], s48 offen offset:3072 sc1
    v_bitop3_b32 v15, v60, v62, v11 bitop3:0x7e
    v_bitop3_b32 v14, v14, v15, 1 bitop3:0xa8
    v_cmp_ne_u32 vcc, 0, v14
    s_cbranch_vccz L_redok2_57
    s_add_u32 s54, s54, 1
    s_cmp_lg_u32 s41, 0
    s_cbranch_scc1 L_redok2_57
    s_cmp_lt_u32 s54, 65536
    s_cbranch_scc1 L_red_54
    s_mov_b32 s41, 1
L_redok2_57:
    s_waitcnt vmcnt(0)
    s_branch L_redok_55
L_notred_53:
    s_mov_b32 s54, 0
    s_waitcnt vmcnt(10)
    v_readfirstlane_b32 s35, v12
    v_mov_b64 v[112:113], 0
    v_mov_b64 v[114:115], 0
    v_mov_b64 v[116:117], 0
    v_mov_b64 v[118:119], 0
    v_mov_b64 v[120:121], 0
    v_mov_b64 v[122:123], 0
    v_mov_b64 v[124:125], 0
    v_mov_b64 v[126:127], 0
    v_mov_b64 v[88:89], 0
    v_mov_b64 v[90:91], 0
    v_mov_b64 v[92:93], 0
    v_mov_b64 v[94:95], 0
    s_cmp_ge_u32 s35, s79
    s_cbranch_scc1 L_fok_58
    s_cmp_lg_u32 s41, 0
    s_cbranch_scc1 L_fok_58
    s_mov_b32 s54, 0
L_fsp_59:
    buffer_load_dword v12, off, s[4:7], s78 sc1
    s_waitcnt vmcnt(0)
    v_readfirstlane_b32 s35, v12
    s_cmp_ge_u32 s35, s79
    s_cbranch_scc1 L_fok_58
    s_sleep 1
    s_add_u32 s54, s54, 1
    s_cmp_lt_u32 s54, 131072
    s_cbranch_scc1 L_fsp_59
    s_mov_b32 s41, 1
L_fok_58:
    s_sub_u32 s35, s45, 57
    s_cmp_lt_u32 s35, 6
    s_cbranch_scc1 L_cfa_s
L_cfar_s:
    s_add_u32 s45, s45, 1
    s_add_u32 s50, s50, 0x20000
    s_add_u32 s51, s51, 0x80000
    s_add_u32 s84, s84, 0x80000
    s_add_u32 s80, s80, 4
    s_cmp_eq_u32 s80, 20
    s_cselect_b32 s80, 0, s80
    s_addc_u32 s81, s81, 0
    s_add_u32 s78, s67, s80
    s_cmp_lt_u32 s45, 62
    s_cselect_b32 s79, s81, 0
    s_cmp_eq_u32 s45, 62
    s_cselect_b32 s78, 0x121f80, s78
    s_cselect_b32 s79, 32, s79
    s_cmp_eq_u32 s45, 63
    s_cselect_b32 s84, 0x40000000, s84
    s_cselect_b32 s78, 0x40000000, s78
    buffer_store_dwordx4 v[16:19], v10, s[4:7], s56 offen sc1
    s_branch L_top_s
L_retry0_s:
    s_mov_b64 exec, vcc
    buffer_load_dwordx4 v[48:51], v0, s[4:7], s85 offen sc1
    buffer_load_dwordx4 v[52:55], v0, s[4:7], s85 offen offset:1024 sc1
    s_mov_b64 exec, -1
    s_nop 3
    v_mov_b64 v[112:113], 0
    v_mov_b64 v[114:115], 0
    v_mov_b64 v[116:117], 0
    v_mov_b64 v[118:119], 0
    s_waitcnt vmcnt(2)
    ds_write_b128 v6, v[56:59]
    v_max3_u32 v64, v56, v58, v60
    ds_write_b128 v6, v[60:63] offset:1024
    v_max_u32 v64, v64, v62
    v_cmp_eq_u32 vcc, -1, v64
    s_add_u32 s54, s54, 1
    s_cbranch_vccz L_own1_s
    s_mov_b64 exec, vcc
    buffer_load_dwordx4 v[56:59], v0, s[4:7], s85 offen sc1
    buffer_load_dwordx4 v[60:63], v0, s[4:7], s85 offen offset:1024 sc1
    s_mov_b64 exec, -1
    s_cmp_lg_u32 s41, 0
    s_cbranch_scc1 L_own1_s
    s_cmp_lt_u32 s54, 65536
    s_cbranch_scc1 L_spec_s
    s_mov_b32 s41, 1
L_own1_s:
    v_smfmac_f32_16x16x64_bf16 v[112:115], v[56:59], a[0:7], v2
    v_smfmac_f32_16x16x64_bf16 v[116:119], v[56:59], a[8:15], v2
    v_smfmac_f32_16x16x64_bf16 v[112:115], v[60:63], a[16:23], v2
    v_smfmac_f32_16x16x64_bf16 v[116:119], v[60:63], a[24:31], v2
    s_waitcnt lgkmcnt(0)
    s_barrier
    v_smfmac_f32_16x16x64_bf16 v[88:91], v[56:59], a[128:135], v2
    ds_read_b128 v[64:67], v14 offset:0
    v_smfmac_f32_16x16x64_bf16 v[92:95], v[56:59], a[136:143], v2
    ds_read_b128 v[68:71], v14 offset:1024
    v_smfmac_f32_16x16x64_bf16 v[88:91], v[60:63], a[144:151], v2
    ds_read_b128 v[72:75], v15 offset:0
    v_smfmac_f32_16x16x64_bf16 v[92:95], v[60:63], a[152:159], v2
    ds_read_b128 v[76:79], v15 offset:1024
    v_smfmac_f32_16x16x64_bf16 v[120:123], v[56:59], v[128:135], v2
    s_add_u32 s38, s51, 8192
    ds_read_b128 v[80:83], v30 offset:0
    v_smfmac_f32_16x16x64_bf16 v[124:127], v[56:59], v[136:143], v2
    buffer_load_dwordx4 v0, s[4:7], s38 offen lds
    ds_read_b128 v[84:87], v30 offset:1024
    v_smfmac_f32_16x16x64_bf16 v[120:123], v[60:63], v[144:151], v2
    buffer_load_dwordx4 v0, s[4:7], s38 offen offset:1024 lds
    v_smfmac_f32_16x16x64_bf16 v[124:127], v[60:63], v[152:159], v2
    s_branch L_common_s
L_cfa_s:
    s_cmp_eq_u32 s45, 62
    s_cbranch_scc1 L_cfq_60
    s_branch L_cfar_s
L_cfq_60:
    s_lshl_b32 s35, s44, 13
    s_lshr_b32 s36, s32, 1
    s_lshl_b32 s36, s36, 12
    s_add_u32 s35, s35, s36
    s_and_b32 s36, s32, 1
    s_lshl_b32 s36, s36, 7
    s_add_u32 s35, s35, s36
    s_add_u32 s35, s35, 0x3fc0000
    v_and_b32 v14, 0x370, v0
    buffer_load_dwordx4 a[0:3], v14, s[4:7], s35 offen offset:0
    buffer_load_dwordx4 a[4:7], v14, s[4:7], s35 offen offset:1024
    buffer_load_dwordx4 a[8:11], v14, s[4:7], s35 offen offset:2048
    buffer_load_dwordx4 a[12:15], v14, s[4:7], s35 offen offset:3072
    s_branch L_cfar_s
L_cfq0_s:
    s_lshl_b32 s35, s44, 13
    s_lshr_b32 s36, s32, 1
    s_lshl_b32 s36, s36, 12
    s_add_u32 s35, s35, s36
    s_and_b32 s36, s32, 1
    s_lshl_b32 s36, s36, 7
    s_add_u32 s35, s35, s36
    s_add_u32 s35, s35, 0x3fc0000
    v_and_b32 v14, 0x370, v0
    buffer_load_dwordx4 a[0:3], v14, s[4:7], s35 offen offset:0
    buffer_load_dwordx4 a[4:7], v14, s[4:7], s35 offen offset:1024
    buffer_load_dwordx4 a[8:11], v14, s[4:7], s35 offen offset:2048
    buffer_load_dwordx4 a[12:15], v14, s[4:7], s35 offen offset:3072
    s_branch L_top_s
L_last_s:
    s_lshl_b32 s35, s32, 9
    v_lshrrev_b32 v113, 2, v0
    v_add_u32 v112, s35, v113
    ds_write_b32 v112, v30 offset:4096
    ds_write_b32 v112, v20 offset:4352
    v_bfe_u32 v114, v0, 4, 3
    v_lshrrev_b32 v115, 6, v0
    v_and_b32 v115, 12, v115
    v_sub_u32 v114, v114, v115
    s_lshl_b32 s35, s32, 3
    v_add_u32 v114, s35, v114
    s_mov_b32 s30, 0x200000
    s_mov_b32 s31, 0x00020000
    s_waitcnt vmcnt(4) lgkmcnt(0)
    s_barrier
    v_mfma_f32_16x16x32_bf16 v[96:99], v[48:51], a[0:3], 0
    ds_read_b32 v64, v113 offset:4096
    v_cmp_le_i32 s[12:13], 0, v114
    v_mfma_f32_16x16x32_bf16 v[100:103], v[52:55], a[0:3], 0
    ds_read_b32 v66, v113 offset:4352
    v_cmp_le_i32 s[14:15], 1, v114
    v_mfma_f32_16x16x32_bf16 v[96:99], v[56:59], a[4:7], v[96:99]
    ds_read_b32 v68, v113 offset:4608
    v_cmp_le_i32 s[16:17], 2, v114
    v_mfma_f32_16x16x32_bf16 v[100:103], v[60:63], a[4:7], v[100:103]
    ds_read_b32 v70, v113 offset:4864
    v_cmp_le_i32 s[18:19], 3, v114
    v_mfma_f32_16x16x32_bf16 v[96:99], v[32:35], a[8:11], v[96:99]
    ds_read_b32 v72, v113 offset:5120
    v_cmp_le_i32 s[20:21], 16, v114
    v_mfma_f32_16x16x32_bf16 v[100:103], v[36:39], a[8:11], v[100:103]
    ds_read_b32 v74, v113 offset:5376
    v_cmp_le_i32 s[22:23], 17, v114
    v_mfma_f32_16x16x32_bf16 v[96:99], v[40:43], a[12:15], v[96:99]
    ds_read_b32 v76, v113 offset:5632
    v_cmp_le_i32 s[24:25], 18, v114
    v_mfma_f32_16x16x32_bf16 v[100:103], v[44:47], a[12:15], v[100:103]
    ds_read_b32 v78, v113 offset:5888
    v_cmp_le_i32 s[26:27], 19, v114
    v_mfma_f32_16x16x32_bf16 v[104:107], v[80:83], a[0:3], 0
    s_waitcnt lgkmcnt(0)
    ds_read_b128 a[160:163], v0 offset:24576
    ds_read_b128 a[164:167], v0 offset:25600
    v_mov_b32 v65, 0
    v_mov_b32 v67, 0
    v_mfma_f32_16x16x32_bf16 v[104:107], v[84:87], a[4:7], v[104:107]
    ds_read_b128 a[168:171], v0 offset:26624
    ds_read_b128 a[172:175], v0 offset:27648
    v_mov_b32 v69, 0
    v_mov_b32 v71, 0
    v_mfma_f32_16x16x32_bf16 v[104:107], v[88:91], a[8:11], v[104:107]
    ds_read_b128 a[176:179], v0 offset:28672
    ds_read_b128 a[180:183], v0 offset:29696
    v_mov_b32 v73, 0
    v_mov_b32 v75, 0
    v_mfma_f32_16x16x32_bf16 v[104:107], v[92:95], a[12:15], v[104:107]
    ds_read_b128 a[184:187], v0 offset:30720
    ds_read_b128 a[188:191], v0 offset:31744
    v_mov_b32 v77, 0
    v_mov_b32 v79, 0
    v_mov_b32 v112, 0xff800000
    v_cndmask_b32 v96, v112, v96, s[12:13]
    v_cndmask_b32 v97, v112, v97, s[14:15]
    v_cndmask_b32 v98, v112, v98, s[16:17]
    v_cndmask_b32 v99, v112, v99, s[18:19]
    v_cndmask_b32 v100, v112, v100, s[20:21]
    v_cndmask_b32 v101, v112, v101, s[22:23]
    v_cndmask_b32 v102, v112, v102, s[24:25]
    v_cndmask_b32 v103, v112, v103, s[26:27]
    v_max3_f32 v14, v96, v97, v98
    v_max3_f32 v15, v99, v100, v101
    v_max3_f32 v14, v14, v102, v103
    v_max3_f32 v14, v14, v15, v104
    v_max_f32 v112, v14, v105
    v_max_f32 v115, v14, v105
    v_mov_b64 v[128:129], 0
    v_mov_b64 v[130:131], 0
    v_permlane16_swap_b32 v112, v115
    v_max_f32 v14, v112, v115
    v_max_f32 v15, v112, v115
    v_mov_b64 v[132:133], 0
    v_mov_b64 v[134:135], 0
    v_permlane32_swap_b32 v14, v15
    v_max_f32 v14, v14, v15
    v_mul_f32 v14, s53, v14
    s_waitcnt lgkmcnt(0)
    v_pk_fma_f32 v[96:97], v[96:97], s[52:53], v[14:15] op_sel_hi:[1,0,0]
    ds_read_b128 a[96:99], v7 offset:16384
    v_pk_fma_f32 v[98:99], v[98:99], s[52:53], v[14:15] op_sel_hi:[1,0,0]
    ds_read_b128 a[100:103], v7 offset:17408
    v_pk_fma_f32 v[100:101], v[100:101], s[52:53], v[14:15] op_sel_hi:[1,0,0]
    ds_read_b128 a[104:107], v7 offset:18432
    v_pk_fma_f32 v[102:103], v[102:103], s[52:53], v[14:15] op_sel_hi:[1,0,0]
    ds_read_b128 a[108:111], v7 offset:19456
    v_pk_fma_f32 v[104:105], v[104:105], s[52:53], v[14:15] op_sel_hi:[1,0,0]
    ds_read_b128 a[112:115], v7 offset:20480
    v_exp_f32 v96, v96
    ds_read_b128 a[116:119], v7 offset:21504
    v_exp_f32 v97, v97
    ds_read_b128 a[120:123], v7 offset:22528
    v_exp_f32 v98, v98
    v_cvt_pk_bf16_f32 v124, v96, v97
    ds_read_b128 a[124:127], v7 offset:23552
    v_exp_f32 v99, v99
    ds_read_b128 a[128:131], v7 offset:24576
    v_exp_f32 v100, v100
    v_cvt_pk_bf16_f32 v125, v98, v99
    ds_read_b128 a[132:135], v7 offset:25600
    v_exp_f32 v101, v101
    ds_read_b128 a[136:139], v7 offset:26624
    v_exp_f32 v102, v102
    v_cvt_pk_bf16_f32 v126, v100, v101
    ds_read_b128 a[140:143], v7 offset:27648
    v_exp_f32 v103, v103
    ds_read_b128 a[144:147], v7 offset:28672
    v_exp_f32 v104, v104
    v_cvt_pk_bf16_f32 v127, v102, v103
    v_exp_f32 v105, v105
    v_mfma_f32_16x16x32_bf16 v[120:123], v[22:25], v[124:127], 0
    v_cvt_pk_bf16_f32 v26, v104, v105
    v_mfma_f32_16x16x32_bf16 v[192:195], a[160:163], v[124:127], 0
    v_and_b32 v112, 0x1ff, v5
    ds_read_b128 a[148:151], v7 offset:29696
    v_mfma_f32_16x16x32_bf16 v[196:199], a[164:167], v[124:127], 0
    v_mfma_f32_16x16x32_bf16 v[120:123], v[22:25], v[26:29], v[120:123]
    s_lshl_b32 s35, s32, 11
    v_add_u32 v112, s35, v112
    ds_read_b128 a[152:155], v7 offset:30720
    v_mfma_f32_16x16x32_bf16 v[200:203], a[168:171], v[124:127], 0
    v_mov_b64 v[136:137], 0
    ds_read_b128 a[156:159], v7 offset:31744
    v_mfma_f32_16x16x32_bf16 v[204:207], a[172:175], v[124:127], 0
    v_mov_b64 v[138:139], 0
    v_mfma_f32_16x16x32_bf16 v[208:211], a[176:179], v[124:127], 0
    v_mov_b64 v[140:141], 0
    v_mfma_f32_16x16x32_bf16 v[212:215], a[180:183], v[124:127], 0
    v_rcp_f32 v14, v120
    v_mfma_f32_16x16x32_bf16 v[216:219], a[184:187], v[124:127], 0
    v_mov_b64 v[142:143], 0
    v_mfma_f32_16x16x32_bf16 v[220:223], a[188:191], v[124:127], 0
    v_mov_b64 v[144:145], 0
    v_mfma_f32_16x16x32_bf16 v[192:195], v[64:67], v[26:29], v[192:195]
    v_mov_b64 v[146:147], 0
    v_mov_b64 v[148:149], 0
    v_mfma_f32_16x16x32_bf16 v[196:199], v[66:69], v[26:29], v[196:199]
    v_mov_b64 v[150:151], 0
    v_mov_b64 v[152:153], 0
    v_mfma_f32_16x16x32_bf16 v[200:203], v[68:71], v[26:29], v[200:203]
    v_mov_b64 v[154:155], 0
    v_mov_b64 v[156:157], 0
    v_mfma_f32_16x16x32_bf16 v[204:207], v[70:73], v[26:29], v[204:207]
    v_pk_mul_f32 v[192:193], v[192:193], v[14:15] op_sel_hi:[1,0]
    v_pk_mul_f32 v[194:195], v[194:195], v[14:15] op_sel_hi:[1,0]
    v_mfma_f32_16x16x32_bf16 v[208:211], v[72:75], v[26:29], v[208:211]
    v_cvt_pk_bf16_f32 v96, v192, v193
    v_cvt_pk_bf16_f32 v97, v194, v195
    v_mfma_f32_16x16x32_bf16 v[212:215], v[74:77], v[26:29], v[212:215]
    v_pk_mul_f32 v[196:197], v[196:197], v[14:15] op_sel_hi:[1,0]
    v_pk_mul_f32 v[198:199], v[198:199], v[14:15] op_sel_hi:[1,0]
    v_mfma_f32_16x16x32_bf16 v[216:219], v[76:79], v[26:29], v[216:219]
    v_cvt_pk_bf16_f32 v98, v196, v197
    v_cvt_pk_bf16_f32 v99, v198, v199
    v_mfma_f32_16x16x32_bf16 v[220:223], v[78:81], v[26:29], v[220:223]
    v_pk_mul_f32 v[200:201], v[200:201], v[14:15] op_sel_hi:[1,0]
    v_pk_mul_f32 v[202:203], v[202:203], v[14:15] op_sel_hi:[1,0]
    v_cvt_pk_bf16_f32 v100, v200, v201
    v_cvt_pk_bf16_f32 v101, v202, v203
    v_pk_mul_f32 v[204:205], v[204:205], v[14:15] op_sel_hi:[1,0]
    v_pk_mul_f32 v[206:207], v[206:207], v[14:15] op_sel_hi:[1,0]
    v_cvt_pk_bf16_f32 v102, v204, v205
    v_cvt_pk_bf16_f32 v103, v206, v207
    ds_write_b128 v112, v[96:99] offset:8192
    ds_write_b128 v112, v[100:103] offset:8704
    v_pk_mul_f32 v[208:209], v[208:209], v[14:15] op_sel_hi:[1,0]
    v_pk_mul_f32 v[210:211], v[210:211], v[14:15] op_sel_hi:[1,0]
    v_cvt_pk_bf16_f32 v104, v208, v209
    v_cvt_pk_bf16_f32 v105, v210, v211
    v_pk_mul_f32 v[212:213], v[212:213], v[14:15] op_sel_hi:[1,0]
    v_pk_mul_f32 v[214:215], v[214:215], v[14:15] op_sel_hi:[1,0]
    v_cvt_pk_bf16_f32 v106, v212, v213
    v_cvt_pk_bf16_f32 v107, v214, v215
    ds_write_b128 v112, v[104:107] offset:9216
    v_pk_mul_f32 v[216:217], v[216:217], v[14:15] op_sel_hi:[1,0]
    v_pk_mul_f32 v[218:219], v[218:219], v[14:15] op_sel_hi:[1,0]
    v_cvt_pk_bf16_f32 v108, v216, v217
    v_cvt_pk_bf16_f32 v109, v218, v219
    v_mov_b64 v[158:159], 0
    v_mov_b64 v[160:161], 0
    v_pk_mul_f32 v[220:221], v[220:221], v[14:15] op_sel_hi:[1,0]
    v_pk_mul_f32 v[222:223], v[222:223], v[14:15] op_sel_hi:[1,0]
    v_cvt_pk_bf16_f32 v110, v220, v221
    v_cvt_pk_bf16_f32 v111, v222, v223
    ds_write_b128 v112, v[108:111] offset:9728
    v_xor_b32 v114, 0x200, v5
    v_xor_b32 v115, 0x400, v5
    v_xor_b32 v113, 0x600, v5
    v_mov_b64 v[162:163], 0
    v_mov_b64 v[164:165], 0
    v_mov_b64 v[166:167], 0
    v_mov_b64 v[168:169], 0
    v_mov_b64 v[170:171], 0
    v_mov_b64 v[172:173], 0
    v_mov_b64 v[174:175], 0
    v_mov_b64 v[176:177], 0
    v_mov_b64 v[178:179], 0
    v_mov_b64 v[180:181], 0
    v_mov_b64 v[182:183], 0
    v_mov_b64 v[184:185], 0
    v_mov_b64 v[186:187], 0
    v_mov_b64 v[188:189], 0
    v_mov_b64 v[190:191], 0
    s_waitcnt lgkmcnt(0)
    s_barrier
    ds_read_b128 v[32:35], v5 offset:4096
    ds_read_b128 v[36:39], v114 offset:4096
    ds_read_b128 v[40:43], v115 offset:4096
    ds_read_b128 v[44:47], v113 offset:4096
    ds_read_b128 v[48:51], v5 offset:6144
    ds_read_b128 v[52:55], v114 offset:6144
    ds_read_b128 v[56:59], v115 offset:6144
    ds_read_b128 v[60:63], v113 offset:6144
    v_mov_b32 v116, 0x3f80
    s_waitcnt lgkmcnt(7)
    v_smfmac_f32_16x16x64_bf16 v[128:131], v[32:35], a[224:231], v31
    v_bfe_u32 v15, v0, 4, 4
    v_smfmac_f32_16x16x64_bf16 v[132:135], v[32:35], a[232:239], v31
    v_and_b32 v14, 1, v15
    v_smfmac_f32_16x16x64_bf16 v[136:139], v[32:35], a[240:247], v31
    v_lshlrev_b32 v14, 4, v14
    v_smfmac_f32_16x16x64_bf16 v[140:143], v[32:35], a[248:255], v31
    s_waitcnt lgkmcnt(6)
    v_lshlrev_b32 v14, v14, v116
    v_smfmac_f32_16x16x64_bf16 v[128:131], v[36:39], v[224:231], v31
    ds_read_b128 v[64:67], v5 offset:8192
    v_lshrrev_b32 v15, 1, v15
    v_smfmac_f32_16x16x64_bf16 v[132:135], v[36:39], v[248:255], v31
    v_cmp_eq_u32 vcc, 0, v15
    v_smfmac_f32_16x16x64_bf16 v[136:139], v[36:39], a[112:119], v31
    ds_read_b128 v[68:71], v114 offset:8192
    v_cndmask_b32 v116, 0, v14, vcc
    v_smfmac_f32_16x16x64_bf16 v[140:143], v[36:39], a[136:143], v31
    v_cmp_eq_u32 vcc, 1, v15
    s_waitcnt lgkmcnt(7)
    v_smfmac_f32_16x16x64_bf16 v[128:131], v[40:43], v[232:239], v31
    ds_read_b128 v[72:75], v115 offset:8192
    v_cndmask_b32 v117, 0, v14, vcc
    v_smfmac_f32_16x16x64_bf16 v[132:135], v[40:43], a[96:103], v31
    v_cmp_eq_u32 vcc, 2, v15
    v_smfmac_f32_16x16x64_bf16 v[136:139], v[40:43], a[120:127], v31
    ds_read_b128 v[76:79], v113 offset:8192
    v_cndmask_b32 v118, 0, v14, vcc
    v_smfmac_f32_16x16x64_bf16 v[140:143], v[40:43], a[144:151], v31
    v_cmp_eq_u32 vcc, 3, v15
    s_waitcnt lgkmcnt(8)
    v_smfmac_f32_16x16x64_bf16 v[128:131], v[44:47], v[240:247], v31
    v_cndmask_b32 v119, 0, v14, vcc
    v_smfmac_f32_16x16x64_bf16 v[132:135], v[44:47], a[104:111], v31
    v_and_b32 v120, 0x70, v0
    v_smfmac_f32_16x16x64_bf16 v[136:139], v[44:47], a[128:135], v31
    v_lshrrev_b32 v121, 2, v120
    v_smfmac_f32_16x16x64_bf16 v[140:143], v[44:47], a[152:159], v31
    s_lshl_b32 s56, s32, 5
    s_add_u32 s56, s56, 0x5801f80
    buffer_load_dword a84, v121, s[4:7], s56 offen
    s_lshl_b32 s56, s32, 14
    s_lshl_b32 s81, s44, 6
    s_add_u32 s56, s56, s81
    s_add_u32 s56, s56, 0xb10000
    v_lshlrev_b32 v120, 7, v120
    v_lshrrev_b32 v122, 8, v0
    v_lshlrev_b32 v122, 4, v122
    v_add_u32 v120, v120, v122
    buffer_load_dwordx4 a[80:83], v120, s[4:7], s56 offen
    s_waitcnt lgkmcnt(7)
    v_smfmac_f32_16x16x64_bf16 v[144:147], v[48:51], a[224:231], v31
    v_smfmac_f32_16x16x64_bf16 v[148:151], v[48:51], a[232:239], v31
    v_smfmac_f32_16x16x64_bf16 v[152:155], v[48:51], a[240:247], v31
    s_mov_b32 s35, 0xa00000
    v_cvt_pk_bf16_f32 v128, v128, v129
    v_smfmac_f32_16x16x64_bf16 v[156:159], v[48:51], a[248:255], v31
    s_waitcnt lgkmcnt(6)
    v_cvt_pk_bf16_f32 v129, v130, v131
    v_smfmac_f32_16x16x64_bf16 v[144:147], v[52:55], v[224:231], v31
    ds_read_b128 v[80:83], v5 offset:10240
    v_or_b32 v128, 1, v128
    v_smfmac_f32_16x16x64_bf16 v[148:151], v[52:55], v[248:255], v31
    buffer_store_dwordx2 v[128:129], v8, s[4:7], s35 offen sc1
    v_smfmac_f32_16x16x64_bf16 v[152:155], v[52:55], a[112:119], v31
    ds_read_b128 v[84:87], v114 offset:10240
    s_mov_b32 s36, 0xa04000
    v_cvt_pk_bf16_f32 v132, v132, v133
    v_smfmac_f32_16x16x64_bf16 v[156:159], v[52:55], a[136:143], v31
    s_waitcnt lgkmcnt(7)
    v_cvt_pk_bf16_f32 v133, v134, v135
    v_smfmac_f32_16x16x64_bf16 v[144:147], v[56:59], v[232:239], v31
    ds_read_b128 v[88:91], v115 offset:10240
    v_or_b32 v132, 1, v132
    v_smfmac_f32_16x16x64_bf16 v[148:151], v[56:59], a[96:103], v31
    buffer_store_dwordx2 v[132:133], v8, s[4:7], s36 offen sc1
    v_smfmac_f32_16x16x64_bf16 v[152:155], v[56:59], a[120:127], v31
    ds_read_b128 v[92:95], v113 offset:10240
    s_mov_b32 s37, 0xa08000
    v_cvt_pk_bf16_f32 v136, v136, v137
    v_smfmac_f32_16x16x64_bf16 v[156:159], v[56:59], a[144:151], v31
    s_waitcnt lgkmcnt(8)
    v_cvt_pk_bf16_f32 v137, v138, v139
    v_smfmac_f32_16x16x64_bf16 v[144:147], v[60:63], v[240:247], v31
    v_or_b32 v136, 1, v136
    v_smfmac_f32_16x16x64_bf16 v[148:151], v[60:63], a[104:111], v31
    buffer_store_dwordx2 v[136:137], v8, s[4:7], s37 offen sc1
    v_smfmac_f32_16x16x64_bf16 v[152:155], v[60:63], a[128:135], v31
    s_mov_b32 s38, 0xa0c000
    v_cvt_pk_bf16_f32 v140, v140, v141
    v_smfmac_f32_16x16x64_bf16 v[156:159], v[60:63], a[152:159], v31
    v_cvt_pk_bf16_f32 v141, v142, v143
    v_or_b32 v140, 1, v140
    buffer_store_dwordx2 v[140:141], v8, s[4:7], s38 offen sc1
    s_lshl_b32 s56, s32, 18
    s_add_u32 s56, s56, 0xa00000
    s_add_u32 s81, s56, 4096
    s_waitcnt lgkmcnt(7)
    v_smfmac_f32_16x16x64_bf16 v[160:163], v[64:67], a[224:231], v31
    v_smfmac_f32_16x16x64_bf16 v[164:167], v[64:67], a[232:239], v31
    v_smfmac_f32_16x16x64_bf16 v[168:171], v[64:67], a[240:247], v31
    s_mov_b32 s35, 0xa40000
    v_cvt_pk_bf16_f32 v144, v144, v145
    v_smfmac_f32_16x16x64_bf16 v[172:175], v[64:67], a[248:255], v31
    s_waitcnt lgkmcnt(6)
    v_cvt_pk_bf16_f32 v145, v146, v147
    v_smfmac_f32_16x16x64_bf16 v[160:163], v[68:71], v[224:231], v31
    v_or_b32 v144, 1, v144
    v_smfmac_f32_16x16x64_bf16 v[164:167], v[68:71], v[248:255], v31
    buffer_store_dwordx2 v[144:145], v8, s[4:7], s35 offen sc1
    v_smfmac_f32_16x16x64_bf16 v[168:171], v[68:71], a[112:119], v31
    s_mov_b32 s36, 0xa44000
    v_cvt_pk_bf16_f32 v148, v148, v149
    v_smfmac_f32_16x16x64_bf16 v[172:175], v[68:71], a[136:143], v31
    s_waitcnt lgkmcnt(5)
    v_cvt_pk_bf16_f32 v149, v150, v151
    v_smfmac_f32_16x16x64_bf16 v[160:163], v[72:75], v[232:239], v31
    v_or_b32 v148, 1, v148
    v_smfmac_f32_16x16x64_bf16 v[164:167], v[72:75], a[96:103], v31
    buffer_store_dwordx2 v[148:149], v8, s[4:7], s36 offen sc1
    v_smfmac_f32_16x16x64_bf16 v[168:171], v[72:75], a[120:127], v31
    s_mov_b32 s37, 0xa48000
    v_cvt_pk_bf16_f32 v152, v152, v153
    v_smfmac_f32_16x16x64_bf16 v[172:175], v[72:75], a[144:151], v31
    s_waitcnt lgkmcnt(4)
    v_cvt_pk_bf16_f32 v153, v154, v155
    v_smfmac_f32_16x16x64_bf16 v[160:163], v[76:79], v[240:247], v31
    v_or_b32 v152, 1, v152
    v_smfmac_f32_16x16x64_bf16 v[164:167], v[76:79], a[104:111], v31
    buffer_store_dwordx2 v[152:153], v8, s[4:7], s37 offen sc1
    v_smfmac_f32_16x16x64_bf16 v[168:171], v[76:79], a[128:135], v31
    s_mov_b32 s38, 0xa4c000
    v_cvt_pk_bf16_f32 v156, v156, v157
    v_smfmac_f32_16x16x64_bf16 v[172:175], v[76:79], a[152:159], v31
    v_cvt_pk_bf16_f32 v157, v158, v159
    v_or_b32 v156, 1, v156
    buffer_store_dwordx2 v[156:157], v8, s[4:7], s38 offen sc1
    v_bfe_u32 v112, v0, 4, 4
    v_lshlrev_b32 v113, 10, v112
    v_lshrrev_b32 v112, 3, v112
    v_lshlrev_b32 v112, 30, v112
    v_add_u32 v113, v113, v112
    v_lshrrev_b32 v112, 8, v0
    v_lshlrev_b32 v112, 3, v112
    v_add_u32 v113, v113, v112
    s_lshl_b32 s79, s32, 13
    s_lshl_b32 s54, s44, 5
    s_add_u32 s79, s79, s54
    s_add_u32 s79, s79, 0x1f8000
    s_mov_b32 s54, 0
    s_cmp_ge_u32 s32, 2
    s_cbranch_scc1 L_cfb_61
    s_waitcnt lgkmcnt(3)
    v_smfmac_f32_16x16x64_bf16 v[176:179], v[80:83], a[224:231], v31
    buffer_load_dwordx4 v[192:195], v9, s[4:7], s56 offen offset:0 sc1
    v_smfmac_f32_16x16x64_bf16 v[180:183], v[80:83], a[232:239], v31
    v_smfmac_f32_16x16x64_bf16 v[184:187], v[80:83], a[240:247], v31
    s_mov_b32 s35, 0xa80000
    buffer_load_dwordx4 v[196:199], v9, s[4:7], s56 offen offset:1024 sc1
    v_cvt_pk_bf16_f32 v160, v160, v161
    v_smfmac_f32_16x16x64_bf16 v[188:191], v[80:83], a[248:255], v31
    s_waitcnt lgkmcnt(2)
    v_cvt_pk_bf16_f32 v161, v162, v163
    v_smfmac_f32_16x16x64_bf16 v[176:179], v[84:87], v[224:231], v31
    buffer_load_dwordx4 v[200:203], v9, s[4:7], s56 offen offset:2048 sc1
    v_or_b32 v160, 1, v160
    v_smfmac_f32_16x16x64_bf16 v[180:183], v[84:87], v[248:255], v31
    buffer_store_dwordx2 v[160:161], v8, s[4:7], s35 offen sc1
    v_smfmac_f32_16x16x64_bf16 v[184:187], v[84:87], a[112:119], v31
    s_mov_b32 s36, 0xa84000
    buffer_load_dwordx4 v[204:207], v9, s[4:7], s56 offen offset:3072 sc1
    v_cvt_pk_bf16_f32 v164, v164, v165
    v_smfmac_f32_16x16x64_bf16 v[188:191], v[84:87], a[136:143], v31
    s_waitcnt lgkmcnt(1)
    v_cvt_pk_bf16_f32 v165, v166, v167
    v_smfmac_f32_16x16x64_bf16 v[176:179], v[88:91], v[232:239], v31
    buffer_load_dwordx4 v[208:211], v9, s[4:7], s81 offen offset:0 sc1
    v_or_b32 v164, 1, v164
    v_smfmac_f32_16x16x64_bf16 v[180:183], v[88:91], a[96:103], v31
    buffer_store_dwordx2 v[164:165], v8, s[4:7], s36 offen sc1
    v_smfmac_f32_16x16x64_bf16 v[184:187], v[88:91], a[120:127], v31
    s_mov_b32 s37, 0xa88000
    buffer_load_dwordx4 v[212:215], v9, s[4:7], s81 offen offset:1024 sc1
    v_cvt_pk_bf16_f32 v168, v168, v169
    v_smfmac_f32_16x16x64_bf16 v[188:191], v[88:91], a[144:151], v31
    s_waitcnt lgkmcnt(0)
    v_cvt_pk_bf16_f32 v169, v170, v171
    v_smfmac_f32_16x16x64_bf16 v[176:179], v[92:95], v[240:247], v31
    buffer_load_dwordx4 v[216:219], v9, s[4:7], s81 offen offset:2048 sc1
    v_or_b32 v168, 1, v168
    v_smfmac_f32_16x16x64_bf16 v[180:183], v[92:95], a[104:111], v31
    buffer_store_dwordx2 v[168:169], v8, s[4:7], s37 offen sc1
    v_smfmac_f32_16x16x64_bf16 v[184:187], v[92:95], a[128:135], v31
    s_mov_b32 s38, 0xa8c000
    buffer_load_dwordx4 v[220:223], v9, s[4:7], s81 offen offset:3072 sc1
    v_cvt_pk_bf16_f32 v172, v172, v173
    v_smfmac_f32_16x16x64_bf16 v[188:191], v[92:95], a[152:159], v31
    v_cvt_pk_bf16_f32 v173, v174, v175
    v_or_b32 v172, 1, v172
    buffer_store_dwordx2 v[172:173], v8, s[4:7], s38 offen sc1
    s_nop 3
    s_mov_b32 s35, 0xac0000
    v_cvt_pk_bf16_f32 v176, v176, v177
    s_nop 0
    v_cvt_pk_bf16_f32 v177, v178, v179
    v_or_b32 v176, 1, v176
    buffer_store_dwordx2 v[176:177], v8, s[4:7], s35 offen sc1
    s_mov_b32 s36, 0xac4000
    v_cvt_pk_bf16_f32 v180, v180, v181
    s_nop 0
    v_cvt_pk_bf16_f32 v181, v182, v183
    v_or_b32 v180, 1, v180
    buffer_store_dwordx2 v[180:181], v8, s[4:7], s36 offen sc1
    s_mov_b32 s37, 0xac8000
    v_cvt_pk_bf16_f32 v184, v184, v185
    s_nop 0
    v_cvt_pk_bf16_f32 v185, v186, v187
    v_or_b32 v184, 1, v184
    buffer_store_dwordx2 v[184:185], v8, s[4:7], s37 offen sc1
    s_mov_b32 s38, 0xacc000
    v_cvt_pk_bf16_f32 v188, v188, v189
    s_nop 0
    v_cvt_pk_bf16_f32 v189, v190, v191
    v_or_b32 v188, 1, v188
    buffer_store_dwordx2 v[188:189], v8, s[4:7], s38 offen sc1
    s_waitcnt vmcnt(15)
    v_mfma_f32_16x16x32_bf16 v[96:99], v[192:195], v[116:119], 0
    v_and_b32 v14, v192, v194
    s_waitcnt vmcnt(14)
    v_mfma_f32_16x16x32_bf16 v[96:99], v[196:199], v[116:119], v[96:99]
    v_bitop3_b32 v14, v14, v196, v198 bitop3:0x80
    s_waitcnt vmcnt(13)
    v_mfma_f32_16x16x32_bf16 v[96:99], v[200:203], v[116:119], v[96:99]
    v_bitop3_b32 v14, v14, v200, v202 bitop3:0x80
    s_waitcnt vmcnt(11)
    v_mfma_f32_16x16x32_bf16 v[96:99], v[204:207], v[116:119], v[96:99]
    v_bitop3_b32 v14, v14, v204, v206 bitop3:0x80
    s_waitcnt vmcnt(10)
    v_mfma_f32_16x16x32_bf16 v[96:99], v[208:211], v[116:119], v[96:99]
    v_bitop3_b32 v14, v14, v208, v210 bitop3:0x80
    s_waitcnt vmcnt(8)
    v_mfma_f32_16x16x32_bf16 v[96:99], v[212:215], v[116:119], v[96:99]
    v_bitop3_b32 v14, v14, v212, v214 bitop3:0x80
    s_waitcnt vmcnt(7)
    v_mfma_f32_16x16x32_bf16 v[96:99], v[216:219], v[116:119], v[96:99]
    v_bitop3_b32 v14, v14, v216, v218 bitop3:0x80
    s_waitcnt vmcnt(5)
    v_mfma_f32_16x16x32_bf16 v[96:99], v[220:223], v[116:119], v[96:99]
    v_bitop3_b32 v14, v14, v220, v222 bitop3:0x80
    v_and_b32 v14, 1, v14
    v_cmp_ne_u32 vcc, 1, v14
    s_cbranch_vccz L_cfok_63
    s_branch L_cfp_62
L_cfb_61:
    s_waitcnt lgkmcnt(3)
    v_smfmac_f32_16x16x64_bf16 v[176:179], v[80:83], a[224:231], v31
    v_smfmac_f32_16x16x64_bf16 v[180:183], v[80:83], a[232:239], v31
    v_smfmac_f32_16x16x64_bf16 v[184:187], v[80:83], a[240:247], v31
    s_mov_b32 s35, 0xa80000
    v_cvt_pk_bf16_f32 v160, v160, v161
    v_smfmac_f32_16x16x64_bf16 v[188:191], v[80:83], a[248:255], v31
    s_waitcnt lgkmcnt(2)
    v_cvt_pk_bf16_f32 v161, v162, v163
    v_smfmac_f32_16x16x64_bf16 v[176:179], v[84:87], v[224:231], v31
    v_or_b32 v160, 1, v160
    v_smfmac_f32_16x16x64_bf16 v[180:183], v[84:87], v[248:255], v31
    buffer_store_dwordx2 v[160:161], v8, s[4:7], s35 offen sc1
    v_smfmac_f32_16x16x64_bf16 v[184:187], v[84:87], a[112:119], v31
    s_mov_b32 s36, 0xa84000
    v_cvt_pk_bf16_f32 v164, v164, v165
    v_smfmac_f32_16x16x64_bf16 v[188:191], v[84:87], a[136:143], v31
    s_waitcnt lgkmcnt(1)
    v_cvt_pk_bf16_f32 v165, v166, v167
    v_smfmac_f32_16x16x64_bf16 v[176:179], v[88:91], v[232:239], v31
    v_or_b32 v164, 1, v164
    v_smfmac_f32_16x16x64_bf16 v[180:183], v[88:91], a[96:103], v31
    buffer_store_dwordx2 v[164:165], v8, s[4:7], s36 offen sc1
    v_smfmac_f32_16x16x64_bf16 v[184:187], v[88:91], a[120:127], v31
    s_mov_b32 s37, 0xa88000
    v_cvt_pk_bf16_f32 v168, v168, v169
    v_smfmac_f32_16x16x64_bf16 v[188:191], v[88:91], a[144:151], v31
    s_waitcnt lgkmcnt(0)
    v_cvt_pk_bf16_f32 v169, v170, v171
    v_smfmac_f32_16x16x64_bf16 v[176:179], v[92:95], v[240:247], v31
    v_or_b32 v168, 1, v168
    v_smfmac_f32_16x16x64_bf16 v[180:183], v[92:95], a[104:111], v31
    buffer_store_dwordx2 v[168:169], v8, s[4:7], s37 offen sc1
    v_smfmac_f32_16x16x64_bf16 v[184:187], v[92:95], a[128:135], v31
    s_mov_b32 s38, 0xa8c000
    v_cvt_pk_bf16_f32 v172, v172, v173
    v_smfmac_f32_16x16x64_bf16 v[188:191], v[92:95], a[152:159], v31
    v_cvt_pk_bf16_f32 v173, v174, v175
    v_or_b32 v172, 1, v172
    buffer_store_dwordx2 v[172:173], v8, s[4:7], s38 offen sc1
    s_nop 3
    s_mov_b32 s35, 0xac0000
    v_cvt_pk_bf16_f32 v176, v176, v177
    s_nop 0
    v_cvt_pk_bf16_f32 v177, v178, v179
    v_or_b32 v176, 1, v176
    buffer_store_dwordx2 v[176:177], v8, s[4:7], s35 offen sc1
    s_mov_b32 s36, 0xac4000
    v_cvt_pk_bf16_f32 v180, v180, v181
    s_nop 0
    v_cvt_pk_bf16_f32 v181, v182, v183
    v_or_b32 v180, 1, v180
    buffer_store_dwordx2 v[180:181], v8, s[4:7], s36 offen sc1
    s_mov_b32 s37, 0xac8000
    v_cvt_pk_bf16_f32 v184, v184, v185
    s_nop 0
    v_cvt_pk_bf16_f32 v185, v186, v187
    v_or_b32 v184, 1, v184
    buffer_store_dwordx2 v[184:185], v8, s[4:7], s37 offen sc1
    s_mov_b32 s38, 0xacc000
    v_cvt_pk_bf16_f32 v188, v188, v189
    s_nop 0
    v_cvt_pk_bf16_f32 v189, v190, v191
    v_or_b32 v188, 1, v188
    buffer_store_dwordx2 v[188:189], v8, s[4:7], s38 offen sc1
    s_cmp_eq_u32 s32, 2
    s_cbranch_scc1 L_cfp_62
    s_sleep 1
L_cfp_62:
    buffer_load_dwordx4 v[192:195], v9, s[4:7], s56 offen offset:0 sc1
    buffer_load_dwordx4 v[196:199], v9, s[4:7], s56 offen offset:1024 sc1
    buffer_load_dwordx4 v[200:203], v9, s[4:7], s56 offen offset:2048 sc1
    buffer_load_dwordx4 v[204:207], v9, s[4:7], s56 offen offset:3072 sc1
    buffer_load_dwordx4 v[208:211], v9, s[4:7], s81 offen offset:0 sc1
    buffer_load_dwordx4 v[212:215], v9, s[4:7], s81 offen offset:1024 sc1
    buffer_load_dwordx4 v[216:219], v9, s[4:7], s81 offen offset:2048 sc1
    buffer_load_dwordx4 v[220:223], v9, s[4:7], s81 offen offset:3072 sc1
    s_waitcnt vmcnt(7)
    v_mfma_f32_16x16x32_bf16 v[96:99], v[192:195], v[116:119], 0
    v_and_b32 v14, v192, v194
    s_waitcnt vmcnt(6)
    v_mfma_f32_16x16x32_bf16 v[96:99], v[196:199], v[116:119], v[96:99]
    v_bitop3_b32 v14, v14, v196, v198 bitop3:0x80
    s_waitcnt vmcnt(5)
    v_mfma_f32_16x16x32_bf16 v[96:99], v[200:203], v[116:119], v[96:99]
    v_bitop3_b32 v14, v14, v200, v202 bitop3:0x80
    s_waitcnt vmcnt(4)
    v_mfma_f32_16x16x32_bf16 v[96:99], v[204:207], v[116:119], v[96:99]
    v_bitop3_b32 v14, v14, v204, v206 bitop3:0x80
    s_waitcnt vmcnt(3)
    v_mfma_f32_16x16x32_bf16 v[96:99], v[208:211], v[116:119], v[96:99]
    v_bitop3_b32 v14, v14, v208, v210 bitop3:0x80
    s_waitcnt vmcnt(2)
    v_mfma_f32_16x16x32_bf16 v[96:99], v[212:215], v[116:119], v[96:99]
    v_bitop3_b32 v14, v14, v212, v214 bitop3:0x80
    s_waitcnt vmcnt(1)
    v_mfma_f32_16x16x32_bf16 v[96:99], v[216:219], v[116:119], v[96:99]
    v_bitop3_b32 v14, v14, v216, v218 bitop3:0x80
    s_waitcnt vmcnt(0)
    v_mfma_f32_16x16x32_bf16 v[96:99], v[220:223], v[116:119], v[96:99]
    v_bitop3_b32 v14, v14, v220, v222 bitop3:0x80
    v_and_b32 v14, 1, v14
    v_cmp_ne_u32 vcc, 1, v14
    s_cbranch_vccz L_cfok_63
    s_add_u32 s54, s54, 1
    s_cmp_lg_u32 s41, 0
    s_cbranch_scc1 L_cfok_63
    s_cmp_lt_u32 s54, 65536
    s_cbranch_scc1 L_cfp_62
    s_mov_b32 s41, 1
L_cfok_63:
    v_accvgpr_read_b32 v104, a80
    v_accvgpr_read_b32 v105, a81
    v_accvgpr_read_b32 v106, a82
    v_accvgpr_read_b32 v107, a83
    v_accvgpr_read_b32 v108, a84
    v_sub_f32 v96, v96, v104
    v_sub_f32 v97, v97, v105
    v_sub_f32 v98, v98, v106
    v_sub_f32 v99, v99, v107
    v_fma_f32 v96, v96, v108, v104
    v_fma_f32 v97, v97, v108, v105
    v_fma_f32 v98, v98, v108, v106
    v_fma_f32 v99, v99, v108, v107
    v_cvt_pk_bf16_f32 v100, v96, v97
    v_cvt_pk_bf16_f32 v101, v98, v99
    buffer_store_dwordx2 v[100:101], v113, s[28:31], s79 offen
    s_waitcnt vmcnt(0) lgkmcnt(0)
    s_branch L_role_end
    s_branch L_role_end
L_out:
    s_sub_u32 s44, s34, 1
    s_lshr_b32 s45, s33, 4
    s_and_b32 s46, s33, 15
    v_and_b32 v1, 63, v0
    v_lshlrev_b32 v2, 4, v1
    v_mov_b32 v10, 0
    v_mul_u32_u24 v3, 528, v1
    s_lshl_b32 s35, s32, 7
    v_add_u32 v3, s35, v3
    v_lshrrev_b32 v4, 5, v1
    v_mul_u32_u24 v4, 528, v4
    v_and_b32 v12, 31, v1
    v_lshlrev_b32 v12, 4, v12
    v_add_u32 v4, v4, v12
    s_lshl_b32 s35, s44, 5
    s_add_u32 s35, s35, s33
    s_lshl_b32 s35, s35, 2
    s_add_u32 s35, s35, s32
    s_lshl_b32 s35, s35, 14
    v_bfe_u32 v12, v1, 4, 2
    v_mul_u32_u24 v12, 1024, v12
    v_bfe_u32 v15, v1, 0, 4
    v_mul_u32_u24 v15, 16, v15
    v_add_u32 v12, v12, v15
    v_add_u32 v12, 0x100, v12
    v_bfe_u32 v13, v1, 4, 1
    v_mul_u32_u24 v13, 8192, v13
    v_bfe_u32 v15, v1, 0, 4
    v_mul_u32_u24 v15, 16, v15
    v_add_u32 v13, v13, v15
    v_add_u32 v13, 0x1f00, v13
    s_mov_b32 s28, s68
    s_mov_b32 s29, s69
    s_mov_b32 s30, 0x400000
    s_mov_b32 s31, 0x00020000
    s_add_u32 s36, s35, 0
    buffer_load_dwordx4 v[252:255], v12, s[28:31], s36 offen
    s_add_u32 s36, s35, 4096
    buffer_load_dwordx4 v[252:255], v12, s[28:31], s36 offen
    s_add_u32 s36, s35, 8192
    buffer_load_dwordx4 v[252:255], v12, s[28:31], s36 offen
    s_add_u32 s36, s35, 12288
    buffer_load_dwordx4 v[252:255], v12, s[28:31], s36 offen
    s_mov_b64 exec, 0xffffffff
    buffer_load_dwordx4 v[252:255], v13, s[28:31], s35 offen
    s_mov_b64 exec, -1
    s_mov_b32 s28, s70
    s_mov_b32 s29, s71
    s_mov_b32 s30, 0x400000
    s_mov_b32 s31, 0x00020000
    s_add_u32 s36, s35, 0
    buffer_load_dwordx4 v[252:255], v12, s[28:31], s36 offen
    s_add_u32 s36, s35, 4096
    buffer_load_dwordx4 v[252:255], v12, s[28:31], s36 offen
    s_add_u32 s36, s35, 8192
    buffer_load_dwordx4 v[252:255], v12, s[28:31], s36 offen
    s_add_u32 s36, s35, 12288
    buffer_load_dwordx4 v[252:255], v12, s[28:31], s36 offen
    s_mov_b64 exec, 0xffffffff
    buffer_load_dwordx4 v[252:255], v13, s[28:31], s35 offen
    s_mov_b64 exec, -1
    s_mul_i32 s37, s32, 6144
    s_add_u32 s37, s37, 81920
    v_lshrrev_b32 v6, 2, v1
    v_lshlrev_b32 v6, 6, v6
    v_lshrrev_b32 v12, 4, v1
    v_lshlrev_b32 v12, 7, v12
    v_add_u32 v6, v6, v12
    v_and_b32 v12, 3, v1
    v_lshlrev_b32 v12, 4, v12
    v_add_u32 v6, v6, v12
    v_add_u32 v6, s37, v6
    s_cmp_gt_u32 s46, 10
    s_cbranch_scc1 L_out_ph2_66
    s_mov_b32 s16, s80
    s_mov_b32 s17, s81
    s_mov_b32 s18, 0x158000
    s_mov_b32 s19, 0x00020000
    s_mov_b32 s20, s84
    s_mov_b32 s21, s85
    s_mov_b32 s22, 0x400
    s_mov_b32 s23, 0x00020000
    s_lshl_b32 s52, s46, 2
    s_add_u32 s52, s52, s32
    s_lshl_b32 s47, s45, 1
    s_add_u32 s47, s47, s44
    s_lshl_b32 s35, s47, 15
    s_lshl_b32 s36, s32, 13
    s_add_u32 s35, s35, s36
    buffer_load_dwordx4 v[16:19], v2, s[12:15], s35 offen offset:0
    buffer_load_dwordx4 v[20:23], v2, s[12:15], s35 offen offset:1024
    buffer_load_dwordx4 v[24:27], v2, s[12:15], s35 offen offset:2048
    buffer_load_dwordx4 v[28:31], v2, s[12:15], s35 offen offset:3072
    s_add_u32 s35, s35, 4096
    buffer_load_dwordx4 v[32:35], v2, s[12:15], s35 offen offset:0
    buffer_load_dwordx4 v[36:39], v2, s[12:15], s35 offen offset:1024
    buffer_load_dwordx4 v[40:43], v2, s[12:15], s35 offen offset:2048
    buffer_load_dwordx4 v[44:47], v2, s[12:15], s35 offen offset:3072
    s_waitcnt vmcnt(0)
    ds_write_b128 v3, v[16:19] offset:0
    ds_write_b128 v3, v[20:23] offset:16
    ds_write_b128 v3, v[24:27] offset:32
    ds_write_b128 v3, v[28:31] offset:48
    ds_write_b128 v3, v[32:35] offset:64
    ds_write_b128 v3, v[36:39] offset:80
    ds_write_b128 v3, v[40:43] offset:96
    ds_write_b128 v3, v[44:47] offset:112
    v_lshrrev_b32 v12, 4, v1
    v_bfe_u32 v13, v1, 2, 2
    v_and_b32 v7, 3, v1
    v_lshlrev_b32 v7, 3, v7
    v_bfe_u32 v15, v12, 1, 1
    v_mul_u32_u24 v15, 768, v15
    v_add_u32 v7, v7, v15
    v_bfe_u32 v15, v13, 0, 2
    v_mul_u32_u24 v15, 64, v15
    v_add_u32 v7, v7, v15
    v_bfe_u32 v15, v12, 0, 1
    v_mul_u32_u24 v15, 32, v15
    v_add_u32 v7, v7, v15
    v_add_u32 v7, s37, v7
    s_cmp_eq_u32 s52, 43
    s_cbranch_scc1 L_gatew_67
    v_lshrrev_b32 v5, 2, v1
    v_mul_u32_u24 v5, 2752, v5
    v_and_b32 v12, 3, v1
    v_lshlrev_b32 v12, 4, v12
    v_add_u32 v5, v5, v12
    s_lshl_b32 s35, s52, 6
    v_add_u32 v5, s35, v5
    s_mov_b32 s35, 0x0
    buffer_load_dwordx4 a[0:3], v5, s[16:19], s35 offen
    s_mov_b32 s35, 0xac00
    buffer_load_dwordx4 a[4:7], v5, s[16:19], s35 offen
    s_mov_b32 s35, 0x15800
    buffer_load_dwordx4 a[8:11], v5, s[16:19], s35 offen
    s_mov_b32 s35, 0x20400
    buffer_load_dwordx4 a[12:15], v5, s[16:19], s35 offen
    s_mov_b32 s35, 0x2b000
    buffer_load_dwordx4 a[16:19], v5, s[16:19], s35 offen
    s_mov_b32 s35, 0x35c00
    buffer_load_dwordx4 a[20:23], v5, s[16:19], s35 offen
    s_mov_b32 s35, 0x40800
    buffer_load_dwordx4 a[24:27], v5, s[16:19], s35 offen
    s_mov_b32 s35, 0x4b400
    buffer_load_dwordx4 a[28:31], v5, s[16:19], s35 offen
    s_mov_b32 s35, 0x56000
    buffer_load_dwordx4 a[32:35], v5, s[16:19], s35 offen
    s_mov_b32 s35, 0x60c00
    buffer_load_dwordx4 a[36:39], v5, s[16:19], s35 offen
    s_mov_b32 s35, 0x6b800
    buffer_load_dwordx4 a[40:43], v5, s[16:19], s35 offen
    s_mov_b32 s35, 0x76400
    buffer_load_dwordx4 a[44:47], v5, s[16:19], s35 offen
    s_mov_b32 s35, 0x81000
    buffer_load_dwordx4 a[48:51], v5, s[16:19], s35 offen
    s_mov_b32 s35, 0x8bc00
    buffer_load_dwordx4 a[52:55], v5, s[16:19], s35 offen
    s_mov_b32 s35, 0x96800
    buffer_load_dwordx4 a[56:59], v5, s[16:19], s35 offen
    s_mov_b32 s35, 0xa1400
    buffer_load_dwordx4 a[60:63], v5, s[16:19], s35 offen
    s_mov_b32 s35, 0xac000
    buffer_load_dwordx4 a[64:67], v5, s[16:19], s35 offen
    s_mov_b32 s35, 0xb6c00
    buffer_load_dwordx4 a[68:71], v5, s[16:19], s35 offen
    s_mov_b32 s35, 0xc1800
    buffer_load_dwordx4 a[72:75], v5, s[16:19], s35 offen
    s_mov_b32 s35, 0xcc400
    buffer_load_dwordx4 a[76:79], v5, s[16:19], s35 offen
    s_mov_b32 s35, 0xd7000
    buffer_load_dwordx4 a[80:83], v5, s[16:19], s35 offen
    s_mov_b32 s35, 0xe1c00
    buffer_load_dwordx4 a[84:87], v5, s[16:19], s35 offen
    s_mov_b32 s35, 0xec800
    buffer_load_dwordx4 a[88:91], v5, s[16:19], s35 offen
    s_mov_b32 s35, 0xf7400
    buffer_load_dwordx4 a[92:95], v5, s[16:19], s35 offen
    s_mov_b32 s35, 0x102000
    buffer_load_dwordx4 a[96:99], v5, s[16:19], s35 offen
    s_mov_b32 s35, 0x10cc00
    buffer_load_dwordx4 a[100:103], v5, s[16:19], s35 offen
    s_mov_b32 s35, 0x117800
    buffer_load_dwordx4 a[104:107], v5, s[16:19], s35 offen
    s_mov_b32 s35, 0x122400
    buffer_load_dwordx4 a[108:111], v5, s[16:19], s35 offen
    s_mov_b32 s35, 0x12d000
    buffer_load_dwordx4 a[112:115], v5, s[16:19], s35 offen
    s_mov_b32 s35, 0x137c00
    buffer_load_dwordx4 a[116:119], v5, s[16:19], s35 offen
    s_mov_b32 s35, 0x142800
    buffer_load_dwordx4 a[120:123], v5, s[16:19], s35 offen
    s_mov_b32 s35, 0x14d400
    buffer_load_dwordx4 a[124:127], v5, s[16:19], s35 offen
    s_waitcnt vmcnt(30)
    ds_write_b128 v6, a[0:3] offset:0
    ds_write_b128 v6, a[4:7] offset:1536
    ds_read_b64_tr_b16 a[0:1], v7 offset:0
    ds_read_b64_tr_b16 a[2:3], v7 offset:384
    ds_read_b64_tr_b16 a[4:5], v7 offset:1536
    ds_read_b64_tr_b16 a[6:7], v7 offset:1920
    s_waitcnt vmcnt(28)
    ds_write_b128 v6, a[8:11] offset:3072
    ds_write_b128 v6, a[12:15] offset:4608
    ds_read_b64_tr_b16 a[8:9], v7 offset:3072
    ds_read_b64_tr_b16 a[10:11], v7 offset:3456
    ds_read_b64_tr_b16 a[12:13], v7 offset:4608
    ds_read_b64_tr_b16 a[14:15], v7 offset:4992
    s_waitcnt vmcnt(26)
    ds_write_b128 v6, a[16:19] offset:0
    ds_write_b128 v6, a[20:23] offset:1536
    ds_read_b64_tr_b16 a[16:17], v7 offset:0
    ds_read_b64_tr_b16 a[18:19], v7 offset:384
    ds_read_b64_tr_b16 a[20:21], v7 offset:1536
    ds_read_b64_tr_b16 a[22:23], v7 offset:1920
    s_waitcnt vmcnt(24)
    ds_write_b128 v6, a[24:27] offset:3072
    ds_write_b128 v6, a[28:31] offset:4608
    ds_read_b64_tr_b16 a[24:25], v7 offset:3072
    ds_read_b64_tr_b16 a[26:27], v7 offset:3456
    ds_read_b64_tr_b16 a[28:29], v7 offset:4608
    ds_read_b64_tr_b16 a[30:31], v7 offset:4992
    s_waitcnt vmcnt(22)
    ds_write_b128 v6, a[32:35] offset:0
    ds_write_b128 v6, a[36:39] offset:1536
    ds_read_b64_tr_b16 a[32:33], v7 offset:0
    ds_read_b64_tr_b16 a[34:35], v7 offset:384
    ds_read_b64_tr_b16 a[36:37], v7 offset:1536
    ds_read_b64_tr_b16 a[38:39], v7 offset:1920
    s_waitcnt vmcnt(20)
    ds_write_b128 v6, a[40:43] offset:3072
    ds_write_b128 v6, a[44:47] offset:4608
    ds_read_b64_tr_b16 a[40:41], v7 offset:3072
    ds_read_b64_tr_b16 a[42:43], v7 offset:3456
    ds_read_b64_tr_b16 a[44:45], v7 offset:4608
    ds_read_b64_tr_b16 a[46:47], v7 offset:4992
    s_waitcnt vmcnt(18)
    ds_write_b128 v6, a[48:51] offset:0
    ds_write_b128 v6, a[52:55] offset:1536
    ds_read_b64_tr_b16 a[48:49], v7 offset:0
    ds_read_b64_tr_b16 a[50:51], v7 offset:384
    ds_read_b64_tr_b16 a[52:53], v7 offset:1536
    ds_read_b64_tr_b16 a[54:55], v7 offset:1920
    s_waitcnt vmcnt(16)
    ds_write_b128 v6, a[56:59] offset:3072
    ds_write_b128 v6, a[60:63] offset:4608
    ds_read_b64_tr_b16 a[56:57], v7 offset:3072
    ds_read_b64_tr_b16 a[58:59], v7 offset:3456
    ds_read_b64_tr_b16 a[60:61], v7 offset:4608
    ds_read_b64_tr_b16 a[62:63], v7 offset:4992
    s_waitcnt vmcnt(14)
    ds_write_b128 v6, a[64:67] offset:0
    ds_write_b128 v6, a[68:71] offset:1536
    ds_read_b64_tr_b16 a[64:65], v7 offset:0
    ds_read_b64_tr_b16 a[66:67], v7 offset:384
    ds_read_b64_tr_b16 a[68:69], v7 offset:1536
    ds_read_b64_tr_b16 a[70:71], v7 offset:1920
    s_waitcnt vmcnt(12)
    ds_write_b128 v6, a[72:75] offset:3072
    ds_write_b128 v6, a[76:79] offset:4608
    ds_read_b64_tr_b16 a[72:73], v7 offset:3072
    ds_read_b64_tr_b16 a[74:75], v7 offset:3456
    ds_read_b64_tr_b16 a[76:77], v7 offset:4608
    ds_read_b64_tr_b16 a[78:79], v7 offset:4992
    s_waitcnt vmcnt(10)
    ds_write_b128 v6, a[80:83] offset:0
    ds_write_b128 v6, a[84:87] offset:1536
    ds_read_b64_tr_b16 a[80:81], v7 offset:0
    ds_read_b64_tr_b16 a[82:83], v7 offset:384
    ds_read_b64_tr_b16 a[84:85], v7 offset:1536
    ds_read_b64_tr_b16 a[86:87], v7 offset:1920
    s_waitcnt vmcnt(8)
    ds_write_b128 v6, a[88:91] offset:3072
    ds_write_b128 v6, a[92:95] offset:4608
    ds_read_b64_tr_b16 a[88:89], v7 offset:3072
    ds_read_b64_tr_b16 a[90:91], v7 offset:3456
    ds_read_b64_tr_b16 a[92:93], v7 offset:4608
    ds_read_b64_tr_b16 a[94:95], v7 offset:4992
    s_waitcnt vmcnt(6)
    ds_write_b128 v6, a[96:99] offset:0
    ds_write_b128 v6, a[100:103] offset:1536
    ds_read_b64_tr_b16 a[96:97], v7 offset:0
    ds_read_b64_tr_b16 a[98:99], v7 offset:384
    ds_read_b64_tr_b16 a[100:101], v7 offset:1536
    ds_read_b64_tr_b16 a[102:103], v7 offset:1920
    s_waitcnt vmcnt(4)
    ds_write_b128 v6, a[104:107] offset:3072
    ds_write_b128 v6, a[108:111] offset:4608
    ds_read_b64_tr_b16 a[104:105], v7 offset:3072
    ds_read_b64_tr_b16 a[106:107], v7 offset:3456
    ds_read_b64_tr_b16 a[108:109], v7 offset:4608
    ds_read_b64_tr_b16 a[110:111], v7 offset:4992
    s_waitcnt vmcnt(2)
    ds_write_b128 v6, a[112:115] offset:0
    ds_write_b128 v6, a[116:119] offset:1536
    ds_read_b64_tr_b16 a[112:113], v7 offset:0
    ds_read_b64_tr_b16 a[114:115], v7 offset:384
    ds_read_b64_tr_b16 a[116:117], v7 offset:1536
    ds_read_b64_tr_b16 a[118:119], v7 offset:1920
    s_waitcnt vmcnt(0)
    ds_write_b128 v6, a[120:123] offset:3072
    ds_write_b128 v6, a[124:127] offset:4608
    ds_read_b64_tr_b16 a[120:121], v7 offset:3072
    ds_read_b64_tr_b16 a[122:123], v7 offset:3456
    ds_read_b64_tr_b16 a[124:125], v7 offset:4608
    ds_read_b64_tr_b16 a[126:127], v7 offset:4992
    s_waitcnt lgkmcnt(0)
    s_branch L_wdone_68
L_gatew_67:
    v_lshrrev_b32 v5, 5, v1
    v_lshlrev_b32 v5, 4, v5
    v_and_b32 v12, 31, v1
    v_lshlrev_b32 v12, 12, v12
    v_add_u32 v5, v5, v12
    buffer_load_dwordx4 a[0:3], v5, s[20:23], 0 offen offset:0
    buffer_load_dwordx4 a[4:7], v5, s[20:23], 0 offen offset:32
    buffer_load_dwordx4 a[8:11], v5, s[20:23], 0 offen offset:64
    buffer_load_dwordx4 a[12:15], v5, s[20:23], 0 offen offset:96
    buffer_load_dwordx4 a[16:19], v5, s[20:23], 0 offen offset:128
    buffer_load_dwordx4 a[20:23], v5, s[20:23], 0 offen offset:160
    buffer_load_dwordx4 a[24:27], v5, s[20:23], 0 offen offset:192
    buffer_load_dwordx4 a[28:31], v5, s[20:23], 0 offen offset:224
    buffer_load_dwordx4 a[32:35], v5, s[20:23], 0 offen offset:256
    buffer_load_dwordx4 a[36:39], v5, s[20:23], 0 offen offset:288
    buffer_load_dwordx4 a[40:43], v5, s[20:23], 0 offen offset:320
    buffer_load_dwordx4 a[44:47], v5, s[20:23], 0 offen offset:352
    buffer_load_dwordx4 a[48:51], v5, s[20:23], 0 offen offset:384
    buffer_load_dwordx4 a[52:55], v5, s[20:23], 0 offen offset:416
    buffer_load_dwordx4 a[56:59], v5, s[20:23], 0 offen offset:448
    buffer_load_dwordx4 a[60:63], v5, s[20:23], 0 offen offset:480
    buffer_load_dwordx4 a[64:67], v5, s[20:23], 0 offen offset:512
    buffer_load_dwordx4 a[68:71], v5, s[20:23], 0 offen offset:544
    buffer_load_dwordx4 a[72:75], v5, s[20:23], 0 offen offset:576
    buffer_load_dwordx4 a[76:79], v5, s[20:23], 0 offen offset:608
    buffer_load_dwordx4 a[80:83], v5, s[20:23], 0 offen offset:640
    buffer_load_dwordx4 a[84:87], v5, s[20:23], 0 offen offset:672
    buffer_load_dwordx4 a[88:91], v5, s[20:23], 0 offen offset:704
    buffer_load_dwordx4 a[92:95], v5, s[20:23], 0 offen offset:736
    buffer_load_dwordx4 a[96:99], v5, s[20:23], 0 offen offset:768
    buffer_load_dwordx4 a[100:103], v5, s[20:23], 0 offen offset:800
    buffer_load_dwordx4 a[104:107], v5, s[20:23], 0 offen offset:832
    buffer_load_dwordx4 a[108:111], v5, s[20:23], 0 offen offset:864
    buffer_load_dwordx4 a[112:115], v5, s[20:23], 0 offen offset:896
    buffer_load_dwordx4 a[116:119], v5, s[20:23], 0 offen offset:928
    buffer_load_dwordx4 a[120:123], v5, s[20:23], 0 offen offset:960
    buffer_load_dwordx4 a[124:127], v5, s[20:23], 0 offen offset:992
    s_waitcnt vmcnt(0)
L_wdone_68:
    s_waitcnt lgkmcnt(0)
    s_barrier
    s_mov_b32 s49, 36864
    v_add_u32 v3, s49, v3
    s_lshl_b32 s35, s52, 10
    v_bfe_u32 v8, v1, 4, 1
    v_mul_u32_u24 v8, 44032, v8
    v_bfe_u32 v15, v1, 5, 1
    v_mul_u32_u24 v15, 256, v15
    v_add_u32 v8, v8, v15
    v_bfe_u32 v15, v1, 0, 4
    v_mul_u32_u24 v15, 16, v15
    v_add_u32 v8, v8, v15
    v_add_u32 v8, s35, v8
L_ffn_loop_69:
    s_add_u32 s48, s47, 4
    s_lshl_b32 s35, s48, 15
    s_lshl_b32 s36, s32, 13
    s_add_u32 s35, s35, s36
    buffer_load_dwordx4 v[16:19], v2, s[12:15], s35 offen offset:0
    buffer_load_dwordx4 v[20:23], v2, s[12:15], s35 offen offset:1024
    buffer_load_dwordx4 v[24:27], v2, s[12:15], s35 offen offset:2048
    buffer_load_dwordx4 v[28:31], v2, s[12:15], s35 offen offset:3072
    s_add_u32 s35, s35, 4096
    buffer_load_dwordx4 v[32:35], v2, s[12:15], s35 offen offset:0
    buffer_load_dwordx4 v[36:39], v2, s[12:15], s35 offen offset:1024
    buffer_load_dwordx4 v[40:43], v2, s[12:15], s35 offen offset:2048
    buffer_load_dwordx4 v[44:47], v2, s[12:15], s35 offen offset:3072
    ds_read_b128 v[48:51], v4 offset:0
    ds_read_b128 v[52:55], v4 offset:1056
    ds_read_b128 v[56:59], v4 offset:2112
    ds_read_b128 v[60:63], v4 offset:3168
    s_waitcnt lgkmcnt(3)
    v_mfma_f32_32x32x16_bf16 v[64:79], a[0:3], v[48:51], 0
    ds_read_b128 v[48:51], v4 offset:4224
    s_waitcnt lgkmcnt(3)
    v_mfma_f32_32x32x16_bf16 v[64:79], a[4:7], v[52:55], v[64:79]
    ds_read_b128 v[52:55], v4 offset:5280
    s_waitcnt lgkmcnt(3)
    v_mfma_f32_32x32x16_bf16 v[64:79], a[8:11], v[56:59], v[64:79]
    ds_read_b128 v[56:59], v4 offset:6336
    s_waitcnt lgkmcnt(3)
    v_mfma_f32_32x32x16_bf16 v[64:79], a[12:15], v[60:63], v[64:79]
    ds_read_b128 v[60:63], v4 offset:7392
    s_waitcnt lgkmcnt(3)
    v_mfma_f32_32x32x16_bf16 v[64:79], a[16:19], v[48:51], v[64:79]
    ds_read_b128 v[48:51], v4 offset:8448
    s_waitcnt lgkmcnt(3)
    v_mfma_f32_32x32x16_bf16 v[64:79], a[20:23], v[52:55], v[64:79]
    ds_read_b128 v[52:55], v4 offset:9504
    s_waitcnt lgkmcnt(3)
    v_mfma_f32_32x32x16_bf16 v[64:79], a[24:27], v[56:59], v[64:79]
    ds_read_b128 v[56:59], v4 offset:10560
    s_waitcnt lgkmcnt(3)
    v_mfma_f32_32x32x16_bf16 v[64:79], a[28:31], v[60:63], v[64:79]
    ds_read_b128 v[60:63], v4 offset:11616
    s_waitcnt lgkmcnt(3)
    v_mfma_f32_32x32x16_bf16 v[64:79], a[32:35], v[48:51], v[64:79]
    ds_read_b128 v[48:51], v4 offset:12672
    s_waitcnt lgkmcnt(3)
    v_mfma_f32_32x32x16_bf16 v[64:79], a[36:39], v[52:55], v[64:79]
    ds_read_b128 v[52:55], v4 offset:13728
    s_waitcnt lgkmcnt(3)
    v_mfma_f32_32x32x16_bf16 v[64:79], a[40:43], v[56:59], v[64:79]
    ds_read_b128 v[56:59], v4 offset:14784
    s_waitcnt lgkmcnt(3)
    v_mfma_f32_32x32x16_bf16 v[64:79], a[44:47], v[60:63], v[64:79]
    ds_read_b128 v[60:63], v4 offset:15840
    s_waitcnt lgkmcnt(3)
    v_mfma_f32_32x32x16_bf16 v[64:79], a[48:51], v[48:51], v[64:79]
    ds_read_b128 v[48:51], v4 offset:16896
    s_waitcnt lgkmcnt(3)
    v_mfma_f32_32x32x16_bf16 v[64:79], a[52:55], v[52:55], v[64:79]
    ds_read_b128 v[52:55], v4 offset:17952
    s_waitcnt lgkmcnt(3)
    v_mfma_f32_32x32x16_bf16 v[64:79], a[56:59], v[56:59], v[64:79]
    ds_read_b128 v[56:59], v4 offset:19008
    s_waitcnt lgkmcnt(3)
    v_mfma_f32_32x32x16_bf16 v[64:79], a[60:63], v[60:63], v[64:79]
    ds_read_b128 v[60:63], v4 offset:20064
    s_waitcnt lgkmcnt(3)
    v_mfma_f32_32x32x16_bf16 v[64:79], a[64:67], v[48:51], v[64:79]
    ds_read_b128 v[48:51], v4 offset:21120
    s_waitcnt lgkmcnt(3)
    v_mfma_f32_32x32x16_bf16 v[64:79], a[68:71], v[52:55], v[64:79]
    ds_read_b128 v[52:55], v4 offset:22176
    s_waitcnt lgkmcnt(3)
    v_mfma_f32_32x32x16_bf16 v[64:79], a[72:75], v[56:59], v[64:79]
    ds_read_b128 v[56:59], v4 offset:23232
    s_waitcnt lgkmcnt(3)
    v_mfma_f32_32x32x16_bf16 v[64:79], a[76:79], v[60:63], v[64:79]
    ds_read_b128 v[60:63], v4 offset:24288
    s_waitcnt lgkmcnt(3)
    v_mfma_f32_32x32x16_bf16 v[64:79], a[80:83], v[48:51], v[64:79]
    ds_read_b128 v[48:51], v4 offset:25344
    s_waitcnt lgkmcnt(3)
    v_mfma_f32_32x32x16_bf16 v[64:79], a[84:87], v[52:55], v[64:79]
    ds_read_b128 v[52:55], v4 offset:26400
    s_waitcnt lgkmcnt(3)
    v_mfma_f32_32x32x16_bf16 v[64:79], a[88:91], v[56:59], v[64:79]
    ds_read_b128 v[56:59], v4 offset:27456
    s_waitcnt lgkmcnt(3)
    v_mfma_f32_32x32x16_bf16 v[64:79], a[92:95], v[60:63], v[64:79]
    ds_read_b128 v[60:63], v4 offset:28512
    s_waitcnt lgkmcnt(3)
    v_mfma_f32_32x32x16_bf16 v[64:79], a[96:99], v[48:51], v[64:79]
    ds_read_b128 v[48:51], v4 offset:29568
    s_waitcnt lgkmcnt(3)
    v_mfma_f32_32x32x16_bf16 v[64:79], a[100:103], v[52:55], v[64:79]
    ds_read_b128 v[52:55], v4 offset:30624
    s_waitcnt lgkmcnt(3)
    v_mfma_f32_32x32x16_bf16 v[64:79], a[104:107], v[56:59], v[64:79]
    ds_read_b128 v[56:59], v4 offset:31680
    s_waitcnt lgkmcnt(3)
    v_mfma_f32_32x32x16_bf16 v[64:79], a[108:111], v[60:63], v[64:79]
    ds_read_b128 v[60:63], v4 offset:32736
    s_waitcnt lgkmcnt(3)
    v_mfma_f32_32x32x16_bf16 v[64:79], a[112:115], v[48:51], v[64:79]
    s_waitcnt lgkmcnt(2)
    v_mfma_f32_32x32x16_bf16 v[64:79], a[116:119], v[52:55], v[64:79]
    s_waitcnt lgkmcnt(1)
    v_mfma_f32_32x32x16_bf16 v[64:79], a[120:123], v[56:59], v[64:79]
    s_waitcnt lgkmcnt(0)
    v_mfma_f32_32x32x16_bf16 v[64:79], a[124:127], v[60:63], v[64:79]
    s_waitcnt vmcnt(0)
    ds_write_b128 v3, v[16:19] offset:0
    ds_write_b128 v3, v[20:23] offset:16
    ds_write_b128 v3, v[24:27] offset:32
    ds_write_b128 v3, v[28:31] offset:48
    ds_write_b128 v3, v[32:35] offset:64
    ds_write_b128 v3, v[36:39] offset:80
    ds_write_b128 v3, v[40:43] offset:96
    ds_write_b128 v3, v[44:47] offset:112
    s_waitcnt lgkmcnt(0)
    s_nop 11
    s_cmp_eq_u32 s52, 43
    s_cbranch_scc1 L_gate_ep_70
    s_mov_b32 s35, 0xbfb8aa3b
    v_mul_f32 v80, s35, v64
    v_mul_f32 v81, s35, v65
    v_mul_f32 v82, s35, v66
    v_mul_f32 v83, s35, v67
    v_mul_f32 v84, s35, v68
    v_mul_f32 v85, s35, v69
    v_mul_f32 v86, s35, v70
    v_mul_f32 v87, s35, v71
    v_mul_f32 v88, s35, v72
    v_mul_f32 v89, s35, v73
    v_mul_f32 v90, s35, v74
    v_mul_f32 v91, s35, v75
    v_mul_f32 v92, s35, v76
    v_mul_f32 v93, s35, v77
    v_mul_f32 v94, s35, v78
    v_mul_f32 v95, s35, v79
    v_exp_f32 v80, v80
    v_exp_f32 v81, v81
    v_exp_f32 v82, v82
    v_exp_f32 v83, v83
    v_exp_f32 v84, v84
    v_exp_f32 v85, v85
    v_exp_f32 v86, v86
    v_exp_f32 v87, v87
    v_exp_f32 v88, v88
    v_exp_f32 v89, v89
    v_exp_f32 v90, v90
    v_exp_f32 v91, v91
    v_exp_f32 v92, v92
    v_exp_f32 v93, v93
    v_exp_f32 v94, v94
    v_exp_f32 v95, v95
    v_add_f32 v80, 1.0, v80
    v_add_f32 v81, 1.0, v81
    v_add_f32 v82, 1.0, v82
    v_add_f32 v83, 1.0, v83
    v_add_f32 v84, 1.0, v84
    v_add_f32 v85, 1.0, v85
    v_add_f32 v86, 1.0, v86
    v_add_f32 v87, 1.0, v87
    v_add_f32 v88, 1.0, v88
    v_add_f32 v89, 1.0, v89
    v_add_f32 v90, 1.0, v90
    v_add_f32 v91, 1.0, v91
    v_add_f32 v92, 1.0, v92
    v_add_f32 v93, 1.0, v93
    v_add_f32 v94, 1.0, v94
    v_add_f32 v95, 1.0, v95
    v_rcp_f32 v80, v80
    v_rcp_f32 v81, v81
    v_rcp_f32 v82, v82
    v_rcp_f32 v83, v83
    v_rcp_f32 v84, v84
    v_rcp_f32 v85, v85
    v_rcp_f32 v86, v86
    v_rcp_f32 v87, v87
    v_rcp_f32 v88, v88
    v_rcp_f32 v89, v89
    v_rcp_f32 v90, v90
    v_rcp_f32 v91, v91
    v_rcp_f32 v92, v92
    v_rcp_f32 v93, v93
    v_rcp_f32 v94, v94
    v_rcp_f32 v95, v95
    v_mul_f32 v64, v64, v80
    v_mul_f32 v65, v65, v81
    v_mul_f32 v66, v66, v82
    v_mul_f32 v67, v67, v83
    v_mul_f32 v68, v68, v84
    v_mul_f32 v69, v69, v85
    v_mul_f32 v70, v70, v86
    v_mul_f32 v71, v71, v87
    v_mul_f32 v72, v72, v88
    v_mul_f32 v73, v73, v89
    v_mul_f32 v74, v74, v90
    v_mul_f32 v75, v75, v91
    v_mul_f32 v76, v76, v92
    v_mul_f32 v77, v77, v93
    v_mul_f32 v78, v78, v94
    v_mul_f32 v79, v79, v95
    v_cvt_pk_bf16_f32 v112, v64, v65
    v_cvt_pk_bf16_f32 v113, v66, v67
    v_cvt_pk_bf16_f32 v114, v68, v69
    v_cvt_pk_bf16_f32 v115, v70, v71
    v_cvt_pk_bf16_f32 v116, v72, v73
    v_cvt_pk_bf16_f32 v117, v74, v75
    v_cvt_pk_bf16_f32 v118, v76, v77
    v_cvt_pk_bf16_f32 v119, v78, v79
    s_mul_i32 s35, s47, 88064
    s_add_u32 s35, s35, 0x5000000
    buffer_store_dwordx4 v[112:115], v8, s[4:7], s35 offen offset:0 sc1
    buffer_store_dwordx4 v[116:119], v8, s[4:7], s35 offen offset:512 sc1
    s_branch L_ep_done_71
L_gate_ep_70:
    s_mov_b32 s35, 0xbfb8aa3b
    v_mul_f32 v12, s35, v64
    v_exp_f32 v12, v12
    s_nop 0
    v_add_f32 v12, 1.0, v12
    v_rcp_f32 v12, v12
    v_lshlrev_b32 v13, 2, v1
    s_lshl_b32 s35, s47, 7
    s_add_u32 s35, s35, 0x5800000
    s_mov_b64 exec, 0xffffffff
    buffer_store_dword v12, v13, s[4:7], s35 offen sc1
    s_mov_b64 exec, -1
L_ep_done_71:
    v_add_u32 v4, s49, v4
    s_sub_u32 s49, 0, s49
    v_add_u32 v3, s49, v3
    s_waitcnt lgkmcnt(0)
    s_barrier
    s_mov_b32 s47, s48
    s_cmp_lt_u32 s47, 64
    s_cbranch_scc1 L_ffn_loop_69
    s_waitcnt vmcnt(0)
    s_barrier
    s_cmp_lg_u32 s32, 0
    s_cbranch_scc1 L_ffn_nf_72
    s_lshl_b32 s50, s44, 2
    s_add_u32 s50, s50, 8
    s_mov_b32 s51, 0
    s_lshl_b32 s35, 1, s51
    v_mov_b32 v11, s35
    s_mov_b64 s[42:43], exec
    s_mov_b64 exec, 1
    buffer_atomic_add v11, v10, s[8:11], s50 offen sc1
    s_mov_b64 exec, s[42:43]
L_ffn_nf_72:
L_out_ph2_66:
    s_mov_b32 s16, s74
    s_mov_b32 s17, s75
    s_mov_b32 s18, 0x400000
    s_mov_b32 s19, 0x00020000
    s_mov_b32 s20, s82
    s_mov_b32 s21, s83
    s_mov_b32 s22, 0x158000
    s_mov_b32 s23, 0x00020000
    s_mov_b32 s24, s86
    s_mov_b32 s25, s87
    s_mov_b32 s26, 0x200000
    s_mov_b32 s27, 0x00020000
    v_lshrrev_b32 v5, 2, v1
    v_mul_u32_u24 v5, 1024, v5
    v_and_b32 v12, 3, v1
    v_lshlrev_b32 v12, 4, v12
    v_add_u32 v5, v5, v12
    s_lshl_b32 s35, s46, 6
    v_add_u32 v5, s35, v5
    s_mul_i32 s35, s32, 360448
    v_add_u32 v8, s35, v5
    s_lshl_b32 s35, s32, 20
    v_add_u32 v5, s35, v5
    s_mul_i32 s37, s32, 6144
    s_add_u32 s37, s37, 81920
    v_lshrrev_b32 v12, 4, v1
    v_bfe_u32 v13, v1, 2, 2
    v_and_b32 v7, 3, v1
    v_lshlrev_b32 v7, 3, v7
    v_bfe_u32 v15, v12, 0, 2
    v_mul_u32_u24 v15, 384, v15
    v_add_u32 v7, v7, v15
    v_bfe_u32 v15, v13, 0, 2
    v_mul_u32_u24 v15, 64, v15
    v_add_u32 v7, v7, v15
    v_add_u32 v7, s37, v7
    v_lshrrev_b32 v12, 4, v1
    v_bfe_u32 v13, v1, 2, 2
    v_and_b32 v9, 3, v1
    v_lshlrev_b32 v9, 3, v9
    v_bfe_u32 v15, v12, 1, 1
    v_mul_u32_u24 v15, 1536, v15
    v_add_u32 v9, v9, v15
    v_bfe_u32 v15, v12, 0, 1
    v_mul_u32_u24 v15, 384, v15
    v_add_u32 v9, v9, v15
    v_bfe_u32 v15, v13, 0, 2
    v_mul_u32_u24 v15, 64, v15
    v_add_u32 v9, v9, v15
    v_add_u32 v9, s37, v9
    s_mov_b32 s35, 0x0
    buffer_load_dwordx4 v[128:131], v8, s[20:23], s35 offen
    s_mov_b32 s35, 0x4000
    buffer_load_dwordx4 v[132:135], v8, s[20:23], s35 offen
    s_mov_b32 s35, 0x8000
    buffer_load_dwordx4 v[136:139], v8, s[20:23], s35 offen
    s_mov_b32 s35, 0xc000
    buffer_load_dwordx4 v[140:143], v8, s[20:23], s35 offen
    s_mov_b32 s35, 0x10000
    buffer_load_dwordx4 v[144:147], v8, s[20:23], s35 offen
    s_mov_b32 s35, 0x14000
    buffer_load_dwordx4 v[148:151], v8, s[20:23], s35 offen
    s_mov_b32 s35, 0x18000
    buffer_load_dwordx4 v[152:155], v8, s[20:23], s35 offen
    s_mov_b32 s35, 0x1c000
    buffer_load_dwordx4 v[156:159], v8, s[20:23], s35 offen
    s_mov_b32 s35, 0x20000
    buffer_load_dwordx4 v[160:163], v8, s[20:23], s35 offen
    s_mov_b32 s35, 0x24000
    buffer_load_dwordx4 v[164:167], v8, s[20:23], s35 offen
    s_mov_b32 s35, 0x28000
    buffer_load_dwordx4 v[168:171], v8, s[20:23], s35 offen
    s_mov_b32 s35, 0x2c000
    buffer_load_dwordx4 v[172:175], v8, s[20:23], s35 offen
    s_mov_b32 s35, 0x30000
    buffer_load_dwordx4 v[176:179], v8, s[20:23], s35 offen
    s_mov_b32 s35, 0x34000
    buffer_load_dwordx4 v[180:183], v8, s[20:23], s35 offen
    s_mov_b32 s35, 0x38000
    buffer_load_dwordx4 v[184:187], v8, s[20:23], s35 offen
    s_mov_b32 s35, 0x3c000
    buffer_load_dwordx4 v[188:191], v8, s[20:23], s35 offen
    s_mov_b32 s35, 0x40000
    buffer_load_dwordx4 v[192:195], v8, s[20:23], s35 offen
    s_mov_b32 s35, 0x44000
    buffer_load_dwordx4 v[196:199], v8, s[20:23], s35 offen
    s_mov_b32 s35, 0x48000
    buffer_load_dwordx4 v[200:203], v8, s[20:23], s35 offen
    s_mov_b32 s35, 0x4c000
    buffer_load_dwordx4 v[204:207], v8, s[20:23], s35 offen
    s_mov_b32 s35, 0x50000
    buffer_load_dwordx4 v[208:211], v8, s[20:23], s35 offen
    s_mov_b32 s35, 0x54000
    buffer_load_dwordx4 v[212:215], v8, s[20:23], s35 offen
    s_mov_b32 s35, 0x0
    buffer_load_dwordx4 a[0:3], v5, s[16:19], s35 offen
    s_mov_b32 s35, 0x4000
    buffer_load_dwordx4 a[4:7], v5, s[16:19], s35 offen
    s_mov_b32 s35, 0x8000
    buffer_load_dwordx4 a[8:11], v5, s[16:19], s35 offen
    s_mov_b32 s35, 0xc000
    buffer_load_dwordx4 a[12:15], v5, s[16:19], s35 offen
    s_mov_b32 s35, 0x10000
    buffer_load_dwordx4 a[16:19], v5, s[16:19], s35 offen
    s_mov_b32 s35, 0x14000
    buffer_load_dwordx4 a[20:23], v5, s[16:19], s35 offen
    s_mov_b32 s35, 0x18000
    buffer_load_dwordx4 a[24:27], v5, s[16:19], s35 offen
    s_mov_b32 s35, 0x1c000
    buffer_load_dwordx4 a[28:31], v5, s[16:19], s35 offen
    s_mov_b32 s35, 0x20000
    buffer_load_dwordx4 a[32:35], v5, s[16:19], s35 offen
    s_mov_b32 s35, 0x24000
    buffer_load_dwordx4 a[36:39], v5, s[16:19], s35 offen
    s_mov_b32 s35, 0x28000
    buffer_load_dwordx4 a[40:43], v5, s[16:19], s35 offen
    s_mov_b32 s35, 0x2c000
    buffer_load_dwordx4 a[44:47], v5, s[16:19], s35 offen
    s_mov_b32 s35, 0x30000
    buffer_load_dwordx4 a[48:51], v5, s[16:19], s35 offen
    s_mov_b32 s35, 0x34000
    buffer_load_dwordx4 a[52:55], v5, s[16:19], s35 offen
    s_mov_b32 s35, 0x38000
    buffer_load_dwordx4 a[56:59], v5, s[16:19], s35 offen
    s_mov_b32 s35, 0x3c000
    buffer_load_dwordx4 a[60:63], v5, s[16:19], s35 offen
    s_mov_b32 s35, 0x40000
    buffer_load_dwordx4 a[64:67], v5, s[16:19], s35 offen
    s_mov_b32 s35, 0x44000
    buffer_load_dwordx4 a[68:71], v5, s[16:19], s35 offen
    s_mov_b32 s35, 0x48000
    buffer_load_dwordx4 a[72:75], v5, s[16:19], s35 offen
    s_mov_b32 s35, 0x4c000
    buffer_load_dwordx4 a[76:79], v5, s[16:19], s35 offen
    s_mov_b32 s35, 0x50000
    buffer_load_dwordx4 a[80:83], v5, s[16:19], s35 offen
    s_mov_b32 s35, 0x54000
    buffer_load_dwordx4 a[84:87], v5, s[16:19], s35 offen
    s_mov_b32 s35, 0x58000
    buffer_load_dwordx4 a[88:91], v5, s[16:19], s35 offen
    s_mov_b32 s35, 0x5c000
    buffer_load_dwordx4 a[92:95], v5, s[16:19], s35 offen
    s_mov_b32 s35, 0x60000
    buffer_load_dwordx4 a[96:99], v5, s[16:19], s35 offen
    s_mov_b32 s35, 0x64000
    buffer_load_dwordx4 a[100:103], v5, s[16:19], s35 offen
    s_mov_b32 s35, 0x68000
    buffer_load_dwordx4 a[104:107], v5, s[16:19], s35 offen
    s_mov_b32 s35, 0x6c000
    buffer_load_dwordx4 a[108:111], v5, s[16:19], s35 offen
    s_mov_b32 s35, 0x70000
    buffer_load_dwordx4 a[112:115], v5, s[16:19], s35 offen
    s_mov_b32 s35, 0x74000
    buffer_load_dwordx4 a[116:119], v5, s[16:19], s35 offen
    s_mov_b32 s35, 0x78000
    buffer_load_dwordx4 a[120:123], v5, s[16:19], s35 offen
    s_mov_b32 s35, 0x7c000
    buffer_load_dwordx4 a[124:127], v5, s[16:19], s35 offen
    s_mov_b32 s35, 0x80000
    buffer_load_dwordx4 a[128:131], v5, s[16:19], s35 offen
    s_mov_b32 s35, 0x84000
    buffer_load_dwordx4 a[132:135], v5, s[16:19], s35 offen
    s_mov_b32 s35, 0x88000
    buffer_load_dwordx4 a[136:139], v5, s[16:19], s35 offen
    s_mov_b32 s35, 0x8c000
    buffer_load_dwordx4 a[140:143], v5, s[16:19], s35 offen
    s_mov_b32 s35, 0x90000
    buffer_load_dwordx4 a[144:147], v5, s[16:19], s35 offen
    s_mov_b32 s35, 0x94000
    buffer_load_dwordx4 a[148:151], v5, s[16:19], s35 offen
    s_mov_b32 s35, 0x98000
    buffer_load_dwordx4 a[152:155], v5, s[16:19], s35 offen
    s_mov_b32 s35, 0x9c000
    buffer_load_dwordx4 a[156:159], v5, s[16:19], s35 offen
    s_waitcnt vmcnt(60)
    ds_write_b128 v6, v[128:131] offset:0
    ds_write_b128 v6, v[132:135] offset:1536
    ds_read_b64_tr_b16 v[128:129], v9 offset:0
    ds_read_b64_tr_b16 v[130:131], v9 offset:768
    ds_read_b64_tr_b16 v[132:133], v9 offset:32
    ds_read_b64_tr_b16 v[134:135], v9 offset:800
    s_mov_b32 s35, 0xa0000
    buffer_load_dwordx4 a[160:163], v5, s[16:19], s35 offen
    s_mov_b32 s35, 0xa4000
    buffer_load_dwordx4 a[164:167], v5, s[16:19], s35 offen
    s_waitcnt vmcnt(60)
    ds_write_b128 v6, v[136:139] offset:3072
    ds_write_b128 v6, v[140:143] offset:4608
    ds_read_b64_tr_b16 v[136:137], v9 offset:3072
    ds_read_b64_tr_b16 v[138:139], v9 offset:3840
    ds_read_b64_tr_b16 v[140:141], v9 offset:3104
    ds_read_b64_tr_b16 v[142:143], v9 offset:3872
    s_mov_b32 s35, 0xa8000
    buffer_load_dwordx4 a[168:171], v5, s[16:19], s35 offen
    s_mov_b32 s35, 0xac000
    buffer_load_dwordx4 a[172:175], v5, s[16:19], s35 offen
    s_waitcnt vmcnt(60)
    ds_write_b128 v6, v[144:147] offset:0
    ds_write_b128 v6, v[148:151] offset:1536
    ds_read_b64_tr_b16 v[144:145], v9 offset:0
    ds_read_b64_tr_b16 v[146:147], v9 offset:768
    ds_read_b64_tr_b16 v[148:149], v9 offset:32
    ds_read_b64_tr_b16 v[150:151], v9 offset:800
    s_mov_b32 s35, 0xb0000
    buffer_load_dwordx4 a[176:179], v5, s[16:19], s35 offen
    s_mov_b32 s35, 0xb4000
    buffer_load_dwordx4 a[180:183], v5, s[16:19], s35 offen
    s_waitcnt vmcnt(60)
    ds_write_b128 v6, v[152:155] offset:3072
    ds_write_b128 v6, v[156:159] offset:4608
    ds_read_b64_tr_b16 v[152:153], v9 offset:3072
    ds_read_b64_tr_b16 v[154:155], v9 offset:3840
    ds_read_b64_tr_b16 v[156:157], v9 offset:3104
    ds_read_b64_tr_b16 v[158:159], v9 offset:3872
    s_mov_b32 s35, 0xb8000
    buffer_load_dwordx4 a[184:187], v5, s[16:19], s35 offen
    s_mov_b32 s35, 0xbc000
    buffer_load_dwordx4 a[188:191], v5, s[16:19], s35 offen
    s_waitcnt vmcnt(60)
    ds_write_b128 v6, v[160:163] offset:0
    ds_write_b128 v6, v[164:167] offset:1536
    ds_read_b64_tr_b16 v[160:161], v9 offset:0
    ds_read_b64_tr_b16 v[162:163], v9 offset:768
    ds_read_b64_tr_b16 v[164:165], v9 offset:32
    ds_read_b64_tr_b16 v[166:167], v9 offset:800
    s_mov_b32 s35, 0xc0000
    buffer_load_dwordx4 a[192:195], v5, s[16:19], s35 offen
    s_mov_b32 s35, 0xc4000
    buffer_load_dwordx4 a[196:199], v5, s[16:19], s35 offen
    s_waitcnt vmcnt(60)
    ds_write_b128 v6, v[168:171] offset:3072
    ds_write_b128 v6, v[172:175] offset:4608
    ds_read_b64_tr_b16 v[168:169], v9 offset:3072
    ds_read_b64_tr_b16 v[170:171], v9 offset:3840
    ds_read_b64_tr_b16 v[172:173], v9 offset:3104
    ds_read_b64_tr_b16 v[174:175], v9 offset:3872
    s_mov_b32 s35, 0xc8000
    buffer_load_dwordx4 a[200:203], v5, s[16:19], s35 offen
    s_mov_b32 s35, 0xcc000
    buffer_load_dwordx4 a[204:207], v5, s[16:19], s35 offen
    s_waitcnt vmcnt(60)
    ds_write_b128 v6, v[176:179] offset:0
    ds_write_b128 v6, v[180:183] offset:1536
    ds_read_b64_tr_b16 v[176:177], v9 offset:0
    ds_read_b64_tr_b16 v[178:179], v9 offset:768
    ds_read_b64_tr_b16 v[180:181], v9 offset:32
    ds_read_b64_tr_b16 v[182:183], v9 offset:800
    s_mov_b32 s35, 0xd0000
    buffer_load_dwordx4 a[208:211], v5, s[16:19], s35 offen
    s_mov_b32 s35, 0xd4000
    buffer_load_dwordx4 a[212:215], v5, s[16:19], s35 offen
    s_waitcnt vmcnt(60)
    ds_write_b128 v6, v[184:187] offset:3072
    ds_write_b128 v6, v[188:191] offset:4608
    ds_read_b64_tr_b16 v[184:185], v9 offset:3072
    ds_read_b64_tr_b16 v[186:187], v9 offset:3840
    ds_read_b64_tr_b16 v[188:189], v9 offset:3104
    ds_read_b64_tr_b16 v[190:191], v9 offset:3872
    s_mov_b32 s35, 0xd8000
    buffer_load_dwordx4 a[216:219], v5, s[16:19], s35 offen
    s_mov_b32 s35, 0xdc000
    buffer_load_dwordx4 a[220:223], v5, s[16:19], s35 offen
    s_waitcnt vmcnt(60)
    ds_write_b128 v6, v[192:195] offset:0
    ds_write_b128 v6, v[196:199] offset:1536
    ds_read_b64_tr_b16 v[192:193], v9 offset:0
    ds_read_b64_tr_b16 v[194:195], v9 offset:768
    ds_read_b64_tr_b16 v[196:197], v9 offset:32
    ds_read_b64_tr_b16 v[198:199], v9 offset:800
    s_mov_b32 s35, 0xe0000
    buffer_load_dwordx4 a[224:227], v5, s[16:19], s35 offen
    s_mov_b32 s35, 0xe4000
    buffer_load_dwordx4 a[228:231], v5, s[16:19], s35 offen
    s_waitcnt vmcnt(60)
    ds_write_b128 v6, v[200:203] offset:3072
    ds_write_b128 v6, v[204:207] offset:4608
    ds_read_b64_tr_b16 v[200:201], v9 offset:3072
    ds_read_b64_tr_b16 v[202:203], v9 offset:3840
    ds_read_b64_tr_b16 v[204:205], v9 offset:3104
    ds_read_b64_tr_b16 v[206:207], v9 offset:3872
    s_mov_b32 s35, 0xe8000
    buffer_load_dwordx4 a[232:235], v5, s[16:19], s35 offen
    s_mov_b32 s35, 0xec000
    buffer_load_dwordx4 a[236:239], v5, s[16:19], s35 offen
    s_waitcnt vmcnt(60)
    ds_write_b128 v6, v[208:211] offset:0
    ds_write_b128 v6, v[212:215] offset:1536
    ds_read_b64_tr_b16 v[208:209], v9 offset:0
    ds_read_b64_tr_b16 v[210:211], v9 offset:768
    ds_read_b64_tr_b16 v[212:213], v9 offset:32
    ds_read_b64_tr_b16 v[214:215], v9 offset:800
    s_mov_b32 s35, 0xf0000
    buffer_load_dwordx4 a[240:243], v5, s[16:19], s35 offen
    s_mov_b32 s35, 0xf4000
    buffer_load_dwordx4 a[244:247], v5, s[16:19], s35 offen
    s_waitcnt vmcnt(60)
    ds_write_b128 v6, a[0:3] offset:3072
    ds_write_b128 v6, a[4:7] offset:4608
    ds_read_b64_tr_b16 a[0:1], v7 offset:3072
    ds_read_b64_tr_b16 a[2:3], v7 offset:4608
    ds_read_b64_tr_b16 a[4:5], v7 offset:3104
    ds_read_b64_tr_b16 a[6:7], v7 offset:4640
    s_mov_b32 s35, 0xf8000
    buffer_load_dwordx4 a[248:251], v5, s[16:19], s35 offen
    s_mov_b32 s35, 0xfc000
    buffer_load_dwordx4 a[252:255], v5, s[16:19], s35 offen
    s_waitcnt vmcnt(60)
    ds_write_b128 v6, a[8:11] offset:0
    ds_write_b128 v6, a[12:15] offset:1536
    ds_read_b64_tr_b16 a[8:9], v7 offset:0
    ds_read_b64_tr_b16 a[10:11], v7 offset:1536
    ds_read_b64_tr_b16 a[12:13], v7 offset:32
    ds_read_b64_tr_b16 a[14:15], v7 offset:1568
    s_waitcnt vmcnt(58)
    ds_write_b128 v6, a[16:19] offset:3072
    ds_write_b128 v6, a[20:23] offset:4608
    ds_read_b64_tr_b16 a[16:17], v7 offset:3072
    ds_read_b64_tr_b16 a[18:19], v7 offset:4608
    ds_read_b64_tr_b16 a[20:21], v7 offset:3104
    ds_read_b64_tr_b16 a[22:23], v7 offset:4640
    s_waitcnt vmcnt(56)
    ds_write_b128 v6, a[24:27] offset:0
    ds_write_b128 v6, a[28:31] offset:1536
    ds_read_b64_tr_b16 a[24:25], v7 offset:0
    ds_read_b64_tr_b16 a[26:27], v7 offset:1536
    ds_read_b64_tr_b16 a[28:29], v7 offset:32
    ds_read_b64_tr_b16 a[30:31], v7 offset:1568
    s_waitcnt vmcnt(54)
    ds_write_b128 v6, a[32:35] offset:3072
    ds_write_b128 v6, a[36:39] offset:4608
    ds_read_b64_tr_b16 a[32:33], v7 offset:3072
    ds_read_b64_tr_b16 a[34:35], v7 offset:4608
    ds_read_b64_tr_b16 a[36:37], v7 offset:3104
    ds_read_b64_tr_b16 a[38:39], v7 offset:4640
    s_waitcnt vmcnt(52)
    ds_write_b128 v6, a[40:43] offset:0
    ds_write_b128 v6, a[44:47] offset:1536
    ds_read_b64_tr_b16 a[40:41], v7 offset:0
    ds_read_b64_tr_b16 a[42:43], v7 offset:1536
    ds_read_b64_tr_b16 a[44:45], v7 offset:32
    ds_read_b64_tr_b16 a[46:47], v7 offset:1568
    s_waitcnt vmcnt(50)
    ds_write_b128 v6, a[48:51] offset:3072
    ds_write_b128 v6, a[52:55] offset:4608
    ds_read_b64_tr_b16 a[48:49], v7 offset:3072
    ds_read_b64_tr_b16 a[50:51], v7 offset:4608
    ds_read_b64_tr_b16 a[52:53], v7 offset:3104
    ds_read_b64_tr_b16 a[54:55], v7 offset:4640
    s_waitcnt vmcnt(48)
    ds_write_b128 v6, a[56:59] offset:0
    ds_write_b128 v6, a[60:63] offset:1536
    ds_read_b64_tr_b16 a[56:57], v7 offset:0
    ds_read_b64_tr_b16 a[58:59], v7 offset:1536
    ds_read_b64_tr_b16 a[60:61], v7 offset:32
    ds_read_b64_tr_b16 a[62:63], v7 offset:1568
    s_waitcnt vmcnt(46)
    ds_write_b128 v6, a[64:67] offset:3072
    ds_write_b128 v6, a[68:71] offset:4608
    ds_read_b64_tr_b16 a[64:65], v7 offset:3072
    ds_read_b64_tr_b16 a[66:67], v7 offset:4608
    ds_read_b64_tr_b16 a[68:69], v7 offset:3104
    ds_read_b64_tr_b16 a[70:71], v7 offset:4640
    s_waitcnt vmcnt(44)
    ds_write_b128 v6, a[72:75] offset:0
    ds_write_b128 v6, a[76:79] offset:1536
    ds_read_b64_tr_b16 a[72:73], v7 offset:0
    ds_read_b64_tr_b16 a[74:75], v7 offset:1536
    ds_read_b64_tr_b16 a[76:77], v7 offset:32
    ds_read_b64_tr_b16 a[78:79], v7 offset:1568
    s_waitcnt vmcnt(42)
    ds_write_b128 v6, a[80:83] offset:3072
    ds_write_b128 v6, a[84:87] offset:4608
    ds_read_b64_tr_b16 a[80:81], v7 offset:3072
    ds_read_b64_tr_b16 a[82:83], v7 offset:4608
    ds_read_b64_tr_b16 a[84:85], v7 offset:3104
    ds_read_b64_tr_b16 a[86:87], v7 offset:4640
    s_waitcnt vmcnt(40)
    ds_write_b128 v6, a[88:91] offset:0
    ds_write_b128 v6, a[92:95] offset:1536
    ds_read_b64_tr_b16 a[88:89], v7 offset:0
    ds_read_b64_tr_b16 a[90:91], v7 offset:1536
    ds_read_b64_tr_b16 a[92:93], v7 offset:32
    ds_read_b64_tr_b16 a[94:95], v7 offset:1568
    s_waitcnt vmcnt(38)
    ds_write_b128 v6, a[96:99] offset:3072
    ds_write_b128 v6, a[100:103] offset:4608
    ds_read_b64_tr_b16 a[96:97], v7 offset:3072
    ds_read_b64_tr_b16 a[98:99], v7 offset:4608
    ds_read_b64_tr_b16 a[100:101], v7 offset:3104
    ds_read_b64_tr_b16 a[102:103], v7 offset:4640
    s_waitcnt vmcnt(36)
    ds_write_b128 v6, a[104:107] offset:0
    ds_write_b128 v6, a[108:111] offset:1536
    ds_read_b64_tr_b16 a[104:105], v7 offset:0
    ds_read_b64_tr_b16 a[106:107], v7 offset:1536
    ds_read_b64_tr_b16 a[108:109], v7 offset:32
    ds_read_b64_tr_b16 a[110:111], v7 offset:1568
    s_waitcnt vmcnt(34)
    ds_write_b128 v6, a[112:115] offset:3072
    ds_write_b128 v6, a[116:119] offset:4608
    ds_read_b64_tr_b16 a[112:113], v7 offset:3072
    ds_read_b64_tr_b16 a[114:115], v7 offset:4608
    ds_read_b64_tr_b16 a[116:117], v7 offset:3104
    ds_read_b64_tr_b16 a[118:119], v7 offset:4640
    s_waitcnt vmcnt(32)
    ds_write_b128 v6, a[120:123] offset:0
    ds_write_b128 v6, a[124:127] offset:1536
    ds_read_b64_tr_b16 a[120:121], v7 offset:0
    ds_read_b64_tr_b16 a[122:123], v7 offset:1536
    ds_read_b64_tr_b16 a[124:125], v7 offset:32
    ds_read_b64_tr_b16 a[126:127], v7 offset:1568
    s_waitcnt vmcnt(30)
    ds_write_b128 v6, a[128:131] offset:3072
    ds_write_b128 v6, a[132:135] offset:4608
    ds_read_b64_tr_b16 a[128:129], v7 offset:3072
    ds_read_b64_tr_b16 a[130:131], v7 offset:4608
    ds_read_b64_tr_b16 a[132:133], v7 offset:3104
    ds_read_b64_tr_b16 a[134:135], v7 offset:4640
    s_waitcnt vmcnt(28)
    ds_write_b128 v6, a[136:139] offset:0
    ds_write_b128 v6, a[140:143] offset:1536
    ds_read_b64_tr_b16 a[136:137], v7 offset:0
    ds_read_b64_tr_b16 a[138:139], v7 offset:1536
    ds_read_b64_tr_b16 a[140:141], v7 offset:32
    ds_read_b64_tr_b16 a[142:143], v7 offset:1568
    s_waitcnt vmcnt(26)
    ds_write_b128 v6, a[144:147] offset:3072
    ds_write_b128 v6, a[148:151] offset:4608
    ds_read_b64_tr_b16 a[144:145], v7 offset:3072
    ds_read_b64_tr_b16 a[146:147], v7 offset:4608
    ds_read_b64_tr_b16 a[148:149], v7 offset:3104
    ds_read_b64_tr_b16 a[150:151], v7 offset:4640
    s_waitcnt vmcnt(24)
    ds_write_b128 v6, a[152:155] offset:0
    ds_write_b128 v6, a[156:159] offset:1536
    ds_read_b64_tr_b16 a[152:153], v7 offset:0
    ds_read_b64_tr_b16 a[154:155], v7 offset:1536
    ds_read_b64_tr_b16 a[156:157], v7 offset:32
    ds_read_b64_tr_b16 a[158:159], v7 offset:1568
    s_waitcnt vmcnt(22)
    ds_write_b128 v6, a[160:163] offset:3072
    ds_write_b128 v6, a[164:167] offset:4608
    ds_read_b64_tr_b16 a[160:161], v7 offset:3072
    ds_read_b64_tr_b16 a[162:163], v7 offset:4608
    ds_read_b64_tr_b16 a[164:165], v7 offset:3104
    ds_read_b64_tr_b16 a[166:167], v7 offset:4640
    s_waitcnt vmcnt(20)
    ds_write_b128 v6, a[168:171] offset:0
    ds_write_b128 v6, a[172:175] offset:1536
    ds_read_b64_tr_b16 a[168:169], v7 offset:0
    ds_read_b64_tr_b16 a[170:171], v7 offset:1536
    ds_read_b64_tr_b16 a[172:173], v7 offset:32
    ds_read_b64_tr_b16 a[174:175], v7 offset:1568
    s_waitcnt vmcnt(18)
    ds_write_b128 v6, a[176:179] offset:3072
    ds_write_b128 v6, a[180:183] offset:4608
    ds_read_b64_tr_b16 a[176:177], v7 offset:3072
    ds_read_b64_tr_b16 a[178:179], v7 offset:4608
    ds_read_b64_tr_b16 a[180:181], v7 offset:3104
    ds_read_b64_tr_b16 a[182:183], v7 offset:4640
    s_waitcnt vmcnt(16)
    ds_write_b128 v6, a[184:187] offset:0
    ds_write_b128 v6, a[188:191] offset:1536
    ds_read_b64_tr_b16 a[184:185], v7 offset:0
    ds_read_b64_tr_b16 a[186:187], v7 offset:1536
    ds_read_b64_tr_b16 a[188:189], v7 offset:32
    ds_read_b64_tr_b16 a[190:191], v7 offset:1568
    s_waitcnt vmcnt(14)
    ds_write_b128 v6, a[192:195] offset:3072
    ds_write_b128 v6, a[196:199] offset:4608
    ds_read_b64_tr_b16 a[192:193], v7 offset:3072
    ds_read_b64_tr_b16 a[194:195], v7 offset:4608
    ds_read_b64_tr_b16 a[196:197], v7 offset:3104
    ds_read_b64_tr_b16 a[198:199], v7 offset:4640
    s_waitcnt vmcnt(12)
    ds_write_b128 v6, a[200:203] offset:0
    ds_write_b128 v6, a[204:207] offset:1536
    ds_read_b64_tr_b16 a[200:201], v7 offset:0
    ds_read_b64_tr_b16 a[202:203], v7 offset:1536
    ds_read_b64_tr_b16 a[204:205], v7 offset:32
    ds_read_b64_tr_b16 a[206:207], v7 offset:1568
    s_waitcnt vmcnt(10)
    ds_write_b128 v6, a[208:211] offset:3072
    ds_write_b128 v6, a[212:215] offset:4608
    ds_read_b64_tr_b16 a[208:209], v7 offset:3072
    ds_read_b64_tr_b16 a[210:211], v7 offset:4608
    ds_read_b64_tr_b16 a[212:213], v7 offset:3104
    ds_read_b64_tr_b16 a[214:215], v7 offset:4640
    s_waitcnt vmcnt(8)
    ds_write_b128 v6, a[216:219] offset:0
    ds_write_b128 v6, a[220:223] offset:1536
    ds_read_b64_tr_b16 a[216:217], v7 offset:0
    ds_read_b64_tr_b16 a[218:219], v7 offset:1536
    ds_read_b64_tr_b16 a[220:221], v7 offset:32
    ds_read_b64_tr_b16 a[222:223], v7 offset:1568
    s_waitcnt vmcnt(6)
    ds_write_b128 v6, a[224:227] offset:3072
    ds_write_b128 v6, a[228:231] offset:4608
    ds_read_b64_tr_b16 a[224:225], v7 offset:3072
    ds_read_b64_tr_b16 a[226:227], v7 offset:4608
    ds_read_b64_tr_b16 a[228:229], v7 offset:3104
    ds_read_b64_tr_b16 a[230:231], v7 offset:4640
    s_waitcnt vmcnt(4)
    ds_write_b128 v6, a[232:235] offset:0
    ds_write_b128 v6, a[236:239] offset:1536
    ds_read_b64_tr_b16 a[232:233], v7 offset:0
    ds_read_b64_tr_b16 a[234:235], v7 offset:1536
    ds_read_b64_tr_b16 a[236:237], v7 offset:32
    ds_read_b64_tr_b16 a[238:239], v7 offset:1568
    s_waitcnt vmcnt(2)
    ds_write_b128 v6, a[240:243] offset:3072
    ds_write_b128 v6, a[244:247] offset:4608
    ds_read_b64_tr_b16 a[240:241], v7 offset:3072
    ds_read_b64_tr_b16 a[242:243], v7 offset:4608
    ds_read_b64_tr_b16 a[244:245], v7 offset:3104
    ds_read_b64_tr_b16 a[246:247], v7 offset:4640
    s_waitcnt vmcnt(0)
    ds_write_b128 v6, a[248:251] offset:0
    ds_write_b128 v6, a[252:255] offset:1536
    ds_read_b64_tr_b16 a[248:249], v7 offset:0
    ds_read_b64_tr_b16 a[250:251], v7 offset:1536
    ds_read_b64_tr_b16 a[252:253], v7 offset:32
    ds_read_b64_tr_b16 a[254:255], v7 offset:1568
    s_waitcnt lgkmcnt(0)
    s_lshl_b32 s50, s44, 2
    s_add_u32 s50, s50, 8
    s_mov_b32 s51, 0
    s_mov_b32 s36, 0
    s_cmp_lg_u32 s41, 0
    s_cbranch_scc1 L_wdffn_74
L_wffn_73:
    buffer_load_dword v11, v10, s[8:11], s50 offen sc1
    s_waitcnt vmcnt(0)
    v_readfirstlane_b32 s35, v11
    s_lshr_b32 s35, s35, s51
    s_and_b32 s35, s35, 0xff
    s_cmp_ge_u32 s35, 22
    s_cbranch_scc1 L_wdffn_74
    s_sleep 4
    s_add_u32 s36, s36, 1
    s_cmp_lt_u32 s36, 131072
    s_cbranch_scc1 L_wffn_73
    s_mov_b32 s41, 1
L_wdffn_74:
    s_mov_b32 s50, 0
    s_mov_b32 s36, 0
    s_cmp_lg_u32 s41, 0
    s_cbranch_scc1 L_wdoci_76
L_woci_75:
    buffer_load_dword v11, v10, s[8:11], s50 offen sc1
    s_waitcnt vmcnt(0)
    v_readfirstlane_b32 s35, v11
    s_lshr_b32 s35, s35, s51
    s_and_b32 s35, s35, 0xff
    s_cmp_ge_u32 s35, 32
    s_cbranch_scc1 L_wdoci_76
    s_sleep 4
    s_add_u32 s36, s36, 1
    s_cmp_lt_u32 s36, 131072
    s_cbranch_scc1 L_woci_75
    s_mov_b32 s41, 1
L_wdoci_76:
    s_barrier
    v_and_b32 v11, 31, v1
    v_lshlrev_b32 v11, 2, v11
    s_lshl_b32 s35, s32, 12
    v_add_u32 v5, s35, v2
    s_and_b32 s35, s32, 1
    s_lshl_b32 s35, s35, 10
    v_add_u32 v6, s35, v2
    s_lshl_b32 s35, s45, 14
    s_lshl_b32 s36, s46, 6
    s_add_u32 s35, s35, s36
    s_and_b32 s36, s32, 1
    s_lshl_b32 s36, s36, 5
    s_add_u32 s35, s35, s36
    v_bfe_u32 v7, v1, 0, 4
    v_mul_u32_u24 v7, 1024, v7
    v_bfe_u32 v15, v1, 4, 2
    v_mul_u32_u24 v15, 8, v15
    v_add_u32 v7, v7, v15
    v_add_u32 v7, s35, v7
    s_lshl_b32 s35, s45, 6
    v_bfe_u32 v8, v1, 0, 4
    v_mul_u32_u24 v8, 4, v8
    v_add_u32 v8, s35, v8
    s_cmp_lg_u32 s44, 1
    s_cbranch_scc1 L_nob63_77
    s_mul_i32 s38, s45, 44032
    s_mul_i32 s37, s32, 11264
    s_add_u32 s37, s37, s38
    s_add_u32 s37, s37, 0x554a800
    buffer_load_dwordx4 v[32:35], v2, s[4:7], s37 offen offset:0
    buffer_load_dwordx4 v[36:39], v2, s[4:7], s37 offen offset:1024
    buffer_load_dwordx4 v[40:43], v2, s[4:7], s37 offen offset:2048
    buffer_load_dwordx4 v[44:47], v2, s[4:7], s37 offen offset:3072
    s_add_u32 s37, s37, 4096
    buffer_load_dwordx4 v[48:51], v2, s[4:7], s37 offen offset:0
    buffer_load_dwordx4 v[52:55], v2, s[4:7], s37 offen offset:1024
    buffer_load_dwordx4 v[56:59], v2, s[4:7], s37 offen offset:2048
    buffer_load_dwordx4 v[60:63], v2, s[4:7], s37 offen offset:3072
    s_add_u32 s37, s37, 4096
    buffer_load_dwordx4 v[64:67], v2, s[4:7], s37 offen offset:0
    buffer_load_dwordx4 v[68:71], v2, s[4:7], s37 offen offset:1024
    s_cmp_eq_u32 s32, 3
    s_cselect_b32 s38, 1024, 0
    s_sub_u32 s37, s37, s38
    buffer_load_dwordx4 v[72:75], v2, s[4:7], s37 offen offset:2048
    s_waitcnt vmcnt(10)
    v_mfma_f32_16x16x32_bf16 v[24:27], v[128:131], v[32:35], 0
    v_mfma_f32_16x16x32_bf16 v[28:31], v[132:135], v[32:35], 0
    s_waitcnt vmcnt(9)
    v_mfma_f32_16x16x32_bf16 v[24:27], v[136:139], v[36:39], v[24:27]
    v_mfma_f32_16x16x32_bf16 v[28:31], v[140:143], v[36:39], v[28:31]
    s_waitcnt vmcnt(8)
    v_mfma_f32_16x16x32_bf16 v[24:27], v[144:147], v[40:43], v[24:27]
    v_mfma_f32_16x16x32_bf16 v[28:31], v[148:151], v[40:43], v[28:31]
    s_waitcnt vmcnt(7)
    v_mfma_f32_16x16x32_bf16 v[24:27], v[152:155], v[44:47], v[24:27]
    v_mfma_f32_16x16x32_bf16 v[28:31], v[156:159], v[44:47], v[28:31]
    s_waitcnt vmcnt(6)
    v_mfma_f32_16x16x32_bf16 v[24:27], v[160:163], v[48:51], v[24:27]
    v_mfma_f32_16x16x32_bf16 v[28:31], v[164:167], v[48:51], v[28:31]
    s_waitcnt vmcnt(5)
    v_mfma_f32_16x16x32_bf16 v[24:27], v[168:171], v[52:55], v[24:27]
    v_mfma_f32_16x16x32_bf16 v[28:31], v[172:175], v[52:55], v[28:31]
    s_waitcnt vmcnt(4)
    v_mfma_f32_16x16x32_bf16 v[24:27], v[176:179], v[56:59], v[24:27]
    v_mfma_f32_16x16x32_bf16 v[28:31], v[180:183], v[56:59], v[28:31]
    s_waitcnt vmcnt(3)
    v_mfma_f32_16x16x32_bf16 v[24:27], v[184:187], v[60:63], v[24:27]
    v_mfma_f32_16x16x32_bf16 v[28:31], v[188:191], v[60:63], v[28:31]
    s_waitcnt vmcnt(2)
    v_mfma_f32_16x16x32_bf16 v[24:27], v[192:195], v[64:67], v[24:27]
    v_mfma_f32_16x16x32_bf16 v[28:31], v[196:199], v[64:67], v[28:31]
    s_waitcnt vmcnt(1)
    v_mfma_f32_16x16x32_bf16 v[24:27], v[200:203], v[68:71], v[24:27]
    v_mfma_f32_16x16x32_bf16 v[28:31], v[204:207], v[68:71], v[28:31]
    s_waitcnt vmcnt(0)
    v_mfma_f32_16x16x32_bf16 v[24:27], v[208:211], v[72:75], v[24:27]
    v_mfma_f32_16x16x32_bf16 v[28:31], v[212:215], v[72:75], v[28:31]
    s_nop 7
    ds_write_b128 v5, v[24:27] offset:2048
    ds_write_b128 v5, v[28:31] offset:3072
    s_waitcnt lgkmcnt(0)
    s_barrier
    s_cmp_gt_u32 s32, 1
    s_cbranch_scc1 L_b63s_78
    ds_read_b128 v[32:35], v6 offset:2048
    ds_read_b128 v[36:39], v6 offset:6144
    ds_read_b128 v[40:43], v6 offset:10240
    ds_read_b128 v[44:47], v6 offset:14336
    v_lshlrev_b32 v12, 1, v7
    s_waitcnt lgkmcnt(0)
    v_add_f32 v32, v32, v36
    v_add_f32 v40, v40, v44
    v_add_f32 v33, v33, v37
    v_add_f32 v41, v41, v45
    v_add_f32 v34, v34, v38
    v_add_f32 v42, v42, v46
    v_add_f32 v35, v35, v39
    v_add_f32 v43, v43, v47
    v_add_f32 v32, v32, v40
    v_add_f32 v33, v33, v41
    v_add_f32 v34, v34, v42
    v_add_f32 v35, v35, v43
    s_mov_b32 s37, 0xb10000
    buffer_store_dwordx4 v[32:35], v12, s[4:7], s37 offen sc1
    s_waitcnt vmcnt(0)
L_b63s_78:
    s_barrier
    s_cmp_lg_u32 s32, 0
    s_cbranch_scc1 L_b63f_79
    v_mov_b32 v13, 1
    s_mov_b32 s37, 0x121f80
    s_mov_b64 exec, 1
    buffer_atomic_add v13, off, s[4:7], s37 sc1
    s_mov_b64 exec, -1
L_b63f_79:
L_nob63_77:
    s_mov_b32 s47, s44
    v_mov_b32 v12, 0
L_out_loop_80:
    s_mul_i32 s37, s47, 88064
    s_mul_i32 s38, s45, 44032
    s_add_u32 s37, s37, s38
    s_mul_i32 s38, s32, 11264
    s_add_u32 s37, s37, s38
    s_add_u32 s37, s37, 0x5000000
    buffer_load_dwordx4 v[32:35], v2, s[4:7], s37 offen offset:0
    buffer_load_dwordx4 v[36:39], v2, s[4:7], s37 offen offset:1024
    buffer_load_dwordx4 v[40:43], v2, s[4:7], s37 offen offset:2048
    buffer_load_dwordx4 v[44:47], v2, s[4:7], s37 offen offset:3072
    s_add_u32 s37, s37, 4096
    buffer_load_dwordx4 v[48:51], v2, s[4:7], s37 offen offset:0
    buffer_load_dwordx4 v[52:55], v2, s[4:7], s37 offen offset:1024
    buffer_load_dwordx4 v[56:59], v2, s[4:7], s37 offen offset:2048
    buffer_load_dwordx4 v[60:63], v2, s[4:7], s37 offen offset:3072
    s_add_u32 s37, s37, 4096
    buffer_load_dwordx4 v[64:67], v2, s[4:7], s37 offen offset:0
    buffer_load_dwordx4 v[68:71], v2, s[4:7], s37 offen offset:1024
    s_cmp_eq_u32 s32, 3
    s_cselect_b32 s38, 1024, 0
    s_sub_u32 s37, s37, s38
    buffer_load_dwordx4 v[72:75], v2, s[4:7], s37 offen offset:2048
    s_lshl_b32 s37, s47, 7
    s_add_u32 s37, s37, 0x5800000
    buffer_load_dword v9, v8, s[4:7], s37 offen
    s_lshl_b32 s50, s47, 7
    s_add_u32 s50, s50, 0x120000
    v_cmp_ne_u32 vcc, 0, v12
    s_nop 0
    s_cmp_eq_u64 vcc, -1
    s_cbranch_scc1 L_ow_81
    s_cmp_lg_u32 s41, 0
    s_cbranch_scc1 L_ow_81
    s_mov_b32 s51, 0
L_op_82:
    buffer_load_dword v10, v11, s[4:7], s50 offen sc1
    s_waitcnt vmcnt(0)
    v_cmp_ne_u32 vcc, 0, v10
    s_add_u32 s51, s51, 1
    s_nop 0
    s_cmp_eq_u64 vcc, -1
    s_cbranch_scc1 L_ow_81
    s_sleep 4
    s_cmp_lt_u32 s51, 131072
    s_cbranch_scc1 L_op_82
    s_mov_b32 s41, 1
L_ow_81:
    s_add_u32 s50, s50, 256
    buffer_load_dword v12, v11, s[4:7], s50 offen sc1
    s_lshl_b32 s54, s47, 5
    s_lshl_b32 s38, s32, 3
    s_add_u32 s54, s54, s38
    s_lshl_b32 s54, s54, 13
    s_lshl_b32 s38, s45, 12
    s_add_u32 s54, s54, s38
    s_add_u32 s54, s54, 0x4000000
    s_add_u32 s38, s54, 0
    buffer_load_dwordx4 v[76:79], v2, s[4:7], s38 offen offset:0
    s_add_u32 s38, s54, 0
    buffer_load_dwordx4 v[80:83], v2, s[4:7], s38 offen offset:1024
    s_add_u32 s38, s54, 0
    buffer_load_dwordx4 v[84:87], v2, s[4:7], s38 offen offset:2048
    s_add_u32 s38, s54, 0
    buffer_load_dwordx4 v[88:91], v2, s[4:7], s38 offen offset:3072
    s_add_u32 s38, s54, 8192
    buffer_load_dwordx4 v[92:95], v2, s[4:7], s38 offen offset:0
    s_add_u32 s38, s54, 8192
    buffer_load_dwordx4 v[96:99], v2, s[4:7], s38 offen offset:1024
    s_add_u32 s38, s54, 8192
    buffer_load_dwordx4 v[100:103], v2, s[4:7], s38 offen offset:2048
    s_add_u32 s38, s54, 8192
    buffer_load_dwordx4 v[104:107], v2, s[4:7], s38 offen offset:3072
    s_add_u32 s38, s54, 16384
    buffer_load_dwordx4 v[108:111], v2, s[4:7], s38 offen offset:0
    s_add_u32 s38, s54, 16384
    buffer_load_dwordx4 v[112:115], v2, s[4:7], s38 offen offset:1024
    s_add_u32 s38, s54, 16384
    buffer_load_dwordx4 v[116:119], v2, s[4:7], s38 offen offset:2048
    s_add_u32 s38, s54, 16384
    buffer_load_dwordx4 v[120:123], v2, s[4:7], s38 offen offset:3072
    s_add_u32 s38, s54, 24576
    buffer_load_dwordx4 v[124:127], v2, s[4:7], s38 offen offset:0
    s_add_u32 s38, s54, 24576
    buffer_load_dwordx4 v[216:219], v2, s[4:7], s38 offen offset:1024
    s_add_u32 s38, s54, 24576
    buffer_load_dwordx4 v[220:223], v2, s[4:7], s38 offen offset:2048
    s_add_u32 s38, s54, 24576
    buffer_load_dwordx4 v[224:227], v2, s[4:7], s38 offen offset:3072
    s_add_u32 s38, s54, 32768
    buffer_load_dwordx4 v[228:231], v2, s[4:7], s38 offen offset:0
    s_add_u32 s38, s54, 32768
    buffer_load_dwordx4 v[232:235], v2, s[4:7], s38 offen offset:1024
    s_add_u32 s38, s54, 32768
    buffer_load_dwordx4 v[236:239], v2, s[4:7], s38 offen offset:2048
    s_add_u32 s38, s54, 32768
    buffer_load_dwordx4 v[240:243], v2, s[4:7], s38 offen offset:3072
    s_add_u32 s38, s54, 40960
    buffer_load_dwordx4 v[244:247], v2, s[4:7], s38 offen offset:0
    s_add_u32 s38, s54, 40960
    buffer_load_dwordx4 v[248:251], v2, s[4:7], s38 offen offset:1024
    s_add_u32 s38, s54, 40960
    buffer_load_dwordx4 v[252:255], v2, s[4:7], s38 offen offset:2048
    s_waitcnt vmcnt(35)
    v_mfma_f32_16x16x32_bf16 v[24:27], v[128:131], v[32:35], 0
    v_mfma_f32_16x16x32_bf16 v[28:31], v[132:135], v[32:35], 0
    s_add_u32 s38, s54, 40960
    buffer_load_dwordx4 v[32:35], v2, s[4:7], s38 offen offset:3072
    s_waitcnt vmcnt(35)
    v_mfma_f32_16x16x32_bf16 v[24:27], v[136:139], v[36:39], v[24:27]
    v_mfma_f32_16x16x32_bf16 v[28:31], v[140:143], v[36:39], v[28:31]
    s_add_u32 s38, s54, 49152
    buffer_load_dwordx4 v[36:39], v2, s[4:7], s38 offen offset:0
    s_waitcnt vmcnt(35)
    v_mfma_f32_16x16x32_bf16 v[24:27], v[144:147], v[40:43], v[24:27]
    v_mfma_f32_16x16x32_bf16 v[28:31], v[148:151], v[40:43], v[28:31]
    s_add_u32 s38, s54, 49152
    buffer_load_dwordx4 v[40:43], v2, s[4:7], s38 offen offset:1024
    s_waitcnt vmcnt(35)
    v_mfma_f32_16x16x32_bf16 v[24:27], v[152:155], v[44:47], v[24:27]
    v_mfma_f32_16x16x32_bf16 v[28:31], v[156:159], v[44:47], v[28:31]
    s_add_u32 s38, s54, 49152
    buffer_load_dwordx4 v[44:47], v2, s[4:7], s38 offen offset:2048
    s_waitcnt vmcnt(35)
    v_mfma_f32_16x16x32_bf16 v[24:27], v[160:163], v[48:51], v[24:27]
    v_mfma_f32_16x16x32_bf16 v[28:31], v[164:167], v[48:51], v[28:31]
    s_add_u32 s38, s54, 49152
    buffer_load_dwordx4 v[48:51], v2, s[4:7], s38 offen offset:3072
    s_waitcnt vmcnt(35)
    v_mfma_f32_16x16x32_bf16 v[24:27], v[168:171], v[52:55], v[24:27]
    v_mfma_f32_16x16x32_bf16 v[28:31], v[172:175], v[52:55], v[28:31]
    s_add_u32 s38, s54, 57344
    buffer_load_dwordx4 v[52:55], v2, s[4:7], s38 offen offset:0
    s_waitcnt vmcnt(35)
    v_mfma_f32_16x16x32_bf16 v[24:27], v[176:179], v[56:59], v[24:27]
    v_mfma_f32_16x16x32_bf16 v[28:31], v[180:183], v[56:59], v[28:31]
    s_add_u32 s38, s54, 57344
    buffer_load_dwordx4 v[56:59], v2, s[4:7], s38 offen offset:1024
    s_waitcnt vmcnt(35)
    v_mfma_f32_16x16x32_bf16 v[24:27], v[184:187], v[60:63], v[24:27]
    v_mfma_f32_16x16x32_bf16 v[28:31], v[188:191], v[60:63], v[28:31]
    s_add_u32 s38, s54, 57344
    buffer_load_dwordx4 v[60:63], v2, s[4:7], s38 offen offset:2048
    s_waitcnt vmcnt(35)
    v_mfma_f32_16x16x32_bf16 v[24:27], v[192:195], v[64:67], v[24:27]
    v_mfma_f32_16x16x32_bf16 v[28:31], v[196:199], v[64:67], v[28:31]
    s_add_u32 s38, s54, 57344
    buffer_load_dwordx4 v[64:67], v2, s[4:7], s38 offen offset:3072
    s_waitcnt vmcnt(35)
    v_mfma_f32_16x16x32_bf16 v[24:27], v[200:203], v[68:71], v[24:27]
    v_mfma_f32_16x16x32_bf16 v[28:31], v[204:207], v[68:71], v[28:31]
    s_waitcnt vmcnt(34)
    v_mfma_f32_16x16x32_bf16 v[24:27], v[208:211], v[72:75], v[24:27]
    v_mfma_f32_16x16x32_bf16 v[28:31], v[212:215], v[72:75], v[28:31]
    s_waitcnt vmcnt(31)
    v_mfma_f32_16x16x32_bf16 v[16:19], a[0:3], v[76:79], 0
    v_mfma_f32_16x16x32_bf16 v[20:23], a[4:7], v[76:79], 0
    s_waitcnt vmcnt(30)
    v_mfma_f32_16x16x32_bf16 v[16:19], a[8:11], v[80:83], v[16:19]
    v_mfma_f32_16x16x32_bf16 v[20:23], a[12:15], v[80:83], v[20:23]
    s_waitcnt vmcnt(29)
    v_mfma_f32_16x16x32_bf16 v[16:19], a[16:19], v[84:87], v[16:19]
    v_mfma_f32_16x16x32_bf16 v[20:23], a[20:23], v[84:87], v[20:23]
    s_waitcnt vmcnt(28)
    v_mfma_f32_16x16x32_bf16 v[16:19], a[24:27], v[88:91], v[16:19]
    v_mfma_f32_16x16x32_bf16 v[20:23], a[28:31], v[88:91], v[20:23]
    s_waitcnt vmcnt(27)
    v_mfma_f32_16x16x32_bf16 v[16:19], a[32:35], v[92:95], v[16:19]
    v_mfma_f32_16x16x32_bf16 v[20:23], a[36:39], v[92:95], v[20:23]
    s_waitcnt vmcnt(26)
    v_mfma_f32_16x16x32_bf16 v[16:19], a[40:43], v[96:99], v[16:19]
    v_mfma_f32_16x16x32_bf16 v[20:23], a[44:47], v[96:99], v[20:23]
    s_waitcnt vmcnt(25)
    v_mfma_f32_16x16x32_bf16 v[16:19], a[48:51], v[100:103], v[16:19]
    v_mfma_f32_16x16x32_bf16 v[20:23], a[52:55], v[100:103], v[20:23]
    s_waitcnt vmcnt(24)
    v_mfma_f32_16x16x32_bf16 v[16:19], a[56:59], v[104:107], v[16:19]
    v_mfma_f32_16x16x32_bf16 v[20:23], a[60:63], v[104:107], v[20:23]
    s_waitcnt vmcnt(23)
    v_mfma_f32_16x16x32_bf16 v[16:19], a[64:67], v[108:111], v[16:19]
    v_mfma_f32_16x16x32_bf16 v[20:23], a[68:71], v[108:111], v[20:23]
    s_waitcnt vmcnt(22)
    v_mfma_f32_16x16x32_bf16 v[16:19], a[72:75], v[112:115], v[16:19]
    v_mfma_f32_16x16x32_bf16 v[20:23], a[76:79], v[112:115], v[20:23]
    s_waitcnt vmcnt(21)
    v_mfma_f32_16x16x32_bf16 v[16:19], a[80:83], v[116:119], v[16:19]
    v_mfma_f32_16x16x32_bf16 v[20:23], a[84:87], v[116:119], v[20:23]
    s_waitcnt vmcnt(20)
    v_mfma_f32_16x16x32_bf16 v[16:19], a[88:91], v[120:123], v[16:19]
    v_mfma_f32_16x16x32_bf16 v[20:23], a[92:95], v[120:123], v[20:23]
    s_waitcnt vmcnt(19)
    v_mfma_f32_16x16x32_bf16 v[16:19], a[96:99], v[124:127], v[16:19]
    v_mfma_f32_16x16x32_bf16 v[20:23], a[100:103], v[124:127], v[20:23]
    s_waitcnt vmcnt(18)
    v_mfma_f32_16x16x32_bf16 v[16:19], a[104:107], v[216:219], v[16:19]
    v_mfma_f32_16x16x32_bf16 v[20:23], a[108:111], v[216:219], v[20:23]
    s_waitcnt vmcnt(17)
    v_mfma_f32_16x16x32_bf16 v[16:19], a[112:115], v[220:223], v[16:19]
    v_mfma_f32_16x16x32_bf16 v[20:23], a[116:119], v[220:223], v[20:23]
    s_waitcnt vmcnt(16)
    v_mfma_f32_16x16x32_bf16 v[16:19], a[120:123], v[224:227], v[16:19]
    v_mfma_f32_16x16x32_bf16 v[20:23], a[124:127], v[224:227], v[20:23]
    s_waitcnt vmcnt(15)
    v_mfma_f32_16x16x32_bf16 v[16:19], a[128:131], v[228:231], v[16:19]
    v_mfma_f32_16x16x32_bf16 v[20:23], a[132:135], v[228:231], v[20:23]
    s_waitcnt vmcnt(14)
    v_mfma_f32_16x16x32_bf16 v[16:19], a[136:139], v[232:235], v[16:19]
    v_mfma_f32_16x16x32_bf16 v[20:23], a[140:143], v[232:235], v[20:23]
    s_waitcnt vmcnt(13)
    v_mfma_f32_16x16x32_bf16 v[16:19], a[144:147], v[236:239], v[16:19]
    v_mfma_f32_16x16x32_bf16 v[20:23], a[148:151], v[236:239], v[20:23]
    s_waitcnt vmcnt(12)
    v_mfma_f32_16x16x32_bf16 v[16:19], a[152:155], v[240:243], v[16:19]
    v_mfma_f32_16x16x32_bf16 v[20:23], a[156:159], v[240:243], v[20:23]
    s_waitcnt vmcnt(11)
    v_mfma_f32_16x16x32_bf16 v[16:19], a[160:163], v[244:247], v[16:19]
    v_mfma_f32_16x16x32_bf16 v[20:23], a[164:167], v[244:247], v[20:23]
    s_waitcnt vmcnt(10)
    v_mfma_f32_16x16x32_bf16 v[16:19], a[168:171], v[248:251], v[16:19]
    v_mfma_f32_16x16x32_bf16 v[20:23], a[172:175], v[248:251], v[20:23]
    s_waitcnt vmcnt(9)
    v_mfma_f32_16x16x32_bf16 v[16:19], a[176:179], v[252:255], v[16:19]
    v_mfma_f32_16x16x32_bf16 v[20:23], a[180:183], v[252:255], v[20:23]
    s_waitcnt vmcnt(8)
    v_mfma_f32_16x16x32_bf16 v[16:19], a[184:187], v[32:35], v[16:19]
    v_mfma_f32_16x16x32_bf16 v[20:23], a[188:191], v[32:35], v[20:23]
    s_waitcnt vmcnt(7)
    v_mfma_f32_16x16x32_bf16 v[16:19], a[192:195], v[36:39], v[16:19]
    v_mfma_f32_16x16x32_bf16 v[20:23], a[196:199], v[36:39], v[20:23]
    s_waitcnt vmcnt(6)
    v_mfma_f32_16x16x32_bf16 v[16:19], a[200:203], v[40:43], v[16:19]
    v_mfma_f32_16x16x32_bf16 v[20:23], a[204:207], v[40:43], v[20:23]
    s_waitcnt vmcnt(5)
    v_mfma_f32_16x16x32_bf16 v[16:19], a[208:211], v[44:47], v[16:19]
    v_mfma_f32_16x16x32_bf16 v[20:23], a[212:215], v[44:47], v[20:23]
    s_waitcnt vmcnt(4)
    v_mfma_f32_16x16x32_bf16 v[16:19], a[216:219], v[48:51], v[16:19]
    v_mfma_f32_16x16x32_bf16 v[20:23], a[220:223], v[48:51], v[20:23]
    s_waitcnt vmcnt(3)
    v_mfma_f32_16x16x32_bf16 v[16:19], a[224:227], v[52:55], v[16:19]
    v_mfma_f32_16x16x32_bf16 v[20:23], a[228:231], v[52:55], v[20:23]
    s_waitcnt vmcnt(2)
    v_mfma_f32_16x16x32_bf16 v[16:19], a[232:235], v[56:59], v[16:19]
    v_mfma_f32_16x16x32_bf16 v[20:23], a[236:239], v[56:59], v[20:23]
    s_waitcnt vmcnt(1)
    v_mfma_f32_16x16x32_bf16 v[16:19], a[240:243], v[60:63], v[16:19]
    v_mfma_f32_16x16x32_bf16 v[20:23], a[244:247], v[60:63], v[20:23]
    s_waitcnt vmcnt(0)
    v_mfma_f32_16x16x32_bf16 v[16:19], a[248:251], v[64:67], v[16:19]
    v_mfma_f32_16x16x32_bf16 v[20:23], a[252:255], v[64:67], v[20:23]
    s_nop 7
    ds_write_b128 v5, v[16:19] offset:0
    ds_write_b128 v5, v[20:23] offset:1024
    ds_write_b128 v5, v[24:27] offset:2048
    ds_write_b128 v5, v[28:31] offset:3072
    s_waitcnt lgkmcnt(0)
    s_barrier
    s_cmp_gt_u32 s32, 1
    s_cbranch_scc1 L_osk_83
    ds_read_b128 v[32:35], v6 offset:0
    ds_read_b128 v[36:39], v6 offset:2048
    ds_read_b128 v[40:43], v6 offset:4096
    ds_read_b128 v[44:47], v6 offset:6144
    ds_read_b128 v[48:51], v6 offset:8192
    ds_read_b128 v[52:55], v6 offset:10240
    ds_read_b128 v[56:59], v6 offset:12288
    ds_read_b128 v[60:63], v6 offset:14336
    s_waitcnt lgkmcnt(0)
    v_add_f32 v32, v32, v40
    v_add_f32 v48, v48, v56
    v_add_f32 v36, v36, v44
    v_add_f32 v52, v52, v60
    v_add_f32 v33, v33, v41
    v_add_f32 v49, v49, v57
    v_add_f32 v37, v37, v45
    v_add_f32 v53, v53, v61
    v_add_f32 v34, v34, v42
    v_add_f32 v50, v50, v58
    v_add_f32 v38, v38, v46
    v_add_f32 v54, v54, v62
    v_add_f32 v35, v35, v43
    v_add_f32 v51, v51, v59
    v_add_f32 v39, v39, v47
    v_add_f32 v55, v55, v63
    v_add_f32 v32, v32, v48
    v_add_f32 v36, v36, v52
    v_add_f32 v33, v33, v49
    v_add_f32 v37, v37, v53
    v_add_f32 v34, v34, v50
    v_add_f32 v38, v38, v54
    v_add_f32 v35, v35, v51
    v_add_f32 v39, v39, v55
    v_sub_f32 v32, v32, v36
    v_sub_f32 v33, v33, v37
    v_sub_f32 v34, v34, v38
    v_sub_f32 v35, v35, v39
    v_fma_f32 v32, v32, v9, v36
    v_fma_f32 v33, v33, v9, v37
    v_fma_f32 v34, v34, v9, v38
    v_fma_f32 v35, v35, v9, v39
    v_cvt_pk_bf16_f32 v40, v32, v33
    v_cvt_pk_bf16_f32 v41, v34, v35
    s_lshl_b32 s37, s47, 15
    buffer_store_dwordx2 v[40:41], v7, s[24:27], s37 offen
L_osk_83:
    v_xor_b32 v5, 0x4000, v5
    v_xor_b32 v6, 0x4000, v6
    s_add_u32 s47, s47, 2
    s_cmp_lt_u32 s47, 63
    s_cbranch_scc1 L_out_loop_80
    s_waitcnt vmcnt(0)
L_role_end:
L_flush:
L_exit:
    s_endpgm
.section .rodata,"a"
.p2align 6
.amdhsa_kernel gated_mix__memory_aug_recurrent_mem_tr__dense_activation_silu__prompt_kernel
  .amdhsa_next_free_vgpr 512
  .amdhsa_next_free_sgpr 102
  .amdhsa_accum_offset 256
  .amdhsa_group_segment_fixed_size 0
  .amdhsa_kernarg_size 112
  .amdhsa_user_sgpr_count 2
  .amdhsa_user_sgpr_kernarg_segment_ptr 1
  .amdhsa_system_sgpr_workgroup_id_x 1
.end_amdhsa_kernel
```
